```python
import torch

def _softmax(x, axis=-1):
    return torch.softmax(x, dim=axis)
def _gelu(x):
    return torch.nn.functional.gelu(x, approximate="tanh")
def _silu(x):
    return torch.nn.functional.silu(x)
def _sigmoid(x):
    return torch.sigmoid(x)
def _layernorm(x, axis=-1, eps=1e-5):
    m = x.mean(dim=axis, keepdim=True)
    v = x.var(dim=axis, keepdim=True, unbiased=False)
    return (x - m) / torch.sqrt(v + eps)
def _scatter_add(tgt, idx, src, axis=0):
    return tgt.clone().index_add_(axis, idx, src)
def _segment_sum(src, seg, n):
    out = torch.zeros((n,) + src.shape[1:], dtype=src.dtype)
    return out.index_add_(0, seg, src)
def _pad(x, pw):
    flat = tuple(v for pair in reversed(pw) for v in pair)
    return torch.nn.functional.pad(x, flat)

kernel_name = 'standalone__glu_gated_reglu__prompt'

def setup_inputs():

    _w = (lambda a: (lambda t: t.to(torch.bfloat16) if t.is_floating_point() else t)(torch.as_tensor(a)))
    B, S, D, F = 1, 2048, 576, 4608
    return {
        "x": _w((lambda *s: torch.randn(*s, dtype=torch.bfloat16) * 0.05)(B, S, D)),
        "W_gate": _w((lambda *s: torch.randn(*s, dtype=torch.bfloat16) * 0.05)(D, F) * (2.0 / D) ** 0.5),
        "W_up": _w((lambda *s: torch.randn(*s, dtype=torch.bfloat16) * 0.05)(D, F) * (2.0 / D) ** 0.5),
        "W_down": _w((lambda *s: torch.randn(*s, dtype=torch.bfloat16) * 0.05)(F, D) * (1.0 / F) ** 0.5),
    }

def reference(x, W_gate, W_up, W_down):
    gate = torch.einsum("bsd,df->bsf", x, W_gate)
    up = torch.einsum("bsd,df->bsf", x, W_up)
    gate = gate * (lambda x, dt: x.to(dt))(gate > 0, gate.dtype)
    h = gate * up
    return torch.einsum("bsf,fd->bsd", h, W_down)
```

```asm
; @launch grid=(256,1,1) block=(256,1,1) lds=163840
.amdgcn_target "amdgcn-amd-amdhsa--gfx950"
.text
.globl standalone__glu_gated_reglu__prompt_kernel
.p2align 8
.type standalone__glu_gated_reglu__prompt_kernel,@function
standalone__glu_gated_reglu__prompt_kernel:
    s_cmp_ge_u32 s2, 256
    s_cbranch_scc1 L_done
    s_load_dwordx8 s[4:11], s[0:1], 0
    s_load_dwordx4 s[12:15], s[0:1], 32
    s_load_dwordx2 s[16:17], s[0:1], 48
    v_and_b32 v232, 63, v0
    v_lshrrev_b32 v233, 6, v0
    s_and_b32 s46, s2, 7
    v_readfirstlane_b32 s44, v233
    s_lshr_b32 s51, s2, 3
    s_lshr_b32 s45, s51, 2
    s_and_b32 s47, s51, 3
    v_lshrrev_b32 v243, 3, v232
    v_and_b32 v244, 7, v232
    s_lshl_b32 s51, s47, 1
    s_add_u32 s51, s51, s45
    s_lshl_b32 s66, s46, 2
    s_add_u32 s51, s51, s66
    s_mul_i32 s66, s51, 57
    s_lshr_b32 s66, s66, 9
    s_mul_i32 s66, s66, 9
    s_sub_u32 s51, s51, s66
    s_lshl_b32 s72, s51, 7
    s_lshl_b32 s51, s45, 2
    s_add_u32 s51, s51, s44
    s_mul_i32 s50, s51, 73728
    s_lshl_b32 s53, s44, 13
    s_add_u32 s53, s53, 65536
    v_lshrrev_b32 v233, 1, v243
    v_xor_b32 v233, v233, v244
    v_mul_u32_u24 v234, 1152, v243
    v_xor_b32 v235, 4, v233
    v_lshl_add_u32 v236, v233, 4, v234
    v_lshl_add_u32 v237, v235, 4, v234
    v_add_u32 v16, 0, v236
    v_add_u32 v17, 8192, v237
    v_add_u32 v18, 16384, v236
    v_add_u32 v19, 24576, v237
    v_add_u32 v20, 36864, v236
    v_add_u32 v21, 45056, v237
    v_add_u32 v22, 53248, v236
    v_add_u32 v23, 61440, v237
    s_mul_i32 s51, s46, 1152
    s_lshl_b32 s66, s47, 8
    s_add_u32 s48, s51, s66
    s_lshl_b32 s66, s47, 5
    s_add_u32 s49, s51, s66
    s_add_u32 s49, s49, 1024
    s_lshl_b32 s52, s44, 12
    s_and_b32 s51, s44, 1
    s_lshl_b32 s51, s51, 5
    s_mov_b32 s66, 9216
    v_lshrrev_b32 v233, 1, v244
    v_bfe_u32 v234, v243, 1, 1
    v_xor_b32 v233, v233, v234
    v_and_b32 v235, 1, v244
    v_add_u32 v236, s51, v243
    v_mul_lo_u32 v236, v236, s66
    v_lshl_add_u32 v236, v235, 4, v236
    v_xor_b32 v234, 2, v233
    v_lshl_add_u32 v233, v233, 5, v236
    v_lshl_add_u32 v234, v234, 5, v236
    v_add_u32 v1, 0, v233
    v_add_u32 v2, 72704, v234
    v_add_u32 v3, 145408, v233
    v_add_u32 v4, 218112, v234
    s_waitcnt lgkmcnt(0)
    s_mov_b32 s20, s4
    s_mov_b32 s21, s5
    s_mov_b32 s22, 2359296
    s_mov_b32 s23, 0x00020000
    s_cmp_lt_u32 s44, 2
    s_cselect_b32 s24, s6, s8
    s_cselect_b32 s25, s7, s9
    s_mov_b32 s26, 5308416
    s_mov_b32 s27, 0x00020000
    s_add_u32 s69, s50, s72
    s_add_u32 m0, s53, 0
    s_nop 0
    buffer_load_dwordx4 v16, s[20:23], s69 offen offset:0 lds
    buffer_load_dwordx4 v17, s[20:23], s69 offen offset:1024 lds
    buffer_load_dwordx4 v18, s[20:23], s69 offen offset:2048 lds
    buffer_load_dwordx4 v19, s[20:23], s69 offen offset:3072 lds
    s_add_u32 m0, s53, 4096
    s_nop 0
    buffer_load_dwordx4 v20, s[20:23], s69 offen offset:0 lds
    buffer_load_dwordx4 v21, s[20:23], s69 offen offset:1024 lds
    buffer_load_dwordx4 v22, s[20:23], s69 offen offset:2048 lds
    buffer_load_dwordx4 v23, s[20:23], s69 offen offset:3072 lds
    s_mul_i32 s51, s72, 4608
    s_add_u32 s51, s51, s48
    s_add_u32 m0, s52, 0
    s_nop 0
    buffer_load_dwordx4 v1, s[24:27], s51 offen offset:0 lds
    buffer_load_dwordx4 v2, s[24:27], s51 offen offset:1024 lds
    buffer_load_dwordx4 v3, s[24:27], s51 offen offset:2048 lds
    buffer_load_dwordx4 v4, s[24:27], s51 offen offset:3072 lds
    s_getpc_b64 s[18:19]
L_pc:
    s_lshr_b32 s66, s2, 3
    s_lshl_b32 s66, s66, 2
    s_add_u32 s66, s66, s44
    s_mul_i32 s66, s66, 384
    v_min_u32 v224, 2, v232
    v_lshlrev_b32 v224, 7, v224
    v_add_u32 v224, s66, v224
    v_min_u32 v225, L_done-L_pc, v224
    global_load_dword v226, v225, s[18:19]
    s_add_u32 s73, s72, 128
    s_cmp_eq_u32 s73, 1152
    s_cselect_b32 s73, 0, s73
    s_add_u32 s74, s73, 128
    s_cmp_eq_u32 s74, 1152
    s_cselect_b32 s74, 0, s74
    s_add_u32 s75, s74, 128
    s_cmp_eq_u32 s75, 1152
    s_cselect_b32 s75, 0, s75
    s_add_u32 s76, s75, 128
    s_cmp_eq_u32 s76, 1152
    s_cselect_b32 s76, 0, s76
    s_add_u32 s77, s76, 128
    s_cmp_eq_u32 s77, 1152
    s_cselect_b32 s77, 0, s77
    s_add_u32 s78, s77, 128
    s_cmp_eq_u32 s78, 1152
    s_cselect_b32 s78, 0, s78
    s_add_u32 s79, s78, 128
    s_cmp_eq_u32 s79, 1152
    s_cselect_b32 s79, 0, s79
    s_add_u32 s80, s79, 128
    s_cmp_eq_u32 s80, 1152
    s_cselect_b32 s80, 0, s80
    v_lshrrev_b32 v240, 4, v232
    v_bfe_u32 v241, v232, 2, 2
    v_and_b32 v242, 3, v232
    v_lshlrev_b32 v15, 4, v232
    v_and_b32 v233, 15, v232
    v_lshrrev_b32 v234, 1, v233
    v_xor_b32 v234, v234, v240
    v_lshlrev_b32 v234, 4, v234
    v_lshl_add_u32 v234, v233, 7, v234
    v_add_u32 v24, s53, v234
    v_xor_b32 v25, 64, v24
    v_lshrrev_b32 v233, 1, v241
    v_and_b32 v234, 1, v240
    v_lshl_or_b32 v233, v234, 1, v233
    v_lshlrev_b32 v234, 10, v240
    v_lshl_add_u32 v234, v241, 7, v234
    v_lshl_add_u32 v234, v242, 3, v234
    v_xor_b32 v235, 0, v233
    v_lshl_add_u32 v5, v235, 5, v234
    v_xor_b32 v235, 1, v233
    v_lshl_add_u32 v6, v235, 5, v234
    v_xor_b32 v235, 2, v233
    v_lshl_add_u32 v7, v235, 5, v234
    v_xor_b32 v235, 3, v233
    v_lshl_add_u32 v8, v235, 5, v234
    s_add_u32 s19, s50, s73
    s_add_u32 m0, s53, 32768
    s_nop 0
    buffer_load_dwordx4 v16, s[20:23], s19 offen offset:0 lds
    buffer_load_dwordx4 v17, s[20:23], s19 offen offset:1024 lds
    buffer_load_dwordx4 v18, s[20:23], s19 offen offset:2048 lds
    buffer_load_dwordx4 v19, s[20:23], s19 offen offset:3072 lds
    s_add_u32 m0, s53, 36864
    s_nop 0
    buffer_load_dwordx4 v20, s[20:23], s19 offen offset:0 lds
    buffer_load_dwordx4 v21, s[20:23], s19 offen offset:1024 lds
    buffer_load_dwordx4 v22, s[20:23], s19 offen offset:2048 lds
    buffer_load_dwordx4 v23, s[20:23], s19 offen offset:3072 lds
    s_mul_i32 s51, s73, 4608
    s_add_u32 s51, s51, s48
    s_add_u32 m0, s52, 16384
    s_nop 0
    buffer_load_dwordx4 v1, s[24:27], s51 offen offset:0 lds
    buffer_load_dwordx4 v2, s[24:27], s51 offen offset:1024 lds
    buffer_load_dwordx4 v3, s[24:27], s51 offen offset:2048 lds
    buffer_load_dwordx4 v4, s[24:27], s51 offen offset:3072 lds
    s_waitcnt vmcnt(17)
    ds_read_b128 a[0:3], v24 offset:0
    ds_read_b128 a[4:7], v24 offset:2048
    ds_read_b128 a[8:11], v24 offset:4096
    ds_read_b128 a[12:15], v24 offset:6144
    ds_read_b128 a[16:19], v25 offset:0
    ds_read_b128 a[20:23], v25 offset:2048
    ds_read_b128 a[24:27], v25 offset:4096
    ds_read_b128 a[28:31], v25 offset:6144
    s_waitcnt vmcnt(13)
    s_barrier
    v_add_u32 v9, 0, v5
    v_add_u32 v10, 0, v6
    v_add_u32 v11, 0, v7
    v_add_u32 v12, 0, v8
    ds_read_b64_tr_b16 v[192:193], v9 offset:0
    ds_read_b64_tr_b16 v[194:195], v9 offset:512
    ds_read_b64_tr_b16 v[196:197], v10 offset:0
    ds_read_b64_tr_b16 v[198:199], v10 offset:512
    ds_read_b64_tr_b16 v[200:201], v11 offset:0
    ds_read_b64_tr_b16 v[202:203], v11 offset:512
    s_waitcnt lgkmcnt(4)
    v_mfma_f32_16x16x32_bf16 v[64:67], v[192:195], a[0:3], 0
    ds_read_b64_tr_b16 v[204:205], v12 offset:0
    v_mfma_f32_16x16x32_bf16 v[68:71], v[192:195], a[4:7], 0
    ds_read_b64_tr_b16 v[206:207], v12 offset:512
    s_mul_i32 s51, s74, 4608
    s_add_u32 s51, s51, s48
    v_mfma_f32_16x16x32_bf16 v[72:75], v[192:195], a[8:11], 0
    s_add_u32 m0, s52, 32768
    v_mfma_f32_16x16x32_bf16 v[76:79], v[192:195], a[12:15], 0
    buffer_load_dwordx4 v1, s[24:27], s51 offen offset:0 lds
    s_waitcnt lgkmcnt(4)
    v_mfma_f32_16x16x32_bf16 v[80:83], v[196:199], a[0:3], 0
    ds_read_b64_tr_b16 v[208:209], v9 offset:8192
    s_add_u32 s69, s50, s74
    v_mfma_f32_16x16x32_bf16 v[84:87], v[196:199], a[4:7], 0
    ds_read_b64_tr_b16 v[210:211], v9 offset:8704
    s_add_u32 m0, s53, 65536
    v_mfma_f32_16x16x32_bf16 v[88:91], v[196:199], a[8:11], 0
    buffer_load_dwordx4 v16, s[20:23], s69 offen offset:0 lds
    v_mfma_f32_16x16x32_bf16 v[92:95], v[196:199], a[12:15], 0
    s_waitcnt lgkmcnt(4)
    v_mfma_f32_16x16x32_bf16 v[96:99], v[200:203], a[0:3], 0
    ds_read_b64_tr_b16 v[212:213], v10 offset:8192
    v_mfma_f32_16x16x32_bf16 v[100:103], v[200:203], a[4:7], 0
    ds_read_b64_tr_b16 v[214:215], v10 offset:8704
    s_add_u32 m0, s52, 32768
    s_nop 0
    buffer_load_dwordx4 v2, s[24:27], s51 offen offset:1024 lds
    v_mfma_f32_16x16x32_bf16 v[104:107], v[200:203], a[8:11], 0
    v_mfma_f32_16x16x32_bf16 v[108:111], v[200:203], a[12:15], 0
    s_add_u32 m0, s53, 65536
    s_nop 0
    buffer_load_dwordx4 v17, s[20:23], s69 offen offset:1024 lds
    s_waitcnt lgkmcnt(4)
    v_mfma_f32_16x16x32_bf16 v[112:115], v[204:207], a[0:3], 0
    ds_read_b64_tr_b16 v[192:193], v11 offset:8192
    s_waitcnt vmcnt(8)
    v_mfma_f32_16x16x32_bf16 v[116:119], v[204:207], a[4:7], 0
    ds_read_b64_tr_b16 v[194:195], v11 offset:8704
    ds_read_b128 a[32:35], v24 offset:32768
    v_mfma_f32_16x16x32_bf16 v[120:123], v[204:207], a[8:11], 0
    buffer_load_dwordx4 v18, s[20:23], s69 offen offset:2048 lds
    v_mfma_f32_16x16x32_bf16 v[124:127], v[204:207], a[12:15], 0
    s_add_u32 m0, s52, 32768
    s_nop 0
    buffer_load_dwordx4 v3, s[24:27], s51 offen offset:2048 lds
    s_waitcnt lgkmcnt(5)
    v_mfma_f32_16x16x32_bf16 v[128:131], v[208:211], a[0:3], 0
    ds_read_b64_tr_b16 v[196:197], v12 offset:8192
    ds_read_b128 a[36:39], v24 offset:34816
    v_mfma_f32_16x16x32_bf16 v[132:135], v[208:211], a[4:7], 0
    ds_read_b64_tr_b16 v[198:199], v12 offset:8704
    s_add_u32 m0, s53, 65536
    s_nop 0
    buffer_load_dwordx4 v19, s[20:23], s69 offen offset:3072 lds
    v_mfma_f32_16x16x32_bf16 v[136:139], v[208:211], a[8:11], 0
    s_add_u32 m0, s53, 69632
    v_mfma_f32_16x16x32_bf16 v[140:143], v[208:211], a[12:15], 0
    ds_read_b128 a[40:43], v24 offset:36864
    s_waitcnt lgkmcnt(7)
    v_mfma_f32_16x16x32_bf16 v[144:147], v[212:215], a[0:3], 0
    ds_read_b64_tr_b16 v[200:201], v9 offset:4096
    buffer_load_dwordx4 v20, s[20:23], s69 offen offset:0 lds
    v_mfma_f32_16x16x32_bf16 v[148:151], v[212:215], a[4:7], 0
    ds_read_b64_tr_b16 v[202:203], v9 offset:4608
    s_add_u32 m0, s52, 32768
    s_nop 0
    buffer_load_dwordx4 v4, s[24:27], s51 offen offset:3072 lds
    v_mfma_f32_16x16x32_bf16 v[152:155], v[212:215], a[8:11], 0
    ds_read_b128 a[44:47], v24 offset:38912
    v_mfma_f32_16x16x32_bf16 v[156:159], v[212:215], a[12:15], 0
    s_add_u32 m0, s53, 69632
    s_nop 0
    buffer_load_dwordx4 v21, s[20:23], s69 offen offset:1024 lds
    s_waitcnt lgkmcnt(8)
    v_mfma_f32_16x16x32_bf16 v[160:163], v[192:195], a[0:3], 0
    ds_read_b64_tr_b16 v[204:205], v10 offset:4096
    ds_read_b128 a[48:51], v25 offset:32768
    v_mfma_f32_16x16x32_bf16 v[164:167], v[192:195], a[4:7], 0
    ds_read_b64_tr_b16 v[206:207], v10 offset:4608
    ds_read_b128 a[52:55], v25 offset:34816
    v_mfma_f32_16x16x32_bf16 v[168:171], v[192:195], a[8:11], 0
    buffer_load_dwordx4 v22, s[20:23], s69 offen offset:2048 lds
    v_mfma_f32_16x16x32_bf16 v[172:175], v[192:195], a[12:15], 0
    ds_read_b128 a[56:59], v25 offset:36864
    s_waitcnt lgkmcnt(9)
    v_mfma_f32_16x16x32_bf16 v[176:179], v[196:199], a[0:3], 0
    ds_read_b64_tr_b16 v[208:209], v11 offset:4096
    ds_read_b128 a[60:63], v25 offset:38912
    v_mfma_f32_16x16x32_bf16 v[180:183], v[196:199], a[4:7], 0
    ds_read_b64_tr_b16 v[210:211], v11 offset:4608
    buffer_load_dwordx4 v23, s[20:23], s69 offen offset:3072 lds
    v_mfma_f32_16x16x32_bf16 v[184:187], v[196:199], a[8:11], 0
    v_mfma_f32_16x16x32_bf16 v[188:191], v[196:199], a[12:15], 0
    s_add_u32 s19, s50, s75
    s_waitcnt lgkmcnt(9)
    v_mfma_f32_16x16x32_bf16 v[64:67], v[200:203], a[16:19], v[64:67]
    ds_read_b64_tr_b16 v[212:213], v12 offset:4096
    s_add_u32 m0, s53, 0
    v_mfma_f32_16x16x32_bf16 v[68:71], v[200:203], a[20:23], v[68:71]
    ds_read_b64_tr_b16 v[214:215], v12 offset:4608
    buffer_load_dwordx4 v16, s[20:23], s19 offen offset:0 lds
    v_mfma_f32_16x16x32_bf16 v[72:75], v[200:203], a[24:27], v[72:75]
    s_waitcnt lgkmcnt(3)
    v_mfma_f32_16x16x32_bf16 v[76:79], v[200:203], a[28:31], v[76:79]
    s_add_u32 s69, s50, s76
    v_mfma_f32_16x16x32_bf16 v[80:83], v[204:207], a[16:19], v[80:83]
    ds_read_b64_tr_b16 v[192:193], v9 offset:12288
    s_add_u32 m0, s53, 32768
    v_mfma_f32_16x16x32_bf16 v[84:87], v[204:207], a[20:23], v[84:87]
    ds_read_b64_tr_b16 v[194:195], v9 offset:12800
    s_add_u32 m0, s53, 0
    s_nop 0
    buffer_load_dwordx4 v17, s[20:23], s19 offen offset:1024 lds
    v_mfma_f32_16x16x32_bf16 v[88:91], v[204:207], a[24:27], v[88:91]
    v_mfma_f32_16x16x32_bf16 v[92:95], v[204:207], a[28:31], v[92:95]
    s_add_u32 m0, s53, 32768
    s_nop 0
    buffer_load_dwordx4 v16, s[20:23], s69 offen offset:0 lds
    s_waitcnt lgkmcnt(4)
    v_mfma_f32_16x16x32_bf16 v[96:99], v[208:211], a[16:19], v[96:99]
    ds_read_b64_tr_b16 v[196:197], v10 offset:12288
    v_mfma_f32_16x16x32_bf16 v[100:103], v[208:211], a[20:23], v[100:103]
    ds_read_b64_tr_b16 v[198:199], v10 offset:12800
    s_add_u32 m0, s53, 0
    s_nop 0
    buffer_load_dwordx4 v18, s[20:23], s19 offen offset:2048 lds
    v_mfma_f32_16x16x32_bf16 v[104:107], v[208:211], a[24:27], v[104:107]
    v_mfma_f32_16x16x32_bf16 v[108:111], v[208:211], a[28:31], v[108:111]
    s_add_u32 m0, s53, 32768
    s_nop 0
    buffer_load_dwordx4 v17, s[20:23], s69 offen offset:1024 lds
    s_waitcnt lgkmcnt(4)
    v_mfma_f32_16x16x32_bf16 v[112:115], v[212:215], a[16:19], v[112:115]
    ds_read_b64_tr_b16 v[200:201], v11 offset:12288
    v_mfma_f32_16x16x32_bf16 v[116:119], v[212:215], a[20:23], v[116:119]
    ds_read_b64_tr_b16 v[202:203], v11 offset:12800
    s_add_u32 m0, s53, 0
    s_nop 0
    buffer_load_dwordx4 v19, s[20:23], s19 offen offset:3072 lds
    v_mfma_f32_16x16x32_bf16 v[120:123], v[212:215], a[24:27], v[120:123]
    s_add_u32 m0, s53, 4096
    v_mfma_f32_16x16x32_bf16 v[124:127], v[212:215], a[28:31], v[124:127]
    s_add_u32 m0, s53, 32768
    s_nop 0
    buffer_load_dwordx4 v18, s[20:23], s69 offen offset:2048 lds
    s_waitcnt lgkmcnt(4)
    v_mfma_f32_16x16x32_bf16 v[128:131], v[192:195], a[16:19], v[128:131]
    ds_read_b64_tr_b16 v[204:205], v12 offset:12288
    v_mfma_f32_16x16x32_bf16 v[132:135], v[192:195], a[20:23], v[132:135]
    ds_read_b64_tr_b16 v[206:207], v12 offset:12800
    s_add_u32 m0, s53, 4096
    s_nop 0
    buffer_load_dwordx4 v20, s[20:23], s19 offen offset:0 lds
    v_mfma_f32_16x16x32_bf16 v[136:139], v[192:195], a[24:27], v[136:139]
    v_mfma_f32_16x16x32_bf16 v[140:143], v[192:195], a[28:31], v[140:143]
    s_add_u32 m0, s53, 32768
    s_nop 0
    buffer_load_dwordx4 v19, s[20:23], s69 offen offset:3072 lds
    s_waitcnt lgkmcnt(4)
    v_mfma_f32_16x16x32_bf16 v[144:147], v[196:199], a[16:19], v[144:147]
    s_waitcnt vmcnt(21)
    s_barrier
    v_add_u32 v9, 16384, v5
    v_add_u32 v10, 16384, v6
    v_add_u32 v11, 16384, v7
    v_add_u32 v12, 16384, v8
    ds_read_b64_tr_b16 v[208:209], v9 offset:0
    s_add_u32 m0, s53, 36864
    v_mfma_f32_16x16x32_bf16 v[148:151], v[196:199], a[20:23], v[148:151]
    ds_read_b64_tr_b16 v[210:211], v9 offset:512
    s_mul_i32 s51, s75, 4608
    s_add_u32 s51, s51, s48
    v_mfma_f32_16x16x32_bf16 v[152:155], v[196:199], a[24:27], v[152:155]
    s_add_u32 m0, s52, 49152
    v_mfma_f32_16x16x32_bf16 v[156:159], v[196:199], a[28:31], v[156:159]
    buffer_load_dwordx4 v1, s[24:27], s51 offen offset:0 lds
    s_waitcnt lgkmcnt(4)
    v_mfma_f32_16x16x32_bf16 v[160:163], v[200:203], a[16:19], v[160:163]
    ds_read_b64_tr_b16 v[212:213], v10 offset:0
    v_mfma_f32_16x16x32_bf16 v[164:167], v[200:203], a[20:23], v[164:167]
    ds_read_b64_tr_b16 v[214:215], v10 offset:512
    s_add_u32 m0, s53, 4096
    s_nop 0
    buffer_load_dwordx4 v21, s[20:23], s19 offen offset:1024 lds
    v_mfma_f32_16x16x32_bf16 v[168:171], v[200:203], a[24:27], v[168:171]
    v_mfma_f32_16x16x32_bf16 v[172:175], v[200:203], a[28:31], v[172:175]
    s_add_u32 m0, s53, 36864
    s_nop 0
    buffer_load_dwordx4 v20, s[20:23], s69 offen offset:0 lds
    s_waitcnt lgkmcnt(4)
    v_mfma_f32_16x16x32_bf16 v[176:179], v[204:207], a[16:19], v[176:179]
    ds_read_b64_tr_b16 v[192:193], v11 offset:0
    v_mfma_f32_16x16x32_bf16 v[180:183], v[204:207], a[20:23], v[180:183]
    ds_read_b64_tr_b16 v[194:195], v11 offset:512
    s_add_u32 m0, s53, 4096
    s_nop 0
    buffer_load_dwordx4 v22, s[20:23], s19 offen offset:2048 lds
    v_mfma_f32_16x16x32_bf16 v[184:187], v[204:207], a[24:27], v[184:187]
    v_mfma_f32_16x16x32_bf16 v[188:191], v[204:207], a[28:31], v[188:191]
    s_add_u32 m0, s53, 36864
    s_nop 0
    buffer_load_dwordx4 v21, s[20:23], s69 offen offset:1024 lds
    s_waitcnt lgkmcnt(4)
    v_mfma_f32_16x16x32_bf16 v[64:67], v[208:211], a[32:35], v[64:67]
    ds_read_b64_tr_b16 v[196:197], v12 offset:0
    v_mfma_f32_16x16x32_bf16 v[68:71], v[208:211], a[36:39], v[68:71]
    ds_read_b64_tr_b16 v[198:199], v12 offset:512
    s_add_u32 m0, s53, 4096
    s_nop 0
    buffer_load_dwordx4 v23, s[20:23], s19 offen offset:3072 lds
    v_mfma_f32_16x16x32_bf16 v[72:75], v[208:211], a[40:43], v[72:75]
    v_mfma_f32_16x16x32_bf16 v[76:79], v[208:211], a[44:47], v[76:79]
    s_add_u32 m0, s52, 49152
    s_nop 0
    buffer_load_dwordx4 v2, s[24:27], s51 offen offset:1024 lds
    s_waitcnt lgkmcnt(4)
    v_mfma_f32_16x16x32_bf16 v[80:83], v[212:215], a[32:35], v[80:83]
    ds_read_b64_tr_b16 v[200:201], v9 offset:8192
    v_mfma_f32_16x16x32_bf16 v[84:87], v[212:215], a[36:39], v[84:87]
    ds_read_b64_tr_b16 v[202:203], v9 offset:8704
    s_add_u32 m0, s53, 36864
    s_nop 0
    buffer_load_dwordx4 v22, s[20:23], s69 offen offset:2048 lds
    v_mfma_f32_16x16x32_bf16 v[88:91], v[212:215], a[40:43], v[88:91]
    s_mov_b32 s32, s16
    s_mov_b32 s33, s17
    v_mfma_f32_16x16x32_bf16 v[92:95], v[212:215], a[44:47], v[92:95]
    s_mov_b32 s34, 50331648
    s_waitcnt lgkmcnt(4)
    v_mfma_f32_16x16x32_bf16 v[96:99], v[192:195], a[32:35], v[96:99]
    ds_read_b64_tr_b16 v[204:205], v10 offset:8192
    s_mov_b32 s35, 0x00020000
    v_mfma_f32_16x16x32_bf16 v[100:103], v[192:195], a[36:39], v[100:103]
    ds_read_b64_tr_b16 v[206:207], v10 offset:8704
    buffer_load_dwordx4 v23, s[20:23], s69 offen offset:3072 lds
    v_mfma_f32_16x16x32_bf16 v[104:107], v[192:195], a[40:43], v[104:107]
    s_mov_b32 s28, s10
    s_mov_b32 s29, s11
    v_mfma_f32_16x16x32_bf16 v[108:111], v[192:195], a[44:47], v[108:111]
    s_mov_b32 s30, 5308416
    s_waitcnt lgkmcnt(4)
    v_mfma_f32_16x16x32_bf16 v[112:115], v[196:199], a[32:35], v[112:115]
    ds_read_b64_tr_b16 v[208:209], v11 offset:8192
    s_waitcnt vmcnt(18)
    v_mfma_f32_16x16x32_bf16 v[116:119], v[196:199], a[36:39], v[116:119]
    ds_read_b64_tr_b16 v[210:211], v11 offset:8704
    v_add_u32 v221, 65536, v24
    v_mfma_f32_16x16x32_bf16 v[120:123], v[196:199], a[40:43], v[120:123]
    v_add_u32 v222, 65536, v25
    s_mov_b32 s31, 0x00020000
    v_mfma_f32_16x16x32_bf16 v[124:127], v[196:199], a[44:47], v[124:127]
    s_add_u32 m0, s52, 49152
    s_nop 0
    buffer_load_dwordx4 v3, s[24:27], s51 offen offset:2048 lds
    s_waitcnt lgkmcnt(4)
    v_mfma_f32_16x16x32_bf16 v[128:131], v[200:203], a[32:35], v[128:131]
    ds_read_b64_tr_b16 v[212:213], v12 offset:8192
    ds_read_b128 a[64:67], v221 offset:0
    v_mfma_f32_16x16x32_bf16 v[132:135], v[200:203], a[36:39], v[132:135]
    ds_read_b64_tr_b16 v[214:215], v12 offset:8704
    ds_read_b128 a[68:71], v221 offset:2048
    v_mfma_f32_16x16x32_bf16 v[136:139], v[200:203], a[40:43], v[136:139]
    ds_read_b128 a[72:75], v221 offset:4096
    s_mov_b32 s36, s12
    v_mfma_f32_16x16x32_bf16 v[140:143], v[200:203], a[44:47], v[140:143]
    ds_read_b128 a[76:79], v221 offset:6144
    s_waitcnt lgkmcnt(8)
    v_mfma_f32_16x16x32_bf16 v[144:147], v[204:207], a[32:35], v[144:147]
    ds_read_b64_tr_b16 v[192:193], v9 offset:4096
    ds_read_b128 a[80:83], v222 offset:0
    v_mfma_f32_16x16x32_bf16 v[148:151], v[204:207], a[36:39], v[148:151]
    ds_read_b64_tr_b16 v[194:195], v9 offset:4608
    ds_read_b128 a[84:87], v222 offset:2048
    v_mfma_f32_16x16x32_bf16 v[152:155], v[204:207], a[40:43], v[152:155]
    ds_read_b128 a[88:91], v222 offset:4096
    s_mov_b32 s37, s13
    v_mfma_f32_16x16x32_bf16 v[156:159], v[204:207], a[44:47], v[156:159]
    ds_read_b128 a[92:95], v222 offset:6144
    s_waitcnt lgkmcnt(12)
    v_mfma_f32_16x16x32_bf16 v[160:163], v[208:211], a[32:35], v[160:163]
    ds_read_b64_tr_b16 v[196:197], v10 offset:4096
    s_mov_b32 s38, 2359296
    v_mfma_f32_16x16x32_bf16 v[164:167], v[208:211], a[36:39], v[164:167]
    ds_read_b64_tr_b16 v[198:199], v10 offset:4608
    s_mov_b32 s39, 0x00020000
    v_mfma_f32_16x16x32_bf16 v[168:171], v[208:211], a[40:43], v[168:171]
    s_lshl_b32 s70, s45, 7
    s_add_u32 s70, s70, 37879808
    buffer_load_dword v0, off, s[32:35], s70 sc1
    s_lshl_b32 s59, s44, 10
    v_mfma_f32_16x16x32_bf16 v[172:175], v[208:211], a[44:47], v[172:175]
    buffer_load_dwordx4 v4, s[24:27], s51 offen offset:3072 lds
    s_waitcnt lgkmcnt(11)
    v_mfma_f32_16x16x32_bf16 v[176:179], v[212:215], a[32:35], v[176:179]
    ds_read_b64_tr_b16 v[200:201], v11 offset:4096
    s_waitcnt lgkmcnt(3)
    v_mfma_f32_16x16x32_bf16 v[180:183], v[212:215], a[36:39], v[180:183]
    ds_read_b64_tr_b16 v[202:203], v11 offset:4608
    s_add_u32 s19, s50, s77
    v_mfma_f32_16x16x32_bf16 v[184:187], v[212:215], a[40:43], v[184:187]
    s_add_u32 m0, s53, 65536
    s_and_b32 s83, s44, 1
    v_mfma_f32_16x16x32_bf16 v[188:191], v[212:215], a[44:47], v[188:191]
    buffer_load_dwordx4 v16, s[20:23], s19 offen offset:0 lds
    v_mfma_f32_16x16x32_bf16 v[64:67], v[192:195], a[48:51], v[64:67]
    ds_read_b64_tr_b16 v[204:205], v12 offset:4096
    s_lshr_b32 s70, s44, 1
    v_mfma_f32_16x16x32_bf16 v[68:71], v[192:195], a[52:55], v[68:71]
    ds_read_b64_tr_b16 v[206:207], v12 offset:4608
    s_lshl_b32 s57, s70, 10
    v_mfma_f32_16x16x32_bf16 v[72:75], v[192:195], a[56:59], v[72:75]
    s_lshl_b32 s71, s83, 11
    s_add_u32 s55, s57, s71
    v_mfma_f32_16x16x32_bf16 v[76:79], v[192:195], a[60:63], v[76:79]
    buffer_load_dwordx4 v17, s[20:23], s19 offen offset:1024 lds
    s_waitcnt lgkmcnt(4)
    v_mfma_f32_16x16x32_bf16 v[80:83], v[196:199], a[48:51], v[80:83]
    ds_read_b64_tr_b16 v[208:209], v9 offset:12288
    s_mul_i32 s71, s83, 294912
    v_mfma_f32_16x16x32_bf16 v[84:87], v[196:199], a[52:55], v[84:87]
    ds_read_b64_tr_b16 v[210:211], v9 offset:12800
    s_add_u32 s56, s49, s71
    v_mfma_f32_16x16x32_bf16 v[88:91], v[196:199], a[56:59], v[88:91]
    s_add_u32 s60, s83, 16
    s_lshl_b32 s60, s60, 10
    v_mfma_f32_16x16x32_bf16 v[92:95], v[196:199], a[60:63], v[92:95]
    buffer_load_dwordx4 v18, s[20:23], s19 offen offset:2048 lds
    s_waitcnt lgkmcnt(4)
    v_mfma_f32_16x16x32_bf16 v[96:99], v[200:203], a[48:51], v[96:99]
    ds_read_b64_tr_b16 v[212:213], v10 offset:12288
    s_mul_i32 s58, s46, 663552
    v_mfma_f32_16x16x32_bf16 v[100:103], v[200:203], a[52:55], v[100:103]
    ds_read_b64_tr_b16 v[214:215], v10 offset:12800
    s_mul_i32 s83, s47, 288
    v_mfma_f32_16x16x32_bf16 v[104:107], v[200:203], a[56:59], v[104:107]
    s_add_u32 s58, s58, s83
    s_lshl_b32 s83, s45, 3
    v_mfma_f32_16x16x32_bf16 v[108:111], v[200:203], a[60:63], v[108:111]
    buffer_load_dwordx4 v19, s[20:23], s19 offen offset:3072 lds
    s_waitcnt lgkmcnt(4)
    v_mfma_f32_16x16x32_bf16 v[112:115], v[204:207], a[48:51], v[112:115]
    ds_read_b64_tr_b16 v[192:193], v11 offset:12288
    s_add_u32 m0, s53, 69632
    v_mfma_f32_16x16x32_bf16 v[116:119], v[204:207], a[52:55], v[116:119]
    ds_read_b64_tr_b16 v[194:195], v11 offset:12800
    s_add_u32 s83, s83, s46
    v_mfma_f32_16x16x32_bf16 v[120:123], v[204:207], a[56:59], v[120:123]
    s_lshl_b32 s61, s83, 18
    s_lshl_b32 s70, s44, 13
    v_mfma_f32_16x16x32_bf16 v[124:127], v[204:207], a[60:63], v[124:127]
    buffer_load_dwordx4 v20, s[20:23], s19 offen offset:0 lds
    s_waitcnt lgkmcnt(4)
    v_mfma_f32_16x16x32_bf16 v[128:131], v[208:211], a[48:51], v[128:131]
    ds_read_b64_tr_b16 v[196:197], v12 offset:12288
    s_add_u32 s61, s61, s70
    v_mfma_f32_16x16x32_bf16 v[132:135], v[208:211], a[52:55], v[132:135]
    ds_read_b64_tr_b16 v[198:199], v12 offset:12800
    s_lshl_b32 s70, s47, 16
    v_mfma_f32_16x16x32_bf16 v[136:139], v[208:211], a[56:59], v[136:139]
    s_add_u32 s54, s61, s70
    s_lshl_b32 s63, s83, 15
    v_mfma_f32_16x16x32_bf16 v[140:143], v[208:211], a[60:63], v[140:143]
    buffer_load_dwordx4 v21, s[20:23], s19 offen offset:1024 lds
    s_waitcnt lgkmcnt(4)
    v_mfma_f32_16x16x32_bf16 v[144:147], v[212:215], a[48:51], v[144:147]
    s_barrier
    v_add_u32 v9, 32768, v5
    v_add_u32 v10, 32768, v6
    v_add_u32 v11, 32768, v7
    v_add_u32 v12, 32768, v8
    ds_read_b64_tr_b16 v[200:201], v9 offset:0
    s_lshl_b32 s70, s44, 11
    v_mfma_f32_16x16x32_bf16 v[148:151], v[212:215], a[52:55], v[148:151]
    ds_read_b64_tr_b16 v[202:203], v9 offset:512
    s_mul_i32 s51, s76, 4608
    s_add_u32 s51, s51, s48
    v_mfma_f32_16x16x32_bf16 v[152:155], v[212:215], a[56:59], v[152:155]
    s_add_u32 m0, s52, 0
    s_add_u32 s63, s63, s70
    v_mfma_f32_16x16x32_bf16 v[156:159], v[212:215], a[60:63], v[156:159]
    buffer_load_dwordx4 v1, s[24:27], s51 offen offset:0 lds
    s_waitcnt lgkmcnt(4)
    v_mfma_f32_16x16x32_bf16 v[160:163], v[192:195], a[48:51], v[160:163]
    ds_read_b64_tr_b16 v[204:205], v10 offset:0
    s_add_u32 s63, s63, 16777216
    v_mfma_f32_16x16x32_bf16 v[164:167], v[192:195], a[52:55], v[164:167]
    ds_read_b64_tr_b16 v[206:207], v10 offset:512
    s_add_u32 m0, s53, 69632
    s_nop 0
    buffer_load_dwordx4 v22, s[20:23], s19 offen offset:2048 lds
    v_mfma_f32_16x16x32_bf16 v[168:171], v[192:195], a[56:59], v[168:171]
    s_lshl_b32 s70, s47, 13
    s_add_u32 s62, s63, s70
    v_mfma_f32_16x16x32_bf16 v[172:175], v[192:195], a[60:63], v[172:175]
    s_lshl_b32 s68, s83, 7
    s_waitcnt lgkmcnt(4)
    v_mfma_f32_16x16x32_bf16 v[176:179], v[196:199], a[48:51], v[176:179]
    ds_read_b64_tr_b16 v[208:209], v11 offset:0
    s_add_u32 s68, s68, 37748736
    v_mfma_f32_16x16x32_bf16 v[180:183], v[196:199], a[52:55], v[180:183]
    ds_read_b64_tr_b16 v[210:211], v11 offset:512
    buffer_load_dwordx4 v23, s[20:23], s19 offen offset:3072 lds
    v_mfma_f32_16x16x32_bf16 v[184:187], v[196:199], a[56:59], v[184:187]
    s_lshl_b32 s70, s45, 2
    s_add_u32 s70, s70, s47
    v_mfma_f32_16x16x32_bf16 v[188:191], v[196:199], a[60:63], v[188:191]
    s_lshl_b32 s70, s70, 3
    s_waitcnt lgkmcnt(4)
    v_mfma_f32_16x16x32_bf16 v[64:67], v[200:203], a[64:67], v[64:67]
    ds_read_b64_tr_b16 v[212:213], v12 offset:0
    s_lshl_b32 s71, s44, 1
    v_mfma_f32_16x16x32_bf16 v[68:71], v[200:203], a[68:71], v[68:71]
    ds_read_b64_tr_b16 v[214:215], v12 offset:512
    s_add_u32 s70, s70, s71
    v_mfma_f32_16x16x32_bf16 v[72:75], v[200:203], a[72:75], v[72:75]
    s_lshl_b32 s70, s70, 3
    s_add_u32 s70, s70, s46
    v_mfma_f32_16x16x32_bf16 v[76:79], v[200:203], a[76:79], v[76:79]
    s_add_u32 m0, s52, 0
    s_nop 0
    buffer_load_dwordx4 v2, s[24:27], s51 offen offset:1024 lds
    s_waitcnt lgkmcnt(4)
    v_mfma_f32_16x16x32_bf16 v[80:83], v[204:207], a[64:67], v[80:83]
    ds_read_b64_tr_b16 v[192:193], v9 offset:8192
    s_mul_i32 s64, s70, 9216
    v_mfma_f32_16x16x32_bf16 v[84:87], v[204:207], a[68:71], v[84:87]
    ds_read_b64_tr_b16 v[194:195], v9 offset:8704
    s_add_u32 s64, s64, 18874368
    v_mfma_f32_16x16x32_bf16 v[88:91], v[204:207], a[72:75], v[88:91]
    s_add_u32 s83, s47, 0
    s_and_b32 s83, s83, 3
    v_mfma_f32_16x16x32_bf16 v[92:95], v[204:207], a[76:79], v[92:95]
    s_lshl_b32 s4, s83, 16
    s_waitcnt lgkmcnt(4)
    v_mfma_f32_16x16x32_bf16 v[96:99], v[208:211], a[64:67], v[96:99]
    ds_read_b64_tr_b16 v[196:197], v10 offset:8192
    s_add_u32 s4, s4, 32768
    v_mfma_f32_16x16x32_bf16 v[100:103], v[208:211], a[68:71], v[100:103]
    ds_read_b64_tr_b16 v[198:199], v10 offset:8704
    s_mul_i32 s8, s83, 147456
    v_mfma_f32_16x16x32_bf16 v[104:107], v[208:211], a[72:75], v[104:107]
    s_add_u32 s8, s8, 73728
    s_add_u32 s83, s47, 1
    v_mfma_f32_16x16x32_bf16 v[108:111], v[208:211], a[76:79], v[108:111]
    s_and_b32 s83, s83, 3
    s_waitcnt lgkmcnt(4)
    v_mfma_f32_16x16x32_bf16 v[112:115], v[212:215], a[64:67], v[112:115]
    ds_read_b64_tr_b16 v[200:201], v11 offset:8192
    s_waitcnt vmcnt(16)
    v_mfma_f32_16x16x32_bf16 v[116:119], v[212:215], a[68:71], v[116:119]
    ds_read_b64_tr_b16 v[202:203], v11 offset:8704
    ds_read_b128 a[96:99], v24 offset:0
    v_mfma_f32_16x16x32_bf16 v[120:123], v[212:215], a[72:75], v[120:123]
    ds_read_b128 a[100:103], v24 offset:2048
    s_lshl_b32 s5, s83, 16
    v_mfma_f32_16x16x32_bf16 v[124:127], v[212:215], a[76:79], v[124:127]
    buffer_load_dwordx4 v3, s[24:27], s51 offen offset:2048 lds
    s_waitcnt lgkmcnt(6)
    v_mfma_f32_16x16x32_bf16 v[128:131], v[192:195], a[64:67], v[128:131]
    ds_read_b64_tr_b16 v[204:205], v12 offset:8192
    ds_read_b128 a[104:107], v24 offset:4096
    v_mfma_f32_16x16x32_bf16 v[132:135], v[192:195], a[68:71], v[132:135]
    ds_read_b64_tr_b16 v[206:207], v12 offset:8704
    ds_read_b128 a[108:111], v24 offset:6144
    v_mfma_f32_16x16x32_bf16 v[136:139], v[192:195], a[72:75], v[136:139]
    ds_read_b128 a[112:115], v25 offset:0
    s_add_u32 s5, s5, 32768
    v_mfma_f32_16x16x32_bf16 v[140:143], v[192:195], a[76:79], v[140:143]
    ds_read_b128 a[116:119], v25 offset:2048
    s_waitcnt lgkmcnt(10)
    v_mfma_f32_16x16x32_bf16 v[144:147], v[196:199], a[64:67], v[144:147]
    ds_read_b64_tr_b16 v[208:209], v9 offset:4096
    ds_read_b128 a[120:123], v25 offset:4096
    v_mfma_f32_16x16x32_bf16 v[148:151], v[196:199], a[68:71], v[148:151]
    ds_read_b64_tr_b16 v[210:211], v9 offset:4608
    ds_read_b128 a[124:127], v25 offset:6144
    v_mfma_f32_16x16x32_bf16 v[152:155], v[196:199], a[72:75], v[152:155]
    s_mul_i32 s9, s83, 147456
    s_add_u32 s9, s9, 73728
    v_mfma_f32_16x16x32_bf16 v[156:159], v[196:199], a[76:79], v[156:159]
    s_add_u32 s83, s47, 2
    s_waitcnt lgkmcnt(12)
    v_mfma_f32_16x16x32_bf16 v[160:163], v[200:203], a[64:67], v[160:163]
    ds_read_b64_tr_b16 v[212:213], v10 offset:4096
    s_and_b32 s83, s83, 3
    v_mfma_f32_16x16x32_bf16 v[164:167], v[200:203], a[68:71], v[164:167]
    ds_read_b64_tr_b16 v[214:215], v10 offset:4608
    s_lshl_b32 s6, s83, 16
    v_mfma_f32_16x16x32_bf16 v[168:171], v[200:203], a[72:75], v[168:171]
    s_add_u32 s6, s6, 32768
    s_mul_i32 s10, s83, 147456
    v_mfma_f32_16x16x32_bf16 v[172:175], v[200:203], a[76:79], v[172:175]
    buffer_load_dwordx4 v4, s[24:27], s51 offen offset:3072 lds
    s_waitcnt lgkmcnt(9)
    v_mfma_f32_16x16x32_bf16 v[176:179], v[204:207], a[64:67], v[176:179]
    ds_read_b64_tr_b16 v[192:193], v11 offset:4096
    s_waitcnt lgkmcnt(3)
    v_mfma_f32_16x16x32_bf16 v[180:183], v[204:207], a[68:71], v[180:183]
    ds_read_b64_tr_b16 v[194:195], v11 offset:4608
    s_add_u32 s69, s50, s78
    v_mfma_f32_16x16x32_bf16 v[184:187], v[204:207], a[72:75], v[184:187]
    s_add_u32 m0, s53, 0
    s_add_u32 s10, s10, 73728
    v_mfma_f32_16x16x32_bf16 v[188:191], v[204:207], a[76:79], v[188:191]
    buffer_load_dwordx4 v16, s[20:23], s69 offen offset:0 lds
    v_mfma_f32_16x16x32_bf16 v[64:67], v[208:211], a[80:83], v[64:67]
    ds_read_b64_tr_b16 v[196:197], v12 offset:4096
    s_add_u32 s83, s47, 3
    v_mfma_f32_16x16x32_bf16 v[68:71], v[208:211], a[84:87], v[68:71]
    ds_read_b64_tr_b16 v[198:199], v12 offset:4608
    s_and_b32 s83, s83, 3
    v_mfma_f32_16x16x32_bf16 v[72:75], v[208:211], a[88:91], v[72:75]
    s_lshl_b32 s7, s83, 16
    s_add_u32 s7, s7, 32768
    v_mfma_f32_16x16x32_bf16 v[76:79], v[208:211], a[92:95], v[76:79]
    buffer_load_dwordx4 v17, s[20:23], s69 offen offset:1024 lds
    s_waitcnt lgkmcnt(4)
    v_mfma_f32_16x16x32_bf16 v[80:83], v[212:215], a[80:83], v[80:83]
    ds_read_b64_tr_b16 v[200:201], v9 offset:12288
    s_mul_i32 s11, s83, 147456
    v_mfma_f32_16x16x32_bf16 v[84:87], v[212:215], a[84:87], v[84:87]
    ds_read_b64_tr_b16 v[202:203], v9 offset:12800
    s_add_u32 s11, s11, 73728
    v_mfma_f32_16x16x32_bf16 v[88:91], v[212:215], a[88:91], v[88:91]
    v_and_b32 v233, 1, v240
    v_lshl_add_u32 v233, v233, 2, v241
    v_mfma_f32_16x16x32_bf16 v[92:95], v[212:215], a[92:95], v[92:95]
    buffer_load_dwordx4 v18, s[20:23], s69 offen offset:2048 lds
    s_waitcnt lgkmcnt(4)
    v_mfma_f32_16x16x32_bf16 v[96:99], v[192:195], a[80:83], v[96:99]
    ds_read_b64_tr_b16 v[204:205], v10 offset:12288
    v_lshrrev_b32 v234, 1, v240
    v_mfma_f32_16x16x32_bf16 v[100:103], v[192:195], a[84:87], v[100:103]
    ds_read_b64_tr_b16 v[206:207], v10 offset:12800
    v_lshl_add_u32 v233, v234, 4, v233
    v_mfma_f32_16x16x32_bf16 v[104:107], v[192:195], a[88:91], v[104:107]
    v_lshlrev_b32 v233, 5, v233
    v_lshl_add_u32 v13, v242, 3, v233
    v_mfma_f32_16x16x32_bf16 v[108:111], v[192:195], a[92:95], v[108:111]
    buffer_load_dwordx4 v19, s[20:23], s69 offen offset:3072 lds
    s_waitcnt lgkmcnt(4)
    v_mfma_f32_16x16x32_bf16 v[112:115], v[196:199], a[80:83], v[112:115]
    ds_read_b64_tr_b16 v[208:209], v11 offset:12288
    s_add_u32 m0, s53, 4096
    v_mfma_f32_16x16x32_bf16 v[116:119], v[196:199], a[84:87], v[116:119]
    ds_read_b64_tr_b16 v[210:211], v11 offset:12800
    s_mov_b32 s70, 9216
    v_mfma_f32_16x16x32_bf16 v[120:123], v[196:199], a[88:91], v[120:123]
    v_lshrrev_b32 v233, 1, v232
    v_and_b32 v234, 19, v233
    v_mfma_f32_16x16x32_bf16 v[124:127], v[196:199], a[92:95], v[124:127]
    buffer_load_dwordx4 v20, s[20:23], s69 offen offset:0 lds
    s_waitcnt lgkmcnt(4)
    v_mfma_f32_16x16x32_bf16 v[128:131], v[200:203], a[80:83], v[128:131]
    ds_read_b64_tr_b16 v[212:213], v12 offset:12288
    v_bfe_u32 v235, v233, 3, 1
    v_mfma_f32_16x16x32_bf16 v[132:135], v[200:203], a[84:87], v[132:135]
    ds_read_b64_tr_b16 v[214:215], v12 offset:12800
    v_lshl_or_b32 v234, v235, 2, v234
    v_mfma_f32_16x16x32_bf16 v[136:139], v[200:203], a[88:91], v[136:139]
    v_bfe_u32 v235, v233, 2, 1
    v_lshl_or_b32 v234, v235, 3, v234
    v_mfma_f32_16x16x32_bf16 v[140:143], v[200:203], a[92:95], v[140:143]
    buffer_load_dwordx4 v21, s[20:23], s69 offen offset:1024 lds
    s_waitcnt lgkmcnt(4)
    v_mfma_f32_16x16x32_bf16 v[144:147], v[204:207], a[80:83], v[144:147]
    s_waitcnt vmcnt(18)
    s_barrier
    v_add_u32 v9, 49152, v5
    v_add_u32 v10, 49152, v6
    v_add_u32 v11, 49152, v7
    v_add_u32 v12, 49152, v8
    ds_read_b64_tr_b16 v[192:193], v9 offset:0
    v_mul_lo_u32 v234, v234, s70
    v_mfma_f32_16x16x32_bf16 v[148:151], v[204:207], a[84:87], v[148:151]
    ds_read_b64_tr_b16 v[194:195], v9 offset:512
    s_mul_i32 s51, s77, 4608
    s_add_u32 s51, s51, s48
    v_mfma_f32_16x16x32_bf16 v[152:155], v[204:207], a[88:91], v[152:155]
    s_add_u32 m0, s52, 16384
    v_and_b32 v235, 1, v232
    v_mfma_f32_16x16x32_bf16 v[156:159], v[204:207], a[92:95], v[156:159]
    buffer_load_dwordx4 v1, s[24:27], s51 offen offset:0 lds
    s_waitcnt lgkmcnt(4)
    v_mfma_f32_16x16x32_bf16 v[160:163], v[208:211], a[80:83], v[160:163]
    ds_read_b64_tr_b16 v[196:197], v10 offset:0
    v_lshl_add_u32 v26, v235, 4, v234
    v_mfma_f32_16x16x32_bf16 v[164:167], v[208:211], a[84:87], v[164:167]
    ds_read_b64_tr_b16 v[198:199], v10 offset:512
    s_add_u32 m0, s53, 4096
    s_nop 0
    buffer_load_dwordx4 v22, s[20:23], s69 offen offset:2048 lds
    v_mfma_f32_16x16x32_bf16 v[168:171], v[208:211], a[88:91], v[168:171]
    v_lshl_add_u32 v233, v240, 2, v241
    v_mul_u32_u24 v233, 288, v233
    v_mfma_f32_16x16x32_bf16 v[172:175], v[208:211], a[92:95], v[172:175]
    v_lshl_add_u32 v14, v242, 3, v233
    s_waitcnt lgkmcnt(4)
    v_mfma_f32_16x16x32_bf16 v[176:179], v[212:215], a[80:83], v[176:179]
    ds_read_b64_tr_b16 v[200:201], v11 offset:0
    s_lshl_b32 s83, s44, 6
    v_mfma_f32_16x16x32_bf16 v[180:183], v[212:215], a[84:87], v[180:183]
    ds_read_b64_tr_b16 v[202:203], v11 offset:512
    buffer_load_dwordx4 v23, s[20:23], s69 offen offset:3072 lds
    v_mfma_f32_16x16x32_bf16 v[184:187], v[212:215], a[88:91], v[184:187]
    s_add_u32 s83, s83, 0
    v_add_u32 v233, s83, v232
    v_mfma_f32_16x16x32_bf16 v[188:191], v[212:215], a[92:95], v[188:191]
    v_mul_u32_u24 v234, 3641, v233
    s_waitcnt lgkmcnt(4)
    v_mfma_f32_16x16x32_bf16 v[64:67], v[192:195], a[96:99], v[64:67]
    ds_read_b64_tr_b16 v[204:205], v12 offset:0
    v_lshrrev_b32 v234, 16, v234
    v_mfma_f32_16x16x32_bf16 v[68:71], v[192:195], a[100:103], v[68:71]
    ds_read_b64_tr_b16 v[206:207], v12 offset:512
    v_mul_u32_u24 v235, 18, v234
    v_mfma_f32_16x16x32_bf16 v[72:75], v[192:195], a[104:107], v[72:75]
    v_sub_u32 v235, v233, v235
    v_mul_u32_u24 v234, 1152, v234
    v_mfma_f32_16x16x32_bf16 v[76:79], v[192:195], a[108:111], v[76:79]
    s_add_u32 m0, s52, 16384
    s_nop 0
    buffer_load_dwordx4 v2, s[24:27], s51 offen offset:1024 lds
    s_waitcnt lgkmcnt(4)
    v_mfma_f32_16x16x32_bf16 v[80:83], v[196:199], a[96:99], v[80:83]
    ds_read_b64_tr_b16 v[208:209], v9 offset:8192
    v_lshl_add_u32 v27, v235, 4, v234
    v_mfma_f32_16x16x32_bf16 v[84:87], v[196:199], a[100:103], v[84:87]
    ds_read_b64_tr_b16 v[210:211], v9 offset:8704
    s_lshl_b32 s83, s44, 6
    v_mfma_f32_16x16x32_bf16 v[88:91], v[196:199], a[104:107], v[88:91]
    s_add_u32 s83, s83, 256
    v_add_u32 v233, s83, v232
    v_mfma_f32_16x16x32_bf16 v[92:95], v[196:199], a[108:111], v[92:95]
    v_mul_u32_u24 v234, 3641, v233
    s_waitcnt lgkmcnt(4)
    v_mfma_f32_16x16x32_bf16 v[96:99], v[200:203], a[96:99], v[96:99]
    ds_read_b64_tr_b16 v[212:213], v10 offset:8192
    v_lshrrev_b32 v234, 16, v234
    v_mfma_f32_16x16x32_bf16 v[100:103], v[200:203], a[100:103], v[100:103]
    ds_read_b64_tr_b16 v[214:215], v10 offset:8704
    v_mul_u32_u24 v235, 18, v234
    v_mfma_f32_16x16x32_bf16 v[104:107], v[200:203], a[104:107], v[104:107]
    v_sub_u32 v235, v233, v235
    v_mul_u32_u24 v234, 1152, v234
    v_mfma_f32_16x16x32_bf16 v[108:111], v[200:203], a[108:111], v[108:111]
    v_lshl_add_u32 v28, v235, 4, v234
    s_waitcnt lgkmcnt(4)
    v_mfma_f32_16x16x32_bf16 v[112:115], v[204:207], a[96:99], v[112:115]
    ds_read_b64_tr_b16 v[192:193], v11 offset:8192
    v_mfma_f32_16x16x32_bf16 v[116:119], v[204:207], a[100:103], v[116:119]
    ds_read_b64_tr_b16 v[194:195], v11 offset:8704
    ds_read_b128 a[128:131], v24 offset:32768
    v_mfma_f32_16x16x32_bf16 v[120:123], v[204:207], a[104:107], v[120:123]
    ds_read_b128 a[132:135], v24 offset:34816
    s_lshl_b32 s83, s44, 6
    v_mfma_f32_16x16x32_bf16 v[124:127], v[204:207], a[108:111], v[124:127]
    buffer_load_dwordx4 v3, s[24:27], s51 offen offset:2048 lds
    s_waitcnt lgkmcnt(6)
    v_mfma_f32_16x16x32_bf16 v[128:131], v[208:211], a[96:99], v[128:131]
    ds_read_b64_tr_b16 v[196:197], v12 offset:8192
    ds_read_b128 a[136:139], v24 offset:36864
    v_mfma_f32_16x16x32_bf16 v[132:135], v[208:211], a[100:103], v[132:135]
    ds_read_b64_tr_b16 v[198:199], v12 offset:8704
    ds_read_b128 a[140:143], v24 offset:38912
    v_mfma_f32_16x16x32_bf16 v[136:139], v[208:211], a[104:107], v[136:139]
    ds_read_b128 a[144:147], v25 offset:32768
    s_add_u32 s83, s83, 512
    v_mfma_f32_16x16x32_bf16 v[140:143], v[208:211], a[108:111], v[140:143]
    ds_read_b128 a[148:151], v25 offset:34816
    s_waitcnt lgkmcnt(10)
    v_mfma_f32_16x16x32_bf16 v[144:147], v[212:215], a[96:99], v[144:147]
    ds_read_b64_tr_b16 v[200:201], v9 offset:4096
    ds_read_b128 a[152:155], v25 offset:36864
    v_mfma_f32_16x16x32_bf16 v[148:151], v[212:215], a[100:103], v[148:151]
    ds_read_b64_tr_b16 v[202:203], v9 offset:4608
    ds_read_b128 a[156:159], v25 offset:38912
    v_mfma_f32_16x16x32_bf16 v[152:155], v[212:215], a[104:107], v[152:155]
    v_add_u32 v233, s83, v232
    v_mul_u32_u24 v234, 3641, v233
    v_mfma_f32_16x16x32_bf16 v[156:159], v[212:215], a[108:111], v[156:159]
    v_lshrrev_b32 v234, 16, v234
    s_waitcnt lgkmcnt(12)
    v_mfma_f32_16x16x32_bf16 v[160:163], v[192:195], a[96:99], v[160:163]
    ds_read_b64_tr_b16 v[204:205], v10 offset:4096
    v_mul_u32_u24 v235, 18, v234
    v_mfma_f32_16x16x32_bf16 v[164:167], v[192:195], a[100:103], v[164:167]
    ds_read_b64_tr_b16 v[206:207], v10 offset:4608
    v_sub_u32 v235, v233, v235
    v_mfma_f32_16x16x32_bf16 v[168:171], v[192:195], a[104:107], v[168:171]
    v_mul_u32_u24 v234, 1152, v234
    v_lshl_add_u32 v29, v235, 4, v234
    v_mfma_f32_16x16x32_bf16 v[172:175], v[192:195], a[108:111], v[172:175]
    buffer_load_dwordx4 v4, s[24:27], s51 offen offset:3072 lds
    s_waitcnt lgkmcnt(9)
    v_mfma_f32_16x16x32_bf16 v[176:179], v[196:199], a[96:99], v[176:179]
    ds_read_b64_tr_b16 v[208:209], v11 offset:4096
    s_waitcnt lgkmcnt(3)
    v_mfma_f32_16x16x32_bf16 v[180:183], v[196:199], a[100:103], v[180:183]
    ds_read_b64_tr_b16 v[210:211], v11 offset:4608
    s_add_u32 s19, s50, s79
    v_mfma_f32_16x16x32_bf16 v[184:187], v[196:199], a[104:107], v[184:187]
    s_add_u32 m0, s53, 32768
    s_lshl_b32 s83, s44, 6
    v_mfma_f32_16x16x32_bf16 v[188:191], v[196:199], a[108:111], v[188:191]
    buffer_load_dwordx4 v16, s[20:23], s19 offen offset:0 lds
    v_mfma_f32_16x16x32_bf16 v[64:67], v[200:203], a[112:115], v[64:67]
    ds_read_b64_tr_b16 v[212:213], v12 offset:4096
    s_add_u32 s83, s83, 768
    v_mfma_f32_16x16x32_bf16 v[68:71], v[200:203], a[116:119], v[68:71]
    ds_read_b64_tr_b16 v[214:215], v12 offset:4608
    v_add_u32 v233, s83, v232
    v_mfma_f32_16x16x32_bf16 v[72:75], v[200:203], a[120:123], v[72:75]
    v_mul_u32_u24 v234, 3641, v233
    v_lshrrev_b32 v234, 16, v234
    v_mfma_f32_16x16x32_bf16 v[76:79], v[200:203], a[124:127], v[76:79]
    buffer_load_dwordx4 v17, s[20:23], s19 offen offset:1024 lds
    s_waitcnt lgkmcnt(4)
    v_mfma_f32_16x16x32_bf16 v[80:83], v[204:207], a[112:115], v[80:83]
    ds_read_b64_tr_b16 v[192:193], v9 offset:12288
    v_mul_u32_u24 v235, 18, v234
    v_mfma_f32_16x16x32_bf16 v[84:87], v[204:207], a[116:119], v[84:87]
    ds_read_b64_tr_b16 v[194:195], v9 offset:12800
    v_sub_u32 v235, v233, v235
    v_mfma_f32_16x16x32_bf16 v[88:91], v[204:207], a[120:123], v[88:91]
    v_mul_u32_u24 v234, 1152, v234
    v_lshl_add_u32 v30, v235, 4, v234
    v_mfma_f32_16x16x32_bf16 v[92:95], v[204:207], a[124:127], v[92:95]
    buffer_load_dwordx4 v18, s[20:23], s19 offen offset:2048 lds
    s_waitcnt lgkmcnt(4)
    v_mfma_f32_16x16x32_bf16 v[96:99], v[208:211], a[112:115], v[96:99]
    ds_read_b64_tr_b16 v[196:197], v10 offset:12288
    s_lshr_b32 s83, s60, 4
    v_mfma_f32_16x16x32_bf16 v[100:103], v[208:211], a[116:119], v[100:103]
    ds_read_b64_tr_b16 v[198:199], v10 offset:12800
    v_add_u32 v233, s83, v232
    v_mfma_f32_16x16x32_bf16 v[104:107], v[208:211], a[120:123], v[104:107]
    v_mul_u32_u24 v234, 3641, v233
    v_lshrrev_b32 v234, 16, v234
    v_mfma_f32_16x16x32_bf16 v[108:111], v[208:211], a[124:127], v[108:111]
    buffer_load_dwordx4 v19, s[20:23], s19 offen offset:3072 lds
    s_waitcnt lgkmcnt(4)
    v_mfma_f32_16x16x32_bf16 v[112:115], v[212:215], a[112:115], v[112:115]
    ds_read_b64_tr_b16 v[200:201], v11 offset:12288
    s_add_u32 m0, s53, 36864
    v_mfma_f32_16x16x32_bf16 v[116:119], v[212:215], a[116:119], v[116:119]
    ds_read_b64_tr_b16 v[202:203], v11 offset:12800
    v_mul_u32_u24 v235, 18, v234
    v_mfma_f32_16x16x32_bf16 v[120:123], v[212:215], a[120:123], v[120:123]
    v_sub_u32 v235, v233, v235
    v_mul_u32_u24 v234, 1152, v234
    v_mfma_f32_16x16x32_bf16 v[124:127], v[212:215], a[124:127], v[124:127]
    buffer_load_dwordx4 v20, s[20:23], s19 offen offset:0 lds
    s_waitcnt lgkmcnt(4)
    v_mfma_f32_16x16x32_bf16 v[128:131], v[192:195], a[112:115], v[128:131]
    ds_read_b64_tr_b16 v[204:205], v12 offset:12288
    v_lshl_add_u32 v31, v235, 4, v234
    v_mfma_f32_16x16x32_bf16 v[132:135], v[192:195], a[116:119], v[132:135]
    ds_read_b64_tr_b16 v[206:207], v12 offset:12800
    s_lshl_b32 s70, s45, 2
    v_mfma_f32_16x16x32_bf16 v[136:139], v[192:195], a[120:123], v[136:139]
    s_add_u32 s70, s70, s47
    s_lshl_b32 s71, s70, 1
    v_mfma_f32_16x16x32_bf16 v[140:143], v[192:195], a[124:127], v[140:143]
    buffer_load_dwordx4 v21, s[20:23], s19 offen offset:1024 lds
    s_waitcnt lgkmcnt(4)
    v_mfma_f32_16x16x32_bf16 v[144:147], v[196:199], a[112:115], v[144:147]
    s_waitcnt vmcnt(18)
    s_barrier
    v_add_u32 v9, 0, v5
    v_add_u32 v10, 0, v6
    v_add_u32 v11, 0, v7
    v_add_u32 v12, 0, v8
    ds_read_b64_tr_b16 v[208:209], v9 offset:0
    s_and_b32 s12, s44, 1
    v_mfma_f32_16x16x32_bf16 v[148:151], v[196:199], a[116:119], v[148:151]
    ds_read_b64_tr_b16 v[210:211], v9 offset:512
    s_mul_i32 s51, s78, 4608
    s_add_u32 s51, s51, s48
    v_mfma_f32_16x16x32_bf16 v[152:155], v[196:199], a[120:123], v[152:155]
    s_add_u32 m0, s52, 32768
    s_add_u32 s71, s71, s12
    v_mfma_f32_16x16x32_bf16 v[156:159], v[196:199], a[124:127], v[156:159]
    buffer_load_dwordx4 v1, s[24:27], s51 offen offset:0 lds
    s_waitcnt lgkmcnt(4)
    v_mfma_f32_16x16x32_bf16 v[160:163], v[200:203], a[112:115], v[160:163]
    ds_read_b64_tr_b16 v[212:213], v10 offset:0
    s_mul_i32 s12, s71, 82944
    v_mfma_f32_16x16x32_bf16 v[164:167], v[200:203], a[116:119], v[164:167]
    ds_read_b64_tr_b16 v[214:215], v10 offset:512
    s_add_u32 m0, s53, 36864
    s_nop 0
    buffer_load_dwordx4 v22, s[20:23], s19 offen offset:2048 lds
    v_mfma_f32_16x16x32_bf16 v[168:171], v[200:203], a[120:123], v[168:171]
    s_mul_i32 s71, s46, 1152
    s_add_u32 s12, s12, s71
    v_mfma_f32_16x16x32_bf16 v[172:175], v[200:203], a[124:127], v[172:175]
    v_lshl_or_b32 v233, v232, 1, 1
    s_waitcnt lgkmcnt(4)
    v_mfma_f32_16x16x32_bf16 v[176:179], v[204:207], a[112:115], v[176:179]
    ds_read_b64_tr_b16 v[192:193], v11 offset:0
    v_min_u32 v233, 8, v233
    v_mfma_f32_16x16x32_bf16 v[180:183], v[204:207], a[116:119], v[180:183]
    ds_read_b64_tr_b16 v[194:195], v11 offset:512
    buffer_load_dwordx4 v23, s[20:23], s19 offen offset:3072 lds
    v_mfma_f32_16x16x32_bf16 v[184:187], v[204:207], a[120:123], v[184:187]
    v_lshlrev_b32 v217, 7, v233
    s_lshl_b32 s71, s70, 2
    v_mfma_f32_16x16x32_bf16 v[188:191], v[204:207], a[124:127], v[188:191]
    s_add_u32 s71, s71, s44
    s_waitcnt lgkmcnt(4)
    v_mfma_f32_16x16x32_bf16 v[64:67], v[208:211], a[128:131], v[64:67]
    ds_read_b64_tr_b16 v[196:197], v12 offset:0
    s_mul_i32 s13, s71, 5376
    v_mfma_f32_16x16x32_bf16 v[68:71], v[208:211], a[132:135], v[68:71]
    ds_read_b64_tr_b16 v[198:199], v12 offset:512
    s_mul_i32 s71, s46, 663552
    v_mfma_f32_16x16x32_bf16 v[72:75], v[208:211], a[136:139], v[72:75]
    s_add_u32 s13, s13, s71
    v_min_u32 v218, 5, v232
    v_mfma_f32_16x16x32_bf16 v[76:79], v[208:211], a[140:143], v[76:79]
    s_add_u32 m0, s52, 32768
    s_nop 0
    buffer_load_dwordx4 v2, s[24:27], s51 offen offset:1024 lds
    s_waitcnt lgkmcnt(4)
    v_mfma_f32_16x16x32_bf16 v[80:83], v[212:215], a[128:131], v[80:83]
    ds_read_b64_tr_b16 v[200:201], v9 offset:8192
    v_lshlrev_b32 v218, 7, v218
    v_mfma_f32_16x16x32_bf16 v[84:87], v[212:215], a[132:135], v[84:87]
    ds_read_b64_tr_b16 v[202:203], v9 offset:8704
    s_lshl_b32 s71, s47, 2
    v_mfma_f32_16x16x32_bf16 v[88:91], v[212:215], a[136:139], v[88:91]
    s_add_u32 s71, s71, s44
    s_lshl_b32 s14, s45, 4
    v_mfma_f32_16x16x32_bf16 v[92:95], v[212:215], a[140:143], v[92:95]
    s_add_u32 s14, s14, s71
    s_waitcnt lgkmcnt(4)
    v_mfma_f32_16x16x32_bf16 v[96:99], v[192:195], a[128:131], v[96:99]
    ds_read_b64_tr_b16 v[204:205], v10 offset:8192
    s_mul_i32 s14, s14, 18432
    v_mfma_f32_16x16x32_bf16 v[100:103], v[192:195], a[132:135], v[100:103]
    ds_read_b64_tr_b16 v[206:207], v10 offset:8704
    s_lshl_b32 s71, s45, 1
    v_mfma_f32_16x16x32_bf16 v[104:107], v[192:195], a[136:139], v[104:107]
    s_and_b32 s15, s44, 1
    s_add_u32 s71, s71, s15
    v_mfma_f32_16x16x32_bf16 v[108:111], v[192:195], a[140:143], v[108:111]
    s_mul_i32 s15, s71, 36864
    s_waitcnt lgkmcnt(4)
    v_mfma_f32_16x16x32_bf16 v[112:115], v[196:199], a[128:131], v[112:115]
    ds_read_b64_tr_b16 v[208:209], v11 offset:8192
    v_mfma_f32_16x16x32_bf16 v[116:119], v[196:199], a[132:135], v[116:119]
    ds_read_b64_tr_b16 v[210:211], v11 offset:8704
    v_add_u32 v221, 65536, v24
    v_mfma_f32_16x16x32_bf16 v[120:123], v[196:199], a[136:139], v[120:123]
    v_add_u32 v222, 65536, v25
    s_add_u32 s15, s15, s48
    v_mfma_f32_16x16x32_bf16 v[124:127], v[196:199], a[140:143], v[124:127]
    buffer_load_dwordx4 v3, s[24:27], s51 offen offset:2048 lds
    s_waitcnt lgkmcnt(4)
    v_mfma_f32_16x16x32_bf16 v[128:131], v[200:203], a[128:131], v[128:131]
    ds_read_b64_tr_b16 v[212:213], v12 offset:8192
    ds_read_b128 a[160:163], v221 offset:0
    v_mfma_f32_16x16x32_bf16 v[132:135], v[200:203], a[132:135], v[132:135]
    ds_read_b64_tr_b16 v[214:215], v12 offset:8704
    ds_read_b128 a[164:167], v221 offset:2048
    v_mfma_f32_16x16x32_bf16 v[136:139], v[200:203], a[136:139], v[136:139]
    ds_read_b128 a[168:171], v221 offset:4096
    v_min_u32 v217, 8, v232
    v_mfma_f32_16x16x32_bf16 v[140:143], v[200:203], a[140:143], v[140:143]
    ds_read_b128 a[172:175], v221 offset:6144
    s_waitcnt lgkmcnt(8)
    v_mfma_f32_16x16x32_bf16 v[144:147], v[204:207], a[128:131], v[144:147]
    ds_read_b64_tr_b16 v[192:193], v9 offset:4096
    ds_read_b128 a[176:179], v222 offset:0
    v_mfma_f32_16x16x32_bf16 v[148:151], v[204:207], a[132:135], v[148:151]
    ds_read_b64_tr_b16 v[194:195], v9 offset:4608
    ds_read_b128 a[180:183], v222 offset:2048
    v_mfma_f32_16x16x32_bf16 v[152:155], v[204:207], a[136:139], v[152:155]
    ds_read_b128 a[184:187], v222 offset:4096
    v_mul_u32_u24 v217, 9216, v217
    v_mfma_f32_16x16x32_bf16 v[156:159], v[204:207], a[140:143], v[156:159]
    ds_read_b128 a[188:191], v222 offset:6144
    s_waitcnt lgkmcnt(12)
    v_mfma_f32_16x16x32_bf16 v[160:163], v[208:211], a[128:131], v[160:163]
    ds_read_b64_tr_b16 v[196:197], v10 offset:4096
    v_mfma_f32_16x16x32_bf16 v[164:167], v[208:211], a[132:135], v[164:167]
    ds_read_b64_tr_b16 v[198:199], v10 offset:4608
    v_mfma_f32_16x16x32_bf16 v[168:171], v[208:211], a[136:139], v[168:171]
    v_mfma_f32_16x16x32_bf16 v[172:175], v[208:211], a[140:143], v[172:175]
    buffer_load_dwordx4 v4, s[24:27], s51 offen offset:3072 lds
    s_waitcnt lgkmcnt(11)
    v_mfma_f32_16x16x32_bf16 v[176:179], v[212:215], a[128:131], v[176:179]
    ds_read_b64_tr_b16 v[200:201], v11 offset:4096
    s_waitcnt lgkmcnt(3)
    v_mfma_f32_16x16x32_bf16 v[180:183], v[212:215], a[132:135], v[180:183]
    ds_read_b64_tr_b16 v[202:203], v11 offset:4608
    s_add_u32 s69, s50, s80
    v_mfma_f32_16x16x32_bf16 v[184:187], v[212:215], a[136:139], v[184:187]
    s_add_u32 m0, s53, 65536
    v_mfma_f32_16x16x32_bf16 v[188:191], v[212:215], a[140:143], v[188:191]
    buffer_load_dwordx4 v16, s[20:23], s69 offen offset:0 lds
    v_mfma_f32_16x16x32_bf16 v[64:67], v[192:195], a[144:147], v[64:67]
    ds_read_b64_tr_b16 v[204:205], v12 offset:4096
    v_mfma_f32_16x16x32_bf16 v[68:71], v[192:195], a[148:151], v[68:71]
    ds_read_b64_tr_b16 v[206:207], v12 offset:4608
    v_mfma_f32_16x16x32_bf16 v[72:75], v[192:195], a[152:155], v[72:75]
    s_add_u32 s66, s12, 1024
    buffer_load_dword v216, v217, s[24:27], s66 offen
    v_mfma_f32_16x16x32_bf16 v[76:79], v[192:195], a[156:159], v[76:79]
    s_waitcnt lgkmcnt(4)
    v_mfma_f32_16x16x32_bf16 v[80:83], v[196:199], a[144:147], v[80:83]
    ds_read_b64_tr_b16 v[208:209], v9 offset:12288
    buffer_load_dwordx4 v17, s[20:23], s69 offen offset:1024 lds
    v_mfma_f32_16x16x32_bf16 v[84:87], v[196:199], a[148:151], v[84:87]
    ds_read_b64_tr_b16 v[210:211], v9 offset:12800
    v_mfma_f32_16x16x32_bf16 v[88:91], v[196:199], a[152:155], v[88:91]
    v_mfma_f32_16x16x32_bf16 v[92:95], v[196:199], a[156:159], v[92:95]
    s_waitcnt lgkmcnt(4)
    v_mfma_f32_16x16x32_bf16 v[96:99], v[200:203], a[144:147], v[96:99]
    ds_read_b64_tr_b16 v[212:213], v10 offset:12288
    buffer_load_dwordx4 v18, s[20:23], s69 offen offset:2048 lds
    v_mfma_f32_16x16x32_bf16 v[100:103], v[200:203], a[148:151], v[100:103]
    ds_read_b64_tr_b16 v[214:215], v10 offset:12800
    v_mfma_f32_16x16x32_bf16 v[104:107], v[200:203], a[152:155], v[104:107]
    v_mfma_f32_16x16x32_bf16 v[108:111], v[200:203], a[156:159], v[108:111]
    s_waitcnt lgkmcnt(4)
    v_mfma_f32_16x16x32_bf16 v[112:115], v[204:207], a[144:147], v[112:115]
    ds_read_b64_tr_b16 v[192:193], v11 offset:12288
    buffer_load_dwordx4 v19, s[20:23], s69 offen offset:3072 lds
    v_mfma_f32_16x16x32_bf16 v[116:119], v[204:207], a[148:151], v[116:119]
    ds_read_b64_tr_b16 v[194:195], v11 offset:12800
    s_add_u32 m0, s53, 69632
    v_mfma_f32_16x16x32_bf16 v[120:123], v[204:207], a[152:155], v[120:123]
    v_mfma_f32_16x16x32_bf16 v[124:127], v[204:207], a[156:159], v[124:127]
    s_waitcnt lgkmcnt(4)
    v_mfma_f32_16x16x32_bf16 v[128:131], v[208:211], a[144:147], v[128:131]
    ds_read_b64_tr_b16 v[196:197], v12 offset:12288
    buffer_load_dwordx4 v20, s[20:23], s69 offen offset:0 lds
    v_mfma_f32_16x16x32_bf16 v[132:135], v[208:211], a[148:151], v[132:135]
    ds_read_b64_tr_b16 v[198:199], v12 offset:12800
    v_mfma_f32_16x16x32_bf16 v[136:139], v[208:211], a[152:155], v[136:139]
    v_mfma_f32_16x16x32_bf16 v[140:143], v[208:211], a[156:159], v[140:143]
    s_waitcnt lgkmcnt(4)
    v_mfma_f32_16x16x32_bf16 v[144:147], v[212:215], a[144:147], v[144:147]
    s_waitcnt vmcnt(18)
    s_barrier
    v_add_u32 v9, 16384, v5
    v_add_u32 v10, 16384, v6
    v_add_u32 v11, 16384, v7
    v_add_u32 v12, 16384, v8
    ds_read_b64_tr_b16 v[200:201], v9 offset:0
    buffer_load_dwordx4 v21, s[20:23], s69 offen offset:1024 lds
    v_mfma_f32_16x16x32_bf16 v[148:151], v[212:215], a[148:151], v[148:151]
    ds_read_b64_tr_b16 v[202:203], v9 offset:512
    s_mul_i32 s51, s79, 4608
    s_add_u32 s51, s51, s48
    v_mfma_f32_16x16x32_bf16 v[152:155], v[212:215], a[152:155], v[152:155]
    s_add_u32 m0, s52, 49152
    v_mfma_f32_16x16x32_bf16 v[156:159], v[212:215], a[156:159], v[156:159]
    buffer_load_dwordx4 v1, s[24:27], s51 offen offset:0 lds
    s_waitcnt lgkmcnt(4)
    v_mfma_f32_16x16x32_bf16 v[160:163], v[192:195], a[144:147], v[160:163]
    ds_read_b64_tr_b16 v[204:205], v10 offset:0
    v_mfma_f32_16x16x32_bf16 v[164:167], v[192:195], a[148:151], v[164:167]
    ds_read_b64_tr_b16 v[206:207], v10 offset:512
    s_add_u32 m0, s53, 69632
    s_nop 0
    buffer_load_dwordx4 v22, s[20:23], s69 offen offset:2048 lds
    v_mfma_f32_16x16x32_bf16 v[168:171], v[192:195], a[152:155], v[168:171]
    v_mfma_f32_16x16x32_bf16 v[172:175], v[192:195], a[156:159], v[172:175]
    s_waitcnt lgkmcnt(4)
    v_mfma_f32_16x16x32_bf16 v[176:179], v[196:199], a[144:147], v[176:179]
    ds_read_b64_tr_b16 v[208:209], v11 offset:0
    v_mfma_f32_16x16x32_bf16 v[180:183], v[196:199], a[148:151], v[180:183]
    ds_read_b64_tr_b16 v[210:211], v11 offset:512
    buffer_load_dwordx4 v23, s[20:23], s69 offen offset:3072 lds
    v_mfma_f32_16x16x32_bf16 v[184:187], v[196:199], a[152:155], v[184:187]
    v_mfma_f32_16x16x32_bf16 v[188:191], v[196:199], a[156:159], v[188:191]
    s_waitcnt lgkmcnt(4)
    v_mfma_f32_16x16x32_bf16 v[64:67], v[200:203], a[160:163], v[64:67]
    ds_read_b64_tr_b16 v[212:213], v12 offset:0
    v_mfma_f32_16x16x32_bf16 v[68:71], v[200:203], a[164:167], v[68:71]
    ds_read_b64_tr_b16 v[214:215], v12 offset:512
    v_mfma_f32_16x16x32_bf16 v[72:75], v[200:203], a[168:171], v[72:75]
    v_mfma_f32_16x16x32_bf16 v[76:79], v[200:203], a[172:175], v[76:79]
    s_add_u32 m0, s52, 49152
    s_nop 0
    buffer_load_dwordx4 v2, s[24:27], s51 offen offset:1024 lds
    s_waitcnt lgkmcnt(4)
    v_mfma_f32_16x16x32_bf16 v[80:83], v[204:207], a[160:163], v[80:83]
    ds_read_b64_tr_b16 v[192:193], v9 offset:8192
    v_mfma_f32_16x16x32_bf16 v[84:87], v[204:207], a[164:167], v[84:87]
    ds_read_b64_tr_b16 v[194:195], v9 offset:8704
    v_mfma_f32_16x16x32_bf16 v[88:91], v[204:207], a[168:171], v[88:91]
    v_mfma_f32_16x16x32_bf16 v[92:95], v[204:207], a[172:175], v[92:95]
    s_waitcnt lgkmcnt(4)
    v_mfma_f32_16x16x32_bf16 v[96:99], v[208:211], a[160:163], v[96:99]
    ds_read_b64_tr_b16 v[196:197], v10 offset:8192
    v_mfma_f32_16x16x32_bf16 v[100:103], v[208:211], a[164:167], v[100:103]
    ds_read_b64_tr_b16 v[198:199], v10 offset:8704
    v_mfma_f32_16x16x32_bf16 v[104:107], v[208:211], a[168:171], v[104:107]
    v_mfma_f32_16x16x32_bf16 v[108:111], v[208:211], a[172:175], v[108:111]
    s_waitcnt lgkmcnt(4)
    v_mfma_f32_16x16x32_bf16 v[112:115], v[212:215], a[160:163], v[112:115]
    ds_read_b64_tr_b16 v[200:201], v11 offset:8192
    v_mfma_f32_16x16x32_bf16 v[116:119], v[212:215], a[164:167], v[116:119]
    ds_read_b64_tr_b16 v[202:203], v11 offset:8704
    ds_read_b128 a[192:195], v24 offset:0
    v_mfma_f32_16x16x32_bf16 v[120:123], v[212:215], a[168:171], v[120:123]
    ds_read_b128 a[196:199], v24 offset:2048
    v_mfma_f32_16x16x32_bf16 v[124:127], v[212:215], a[172:175], v[124:127]
    buffer_load_dwordx4 v3, s[24:27], s51 offen offset:2048 lds
    s_waitcnt lgkmcnt(6)
    v_mfma_f32_16x16x32_bf16 v[128:131], v[192:195], a[160:163], v[128:131]
    ds_read_b64_tr_b16 v[204:205], v12 offset:8192
    ds_read_b128 a[200:203], v24 offset:4096
    v_mfma_f32_16x16x32_bf16 v[132:135], v[192:195], a[164:167], v[132:135]
    ds_read_b64_tr_b16 v[206:207], v12 offset:8704
    ds_read_b128 a[204:207], v24 offset:6144
    v_mfma_f32_16x16x32_bf16 v[136:139], v[192:195], a[168:171], v[136:139]
    ds_read_b128 a[208:211], v25 offset:0
    v_mfma_f32_16x16x32_bf16 v[140:143], v[192:195], a[172:175], v[140:143]
    ds_read_b128 a[212:215], v25 offset:2048
    s_waitcnt lgkmcnt(10)
    v_mfma_f32_16x16x32_bf16 v[144:147], v[196:199], a[160:163], v[144:147]
    ds_read_b64_tr_b16 v[208:209], v9 offset:4096
    ds_read_b128 a[216:219], v25 offset:4096
    v_mfma_f32_16x16x32_bf16 v[148:151], v[196:199], a[164:167], v[148:151]
    ds_read_b64_tr_b16 v[210:211], v9 offset:4608
    ds_read_b128 a[220:223], v25 offset:6144
    v_mfma_f32_16x16x32_bf16 v[152:155], v[196:199], a[168:171], v[152:155]
    v_mfma_f32_16x16x32_bf16 v[156:159], v[196:199], a[172:175], v[156:159]
    s_waitcnt lgkmcnt(12)
    v_mfma_f32_16x16x32_bf16 v[160:163], v[200:203], a[160:163], v[160:163]
    ds_read_b64_tr_b16 v[212:213], v10 offset:4096
    v_mfma_f32_16x16x32_bf16 v[164:167], v[200:203], a[164:167], v[164:167]
    ds_read_b64_tr_b16 v[214:215], v10 offset:4608
    v_mfma_f32_16x16x32_bf16 v[168:171], v[200:203], a[168:171], v[168:171]
    v_mfma_f32_16x16x32_bf16 v[172:175], v[200:203], a[172:175], v[172:175]
    buffer_load_dwordx4 v4, s[24:27], s51 offen offset:3072 lds
    s_waitcnt lgkmcnt(9)
    v_mfma_f32_16x16x32_bf16 v[176:179], v[204:207], a[160:163], v[176:179]
    ds_read_b64_tr_b16 v[192:193], v11 offset:4096
    v_mfma_f32_16x16x32_bf16 v[180:183], v[204:207], a[164:167], v[180:183]
    ds_read_b64_tr_b16 v[194:195], v11 offset:4608
    v_mfma_f32_16x16x32_bf16 v[184:187], v[204:207], a[168:171], v[184:187]
    v_mfma_f32_16x16x32_bf16 v[188:191], v[204:207], a[172:175], v[188:191]
    s_waitcnt lgkmcnt(5)
    v_mfma_f32_16x16x32_bf16 v[64:67], v[208:211], a[176:179], v[64:67]
    ds_read_b64_tr_b16 v[196:197], v12 offset:4096
    v_mfma_f32_16x16x32_bf16 v[68:71], v[208:211], a[180:183], v[68:71]
    ds_read_b64_tr_b16 v[198:199], v12 offset:4608
    v_mfma_f32_16x16x32_bf16 v[72:75], v[208:211], a[184:187], v[72:75]
    v_mfma_f32_16x16x32_bf16 v[76:79], v[208:211], a[188:191], v[76:79]
    s_waitcnt lgkmcnt(4)
    v_mfma_f32_16x16x32_bf16 v[80:83], v[212:215], a[176:179], v[80:83]
    ds_read_b64_tr_b16 v[200:201], v9 offset:12288
    v_mfma_f32_16x16x32_bf16 v[84:87], v[212:215], a[180:183], v[84:87]
    ds_read_b64_tr_b16 v[202:203], v9 offset:12800
    v_mfma_f32_16x16x32_bf16 v[88:91], v[212:215], a[184:187], v[88:91]
    v_mfma_f32_16x16x32_bf16 v[92:95], v[212:215], a[188:191], v[92:95]
    s_waitcnt lgkmcnt(4)
    v_mfma_f32_16x16x32_bf16 v[96:99], v[192:195], a[176:179], v[96:99]
    ds_read_b64_tr_b16 v[204:205], v10 offset:12288
    v_mfma_f32_16x16x32_bf16 v[100:103], v[192:195], a[180:183], v[100:103]
    ds_read_b64_tr_b16 v[206:207], v10 offset:12800
    v_mfma_f32_16x16x32_bf16 v[104:107], v[192:195], a[184:187], v[104:107]
    v_mfma_f32_16x16x32_bf16 v[108:111], v[192:195], a[188:191], v[108:111]
    s_waitcnt lgkmcnt(4)
    v_mfma_f32_16x16x32_bf16 v[112:115], v[196:199], a[176:179], v[112:115]
    ds_read_b64_tr_b16 v[208:209], v11 offset:12288
    v_mfma_f32_16x16x32_bf16 v[116:119], v[196:199], a[180:183], v[116:119]
    ds_read_b64_tr_b16 v[210:211], v11 offset:12800
    v_mfma_f32_16x16x32_bf16 v[120:123], v[196:199], a[184:187], v[120:123]
    v_mfma_f32_16x16x32_bf16 v[124:127], v[196:199], a[188:191], v[124:127]
    s_waitcnt lgkmcnt(4)
    v_mfma_f32_16x16x32_bf16 v[128:131], v[200:203], a[176:179], v[128:131]
    ds_read_b64_tr_b16 v[212:213], v12 offset:12288
    v_mfma_f32_16x16x32_bf16 v[132:135], v[200:203], a[180:183], v[132:135]
    ds_read_b64_tr_b16 v[214:215], v12 offset:12800
    v_mfma_f32_16x16x32_bf16 v[136:139], v[200:203], a[184:187], v[136:139]
    v_mfma_f32_16x16x32_bf16 v[140:143], v[200:203], a[188:191], v[140:143]
    s_waitcnt lgkmcnt(4)
    v_mfma_f32_16x16x32_bf16 v[144:147], v[204:207], a[176:179], v[144:147]
    s_waitcnt vmcnt(13)
    s_barrier
    v_add_u32 v9, 32768, v5
    v_add_u32 v10, 32768, v6
    v_add_u32 v11, 32768, v7
    v_add_u32 v12, 32768, v8
    ds_read_b64_tr_b16 v[192:193], v9 offset:0
    v_mfma_f32_16x16x32_bf16 v[148:151], v[204:207], a[180:183], v[148:151]
    ds_read_b64_tr_b16 v[194:195], v9 offset:512
    s_mul_i32 s51, s80, 4608
    s_add_u32 s51, s51, s48
    v_mfma_f32_16x16x32_bf16 v[152:155], v[204:207], a[184:187], v[152:155]
    s_add_u32 m0, s52, 0
    v_mfma_f32_16x16x32_bf16 v[156:159], v[204:207], a[188:191], v[156:159]
    buffer_load_dwordx4 v1, s[24:27], s51 offen offset:0 lds
    s_waitcnt lgkmcnt(4)
    v_mfma_f32_16x16x32_bf16 v[160:163], v[208:211], a[176:179], v[160:163]
    ds_read_b64_tr_b16 v[196:197], v10 offset:0
    v_mfma_f32_16x16x32_bf16 v[164:167], v[208:211], a[180:183], v[164:167]
    ds_read_b64_tr_b16 v[198:199], v10 offset:512
    v_mfma_f32_16x16x32_bf16 v[168:171], v[208:211], a[184:187], v[168:171]
    v_mfma_f32_16x16x32_bf16 v[172:175], v[208:211], a[188:191], v[172:175]
    s_waitcnt lgkmcnt(4)
    v_mfma_f32_16x16x32_bf16 v[176:179], v[212:215], a[176:179], v[176:179]
    ds_read_b64_tr_b16 v[200:201], v11 offset:0
    v_mfma_f32_16x16x32_bf16 v[180:183], v[212:215], a[180:183], v[180:183]
    ds_read_b64_tr_b16 v[202:203], v11 offset:512
    v_mfma_f32_16x16x32_bf16 v[184:187], v[212:215], a[184:187], v[184:187]
    v_mfma_f32_16x16x32_bf16 v[188:191], v[212:215], a[188:191], v[188:191]
    s_waitcnt lgkmcnt(4)
    v_mfma_f32_16x16x32_bf16 v[64:67], v[192:195], a[192:195], v[64:67]
    ds_read_b64_tr_b16 v[204:205], v12 offset:0
    v_mfma_f32_16x16x32_bf16 v[68:71], v[192:195], a[196:199], v[68:71]
    ds_read_b64_tr_b16 v[206:207], v12 offset:512
    v_mfma_f32_16x16x32_bf16 v[72:75], v[192:195], a[200:203], v[72:75]
    s_mul_i32 s51, s72, 4608
    s_add_u32 s51, s51, s56
    v_mfma_f32_16x16x32_bf16 v[76:79], v[192:195], a[204:207], v[76:79]
    s_mul_i32 s51, s80, 4608
    s_add_u32 s51, s51, s48
    buffer_load_dwordx4 v2, s[24:27], s51 offen offset:1024 lds
    s_waitcnt lgkmcnt(4)
    v_mfma_f32_16x16x32_bf16 v[80:83], v[196:199], a[192:195], v[80:83]
    ds_read_b64_tr_b16 v[208:209], v9 offset:8192
    s_add_u32 m0, s55, 73728
    v_mfma_f32_16x16x32_bf16 v[84:87], v[196:199], a[196:199], v[84:87]
    ds_read_b64_tr_b16 v[210:211], v9 offset:8704
    s_mul_i32 s51, s72, 4608
    s_add_u32 s51, s51, s56
    buffer_load_dwordx4 v26, s[24:27], s51 offen offset:0 lds
    v_mfma_f32_16x16x32_bf16 v[88:91], v[196:199], a[200:203], v[88:91]
    s_mul_i32 s51, s73, 4608
    s_add_u32 s51, s51, s56
    v_mfma_f32_16x16x32_bf16 v[92:95], v[196:199], a[204:207], v[92:95]
    s_add_u32 m0, s55, 77824
    s_waitcnt lgkmcnt(4)
    v_mfma_f32_16x16x32_bf16 v[96:99], v[200:203], a[192:195], v[96:99]
    ds_read_b64_tr_b16 v[212:213], v10 offset:8192
    v_mfma_f32_16x16x32_bf16 v[100:103], v[200:203], a[196:199], v[100:103]
    ds_read_b64_tr_b16 v[214:215], v10 offset:8704
    v_mfma_f32_16x16x32_bf16 v[104:107], v[200:203], a[200:203], v[104:107]
    v_mfma_f32_16x16x32_bf16 v[108:111], v[200:203], a[204:207], v[108:111]
    s_waitcnt lgkmcnt(4)
    v_mfma_f32_16x16x32_bf16 v[112:115], v[204:207], a[192:195], v[112:115]
    ds_read_b64_tr_b16 v[192:193], v11 offset:8192
    v_mfma_f32_16x16x32_bf16 v[116:119], v[204:207], a[196:199], v[116:119]
    ds_read_b64_tr_b16 v[194:195], v11 offset:8704
    ds_read_b128 a[224:227], v24 offset:32768
    v_mfma_f32_16x16x32_bf16 v[120:123], v[204:207], a[200:203], v[120:123]
    ds_read_b128 a[228:231], v24 offset:34816
    v_mfma_f32_16x16x32_bf16 v[124:127], v[204:207], a[204:207], v[124:127]
    s_mul_i32 s51, s80, 4608
    s_add_u32 s51, s51, s48
    s_add_u32 m0, s52, 0
    s_nop 0
    buffer_load_dwordx4 v3, s[24:27], s51 offen offset:2048 lds
    s_waitcnt lgkmcnt(6)
    v_mfma_f32_16x16x32_bf16 v[128:131], v[208:211], a[192:195], v[128:131]
    ds_read_b64_tr_b16 v[196:197], v12 offset:8192
    ds_read_b128 a[232:235], v24 offset:36864
    v_mfma_f32_16x16x32_bf16 v[132:135], v[208:211], a[196:199], v[132:135]
    ds_read_b64_tr_b16 v[198:199], v12 offset:8704
    ds_read_b128 a[236:239], v24 offset:38912
    v_mfma_f32_16x16x32_bf16 v[136:139], v[208:211], a[200:203], v[136:139]
    ds_read_b128 a[240:243], v25 offset:32768
    v_mfma_f32_16x16x32_bf16 v[140:143], v[208:211], a[204:207], v[140:143]
    ds_read_b128 a[244:247], v25 offset:34816
    s_waitcnt lgkmcnt(10)
    v_mfma_f32_16x16x32_bf16 v[144:147], v[212:215], a[192:195], v[144:147]
    ds_read_b64_tr_b16 v[200:201], v9 offset:4096
    ds_read_b128 a[248:251], v25 offset:36864
    v_mfma_f32_16x16x32_bf16 v[148:151], v[212:215], a[196:199], v[148:151]
    ds_read_b64_tr_b16 v[202:203], v9 offset:4608
    ds_read_b128 a[252:255], v25 offset:38912
    v_mfma_f32_16x16x32_bf16 v[152:155], v[212:215], a[200:203], v[152:155]
    v_mfma_f32_16x16x32_bf16 v[156:159], v[212:215], a[204:207], v[156:159]
    s_mul_i32 s51, s73, 4608
    s_add_u32 s51, s51, s56
    s_add_u32 m0, s55, 77824
    s_nop 0
    buffer_load_dwordx4 v26, s[24:27], s51 offen offset:0 lds
    s_waitcnt lgkmcnt(12)
    v_mfma_f32_16x16x32_bf16 v[160:163], v[192:195], a[192:195], v[160:163]
    ds_read_b64_tr_b16 v[204:205], v10 offset:4096
    s_mul_i32 s51, s74, 4608
    s_add_u32 s51, s51, s56
    v_mfma_f32_16x16x32_bf16 v[164:167], v[192:195], a[196:199], v[164:167]
    ds_read_b64_tr_b16 v[206:207], v10 offset:4608
    s_add_u32 m0, s55, 81920
    v_mfma_f32_16x16x32_bf16 v[168:171], v[192:195], a[200:203], v[168:171]
    v_mfma_f32_16x16x32_bf16 v[172:175], v[192:195], a[204:207], v[172:175]
    s_mul_i32 s51, s80, 4608
    s_add_u32 s51, s51, s48
    s_add_u32 m0, s52, 0
    s_nop 0
    buffer_load_dwordx4 v4, s[24:27], s51 offen offset:3072 lds
    s_waitcnt lgkmcnt(9)
    v_mfma_f32_16x16x32_bf16 v[176:179], v[196:199], a[192:195], v[176:179]
    ds_read_b64_tr_b16 v[208:209], v11 offset:4096
    v_mfma_f32_16x16x32_bf16 v[180:183], v[196:199], a[196:199], v[180:183]
    ds_read_b64_tr_b16 v[210:211], v11 offset:4608
    v_mfma_f32_16x16x32_bf16 v[184:187], v[196:199], a[200:203], v[184:187]
    v_mfma_f32_16x16x32_bf16 v[188:191], v[196:199], a[204:207], v[188:191]
    s_waitcnt lgkmcnt(5)
    v_mfma_f32_16x16x32_bf16 v[64:67], v[200:203], a[208:211], v[64:67]
    ds_read_b64_tr_b16 v[212:213], v12 offset:4096
    v_mfma_f32_16x16x32_bf16 v[68:71], v[200:203], a[212:215], v[68:71]
    ds_read_b64_tr_b16 v[214:215], v12 offset:4608
    v_mfma_f32_16x16x32_bf16 v[72:75], v[200:203], a[216:219], v[72:75]
    v_mfma_f32_16x16x32_bf16 v[76:79], v[200:203], a[220:223], v[76:79]
    s_waitcnt lgkmcnt(4)
    v_mfma_f32_16x16x32_bf16 v[80:83], v[204:207], a[208:211], v[80:83]
    ds_read_b64_tr_b16 v[192:193], v9 offset:12288
    v_mfma_f32_16x16x32_bf16 v[84:87], v[204:207], a[212:215], v[84:87]
    ds_read_b64_tr_b16 v[194:195], v9 offset:12800
    v_mfma_f32_16x16x32_bf16 v[88:91], v[204:207], a[216:219], v[88:91]
    v_mfma_f32_16x16x32_bf16 v[92:95], v[204:207], a[220:223], v[92:95]
    s_waitcnt lgkmcnt(4)
    v_mfma_f32_16x16x32_bf16 v[96:99], v[208:211], a[208:211], v[96:99]
    ds_read_b64_tr_b16 v[196:197], v10 offset:12288
    v_mfma_f32_16x16x32_bf16 v[100:103], v[208:211], a[212:215], v[100:103]
    ds_read_b64_tr_b16 v[198:199], v10 offset:12800
    s_mul_i32 s51, s74, 4608
    s_add_u32 s51, s51, s56
    s_add_u32 m0, s55, 81920
    s_nop 0
    buffer_load_dwordx4 v26, s[24:27], s51 offen offset:0 lds
    v_mfma_f32_16x16x32_bf16 v[104:107], v[208:211], a[216:219], v[104:107]
    s_mul_i32 s51, s75, 4608
    s_add_u32 s51, s51, s56
    v_mfma_f32_16x16x32_bf16 v[108:111], v[208:211], a[220:223], v[108:111]
    s_add_u32 m0, s55, 86016
    s_waitcnt lgkmcnt(4)
    v_mfma_f32_16x16x32_bf16 v[112:115], v[212:215], a[208:211], v[112:115]
    ds_read_b64_tr_b16 v[200:201], v11 offset:12288
    v_mfma_f32_16x16x32_bf16 v[116:119], v[212:215], a[212:215], v[116:119]
    ds_read_b64_tr_b16 v[202:203], v11 offset:12800
    v_mfma_f32_16x16x32_bf16 v[120:123], v[212:215], a[216:219], v[120:123]
    v_mfma_f32_16x16x32_bf16 v[124:127], v[212:215], a[220:223], v[124:127]
    s_waitcnt lgkmcnt(4)
    v_mfma_f32_16x16x32_bf16 v[128:131], v[192:195], a[208:211], v[128:131]
    ds_read_b64_tr_b16 v[204:205], v12 offset:12288
    v_mfma_f32_16x16x32_bf16 v[132:135], v[192:195], a[212:215], v[132:135]
    ds_read_b64_tr_b16 v[206:207], v12 offset:12800
    v_mfma_f32_16x16x32_bf16 v[136:139], v[192:195], a[216:219], v[136:139]
    v_mfma_f32_16x16x32_bf16 v[140:143], v[192:195], a[220:223], v[140:143]
    s_waitcnt lgkmcnt(4)
    v_mfma_f32_16x16x32_bf16 v[144:147], v[196:199], a[208:211], v[144:147]
    s_waitcnt vmcnt(7)
    s_barrier
    v_add_u32 v9, 49152, v5
    v_add_u32 v10, 49152, v6
    v_add_u32 v11, 49152, v7
    v_add_u32 v12, 49152, v8
    ds_read_b64_tr_b16 v[208:209], v9 offset:0
    v_mfma_f32_16x16x32_bf16 v[148:151], v[196:199], a[212:215], v[148:151]
    ds_read_b64_tr_b16 v[210:211], v9 offset:512
    v_mfma_f32_16x16x32_bf16 v[152:155], v[196:199], a[216:219], v[152:155]
    v_mfma_f32_16x16x32_bf16 v[156:159], v[196:199], a[220:223], v[156:159]
    s_waitcnt lgkmcnt(4)
    v_mfma_f32_16x16x32_bf16 v[160:163], v[200:203], a[208:211], v[160:163]
    ds_read_b64_tr_b16 v[212:213], v10 offset:0
    v_mfma_f32_16x16x32_bf16 v[164:167], v[200:203], a[212:215], v[164:167]
    ds_read_b64_tr_b16 v[214:215], v10 offset:512
    v_mfma_f32_16x16x32_bf16 v[168:171], v[200:203], a[216:219], v[168:171]
    v_mfma_f32_16x16x32_bf16 v[172:175], v[200:203], a[220:223], v[172:175]
    buffer_load_dwordx4 v26, s[24:27], s51 offen offset:0 lds
    s_waitcnt lgkmcnt(4)
    v_mfma_f32_16x16x32_bf16 v[176:179], v[204:207], a[208:211], v[176:179]
    ds_read_b64_tr_b16 v[192:193], v11 offset:0
    s_mul_i32 s51, s76, 4608
    s_add_u32 s51, s51, s56
    v_mfma_f32_16x16x32_bf16 v[180:183], v[204:207], a[212:215], v[180:183]
    ds_read_b64_tr_b16 v[194:195], v11 offset:512
    s_add_u32 m0, s55, 90112
    v_mfma_f32_16x16x32_bf16 v[184:187], v[204:207], a[216:219], v[184:187]
    v_mfma_f32_16x16x32_bf16 v[188:191], v[204:207], a[220:223], v[188:191]
    s_waitcnt lgkmcnt(4)
    v_mfma_f32_16x16x32_bf16 v[64:67], v[208:211], a[224:227], v[64:67]
    ds_read_b64_tr_b16 v[196:197], v12 offset:0
    v_mfma_f32_16x16x32_bf16 v[68:71], v[208:211], a[228:231], v[68:71]
    ds_read_b64_tr_b16 v[198:199], v12 offset:512
    v_add_u32 v0, 1, v0
    v_mfma_f32_16x16x32_bf16 v[72:75], v[208:211], a[232:235], v[72:75]
    v_or_b32 v0, 0x80000000, v0
    v_mfma_f32_16x16x32_bf16 v[76:79], v[208:211], a[236:239], v[76:79]
    s_nop 1
    s_waitcnt lgkmcnt(4)
    v_mfma_f32_16x16x32_bf16 v[80:83], v[212:215], a[224:227], v[80:83]
    ds_read_b64_tr_b16 v[200:201], v9 offset:8192
    v_readfirstlane_b32 s18, v0
    v_mfma_f32_16x16x32_bf16 v[84:87], v[212:215], a[228:231], v[84:87]
    ds_read_b64_tr_b16 v[202:203], v9 offset:8704
    v_mfma_f32_16x16x32_bf16 v[88:91], v[212:215], a[232:235], v[88:91]
    v_mfma_f32_16x16x32_bf16 v[92:95], v[212:215], a[236:239], v[92:95]
    s_waitcnt lgkmcnt(4)
    v_mfma_f32_16x16x32_bf16 v[96:99], v[192:195], a[224:227], v[96:99]
    ds_read_b64_tr_b16 v[204:205], v10 offset:8192
    v_mfma_f32_16x16x32_bf16 v[100:103], v[192:195], a[228:231], v[100:103]
    ds_read_b64_tr_b16 v[206:207], v10 offset:8704
    v_mfma_f32_16x16x32_bf16 v[104:107], v[192:195], a[232:235], v[104:107]
    v_mfma_f32_16x16x32_bf16 v[108:111], v[192:195], a[236:239], v[108:111]
    s_waitcnt lgkmcnt(4)
    v_mfma_f32_16x16x32_bf16 v[112:115], v[196:199], a[224:227], v[112:115]
    ds_read_b64_tr_b16 v[208:209], v11 offset:8192
    v_mfma_f32_16x16x32_bf16 v[116:119], v[196:199], a[228:231], v[116:119]
    ds_read_b64_tr_b16 v[210:211], v11 offset:8704
    buffer_load_dwordx4 v26, s[24:27], s51 offen offset:0 lds
    v_mfma_f32_16x16x32_bf16 v[120:123], v[196:199], a[232:235], v[120:123]
    s_mul_i32 s51, s77, 4608
    s_add_u32 s51, s51, s56
    v_mfma_f32_16x16x32_bf16 v[124:127], v[196:199], a[236:239], v[124:127]
    s_add_u32 m0, s55, 94208
    s_waitcnt lgkmcnt(4)
    v_mfma_f32_16x16x32_bf16 v[128:131], v[200:203], a[224:227], v[128:131]
    ds_read_b64_tr_b16 v[212:213], v12 offset:8192
    buffer_load_dwordx4 v26, s[24:27], s51 offen offset:0 lds
    v_mfma_f32_16x16x32_bf16 v[132:135], v[200:203], a[228:231], v[132:135]
    ds_read_b64_tr_b16 v[214:215], v12 offset:8704
    s_mul_i32 s51, s78, 4608
    s_add_u32 s51, s51, s56
    v_mfma_f32_16x16x32_bf16 v[136:139], v[200:203], a[232:235], v[136:139]
    s_add_u32 m0, s55, 98304
    v_mfma_f32_16x16x32_bf16 v[140:143], v[200:203], a[236:239], v[140:143]
    v_add_u32 v221, 65536, v24
    s_waitcnt lgkmcnt(4)
    v_mfma_f32_16x16x32_bf16 v[144:147], v[204:207], a[224:227], v[144:147]
    ds_read_b64_tr_b16 v[192:193], v9 offset:4096
    v_add_u32 v222, 65536, v25
    v_mfma_f32_16x16x32_bf16 v[148:151], v[204:207], a[228:231], v[148:151]
    ds_read_b64_tr_b16 v[194:195], v9 offset:4608
    ds_read_b128 v[32:35], v221 offset:0
    v_mfma_f32_16x16x32_bf16 v[152:155], v[204:207], a[232:235], v[152:155]
    ds_read_b128 v[36:39], v221 offset:2048
    v_mfma_f32_16x16x32_bf16 v[156:159], v[204:207], a[236:239], v[156:159]
    ds_read_b128 v[40:43], v221 offset:4096
    s_waitcnt lgkmcnt(7)
    v_mfma_f32_16x16x32_bf16 v[160:163], v[208:211], a[224:227], v[160:163]
    ds_read_b64_tr_b16 v[196:197], v10 offset:4096
    ds_read_b128 v[44:47], v221 offset:6144
    v_mfma_f32_16x16x32_bf16 v[164:167], v[208:211], a[228:231], v[164:167]
    ds_read_b64_tr_b16 v[198:199], v10 offset:4608
    ds_read_b128 v[48:51], v222 offset:0
    v_mfma_f32_16x16x32_bf16 v[168:171], v[208:211], a[232:235], v[168:171]
    ds_read_b128 v[52:55], v222 offset:2048
    v_mfma_f32_16x16x32_bf16 v[172:175], v[208:211], a[236:239], v[172:175]
    ds_read_b128 v[56:59], v222 offset:4096
    s_waitcnt lgkmcnt(11)
    v_mfma_f32_16x16x32_bf16 v[176:179], v[212:215], a[224:227], v[176:179]
    ds_read_b64_tr_b16 v[200:201], v11 offset:4096
    ds_read_b128 v[60:63], v222 offset:6144
    v_mfma_f32_16x16x32_bf16 v[180:183], v[212:215], a[228:231], v[180:183]
    ds_read_b64_tr_b16 v[202:203], v11 offset:4608
    v_mfma_f32_16x16x32_bf16 v[184:187], v[212:215], a[232:235], v[184:187]
    v_mfma_f32_16x16x32_bf16 v[188:191], v[212:215], a[236:239], v[188:191]
    s_waitcnt lgkmcnt(12)
    v_mfma_f32_16x16x32_bf16 v[64:67], v[192:195], a[240:243], v[64:67]
    ds_read_b64_tr_b16 v[204:205], v12 offset:4096
    v_mfma_f32_16x16x32_bf16 v[68:71], v[192:195], a[244:247], v[68:71]
    ds_read_b64_tr_b16 v[206:207], v12 offset:4608
    v_mfma_f32_16x16x32_bf16 v[72:75], v[192:195], a[248:251], v[72:75]
    buffer_load_dwordx4 v26, s[24:27], s51 offen offset:0 lds
    v_mfma_f32_16x16x32_bf16 v[76:79], v[192:195], a[252:255], v[76:79]
    s_mul_i32 s51, s79, 4608
    s_add_u32 s51, s51, s56
    s_waitcnt lgkmcnt(8)
    v_mfma_f32_16x16x32_bf16 v[80:83], v[196:199], a[240:243], v[80:83]
    ds_read_b64_tr_b16 v[208:209], v9 offset:12288
    s_add_u32 m0, s55, 102400
    v_mfma_f32_16x16x32_bf16 v[84:87], v[196:199], a[244:247], v[84:87]
    ds_read_b64_tr_b16 v[210:211], v9 offset:12800
    v_mfma_f32_16x16x32_bf16 v[88:91], v[196:199], a[248:251], v[88:91]
    v_mfma_f32_16x16x32_bf16 v[92:95], v[196:199], a[252:255], v[92:95]
    s_waitcnt lgkmcnt(4)
    v_mfma_f32_16x16x32_bf16 v[96:99], v[200:203], a[240:243], v[96:99]
    ds_read_b64_tr_b16 v[212:213], v10 offset:12288
    v_mfma_f32_16x16x32_bf16 v[100:103], v[200:203], a[244:247], v[100:103]
    ds_read_b64_tr_b16 v[214:215], v10 offset:12800
    v_mfma_f32_16x16x32_bf16 v[104:107], v[200:203], a[248:251], v[104:107]
    v_mfma_f32_16x16x32_bf16 v[108:111], v[200:203], a[252:255], v[108:111]
    s_waitcnt lgkmcnt(4)
    v_mfma_f32_16x16x32_bf16 v[112:115], v[204:207], a[240:243], v[112:115]
    ds_read_b64_tr_b16 v[192:193], v11 offset:12288
    v_mfma_f32_16x16x32_bf16 v[116:119], v[204:207], a[244:247], v[116:119]
    ds_read_b64_tr_b16 v[194:195], v11 offset:12800
    v_mfma_f32_16x16x32_bf16 v[120:123], v[204:207], a[248:251], v[120:123]
    v_mfma_f32_16x16x32_bf16 v[124:127], v[204:207], a[252:255], v[124:127]
    s_waitcnt lgkmcnt(4)
    v_mfma_f32_16x16x32_bf16 v[128:131], v[208:211], a[240:243], v[128:131]
    ds_read_b64_tr_b16 v[196:197], v12 offset:12288
    v_mfma_f32_16x16x32_bf16 v[132:135], v[208:211], a[244:247], v[132:135]
    ds_read_b64_tr_b16 v[198:199], v12 offset:12800
    v_mfma_f32_16x16x32_bf16 v[136:139], v[208:211], a[248:251], v[136:139]
    v_mfma_f32_16x16x32_bf16 v[140:143], v[208:211], a[252:255], v[140:143]
    s_waitcnt lgkmcnt(4)
    v_mfma_f32_16x16x32_bf16 v[144:147], v[212:215], a[240:243], v[144:147]
    s_waitcnt vmcnt(5)
    s_barrier
    v_add_u32 v9, 0, v5
    v_add_u32 v10, 0, v6
    v_add_u32 v11, 0, v7
    v_add_u32 v12, 0, v8
    ds_read_b64_tr_b16 v[200:201], v9 offset:0
    buffer_load_dwordx4 v26, s[24:27], s51 offen offset:0 lds
    v_mfma_f32_16x16x32_bf16 v[148:151], v[212:215], a[244:247], v[148:151]
    ds_read_b64_tr_b16 v[202:203], v9 offset:512
    s_mul_i32 s51, s80, 4608
    s_add_u32 s51, s51, s56
    v_mfma_f32_16x16x32_bf16 v[152:155], v[212:215], a[248:251], v[152:155]
    s_add_u32 m0, s55, 106496
    v_mfma_f32_16x16x32_bf16 v[156:159], v[212:215], a[252:255], v[156:159]
    s_waitcnt lgkmcnt(4)
    v_mfma_f32_16x16x32_bf16 v[160:163], v[192:195], a[240:243], v[160:163]
    ds_read_b64_tr_b16 v[204:205], v9 offset:8192
    v_mfma_f32_16x16x32_bf16 v[164:167], v[192:195], a[244:247], v[164:167]
    ds_read_b64_tr_b16 v[206:207], v9 offset:8704
    v_mfma_f32_16x16x32_bf16 v[168:171], v[192:195], a[248:251], v[168:171]
    v_mfma_f32_16x16x32_bf16 v[172:175], v[192:195], a[252:255], v[172:175]
    s_waitcnt lgkmcnt(4)
    v_mfma_f32_16x16x32_bf16 v[176:179], v[196:199], a[240:243], v[176:179]
    ds_read_b64_tr_b16 v[208:209], v9 offset:4096
    v_mfma_f32_16x16x32_bf16 v[180:183], v[196:199], a[244:247], v[180:183]
    ds_read_b64_tr_b16 v[210:211], v9 offset:4608
    v_mfma_f32_16x16x32_bf16 v[184:187], v[196:199], a[248:251], v[184:187]
    v_mfma_f32_16x16x32_bf16 v[188:191], v[196:199], a[252:255], v[188:191]
    s_waitcnt lgkmcnt(4)
    v_mfma_f32_16x16x32_bf16 v[64:67], v[200:203], v[32:35], v[64:67]
    ds_read_b64_tr_b16 v[212:213], v9 offset:12288
    v_lshrrev_b32 v16, 1, v15
    v_mfma_f32_16x16x32_bf16 v[68:71], v[200:203], v[36:39], v[68:71]
    ds_read_b64_tr_b16 v[214:215], v9 offset:12800
    v_bfe_u32 v17, v15, 4, 2
    v_mfma_f32_16x16x32_bf16 v[72:75], v[200:203], v[40:43], v[72:75]
    v_lshlrev_b32 v17, 2, v17
    v_mfma_f32_16x16x32_bf16 v[76:79], v[200:203], v[44:47], v[76:79]
    s_waitcnt lgkmcnt(4)
    v_mfma_f32_16x16x32_bf16 v[128:131], v[204:207], v[32:35], v[128:131]
    ds_read_b64_tr_b16 v[192:193], v10 offset:0
    v_mfma_f32_16x16x32_bf16 v[132:135], v[204:207], v[36:39], v[132:135]
    ds_read_b64_tr_b16 v[194:195], v10 offset:512
    v_mfma_f32_16x16x32_bf16 v[136:139], v[204:207], v[40:43], v[136:139]
    buffer_load_dwordx4 v26, s[24:27], s51 offen offset:0 lds
    v_mfma_f32_16x16x32_bf16 v[140:143], v[204:207], v[44:47], v[140:143]
    s_mul_i32 s51, s72, 4608
    s_add_u32 s51, s51, s48
    s_add_u32 s51, s51, 128
    s_waitcnt lgkmcnt(4)
    v_mfma_f32_16x16x32_bf16 v[64:67], v[208:211], v[48:51], v[64:67]
    ds_read_b64_tr_b16 v[196:197], v10 offset:8192
    s_add_u32 m0, s52, 110592
    v_mfma_f32_16x16x32_bf16 v[68:71], v[208:211], v[52:55], v[68:71]
    ds_read_b64_tr_b16 v[198:199], v10 offset:8704
    buffer_load_dwordx4 v1, s[24:27], s51 offen offset:0 lds
    v_mfma_f32_16x16x32_bf16 v[72:75], v[208:211], v[56:59], v[72:75]
    v_mfma_f32_16x16x32_bf16 v[76:79], v[208:211], v[60:63], v[76:79]
    s_waitcnt lgkmcnt(4)
    v_mfma_f32_16x16x32_bf16 v[128:131], v[212:215], v[48:51], v[128:131]
    ds_read_b64_tr_b16 v[200:201], v10 offset:4096
    v_mfma_f32_16x16x32_bf16 v[132:135], v[212:215], v[52:55], v[132:135]
    ds_read_b64_tr_b16 v[202:203], v10 offset:4608
    v_mfma_f32_16x16x32_bf16 v[136:139], v[212:215], v[56:59], v[136:139]
    v_mfma_f32_16x16x32_bf16 v[140:143], v[212:215], v[60:63], v[140:143]
    buffer_load_dwordx4 v2, s[24:27], s51 offen offset:1024 lds
    s_waitcnt lgkmcnt(4)
    v_mfma_f32_16x16x32_bf16 v[80:83], v[192:195], v[32:35], v[80:83]
    ds_read_b64_tr_b16 v[204:205], v10 offset:12288
    v_mfma_f32_16x16x32_bf16 v[84:87], v[192:195], v[36:39], v[84:87]
    ds_read_b64_tr_b16 v[206:207], v10 offset:12800
    v_mfma_f32_16x16x32_bf16 v[88:91], v[192:195], v[40:43], v[88:91]
    v_max_f32 v64, 0, v64
    v_max_f32 v65, 0, v65
    v_mfma_f32_16x16x32_bf16 v[92:95], v[192:195], v[44:47], v[92:95]
    v_max_f32 v66, 0, v66
    s_waitcnt lgkmcnt(4)
    v_mfma_f32_16x16x32_bf16 v[144:147], v[196:199], v[32:35], v[144:147]
    ds_read_b64_tr_b16 v[208:209], v11 offset:0
    v_max_f32 v67, 0, v67
    v_mfma_f32_16x16x32_bf16 v[148:151], v[196:199], v[36:39], v[148:151]
    ds_read_b64_tr_b16 v[210:211], v11 offset:512
    buffer_load_dwordx4 v3, s[24:27], s51 offen offset:2048 lds
    v_mfma_f32_16x16x32_bf16 v[152:155], v[196:199], v[40:43], v[152:155]
    v_mul_f32 v64, v64, v128
    v_mul_f32 v65, v65, v129
    v_mfma_f32_16x16x32_bf16 v[156:159], v[196:199], v[44:47], v[156:159]
    v_mul_f32 v66, v66, v130
    s_waitcnt lgkmcnt(4)
    v_mfma_f32_16x16x32_bf16 v[80:83], v[200:203], v[48:51], v[80:83]
    ds_read_b64_tr_b16 v[212:213], v11 offset:8192
    v_mul_f32 v67, v67, v131
    v_mfma_f32_16x16x32_bf16 v[84:87], v[200:203], v[52:55], v[84:87]
    ds_read_b64_tr_b16 v[214:215], v11 offset:8704
    v_cvt_pk_bf16_f32 v224, v64, v65
    v_mfma_f32_16x16x32_bf16 v[88:91], v[200:203], v[56:59], v[88:91]
    v_cvt_pk_bf16_f32 v225, v66, v67
    v_max_f32 v68, 0, v68
    v_mfma_f32_16x16x32_bf16 v[92:95], v[200:203], v[60:63], v[92:95]
    buffer_load_dwordx4 v4, s[24:27], s51 offen offset:3072 lds
    s_waitcnt lgkmcnt(4)
    v_mfma_f32_16x16x32_bf16 v[144:147], v[204:207], v[48:51], v[144:147]
    ds_read_b64_tr_b16 v[192:193], v11 offset:4096
    s_mul_i32 s51, s73, 4608
    s_add_u32 s51, s51, s48
    s_add_u32 s51, s51, 128
    v_mfma_f32_16x16x32_bf16 v[148:151], v[204:207], v[52:55], v[148:151]
    ds_read_b64_tr_b16 v[194:195], v11 offset:4608
    s_add_u32 m0, s52, 129024
    v_mfma_f32_16x16x32_bf16 v[152:155], v[204:207], v[56:59], v[152:155]
    buffer_load_dwordx4 v1, s[24:27], s51 offen offset:0 lds
    v_max_f32 v69, 0, v69
    v_mfma_f32_16x16x32_bf16 v[156:159], v[204:207], v[60:63], v[156:159]
    v_max_f32 v70, 0, v70
    s_waitcnt lgkmcnt(4)
    v_mfma_f32_16x16x32_bf16 v[96:99], v[208:211], v[32:35], v[96:99]
    ds_read_b64_tr_b16 v[196:197], v11 offset:12288
    v_max_f32 v71, 0, v71
    v_mfma_f32_16x16x32_bf16 v[100:103], v[208:211], v[36:39], v[100:103]
    ds_read_b64_tr_b16 v[198:199], v11 offset:12800
    v_mul_f32 v68, v68, v132
    v_mfma_f32_16x16x32_bf16 v[104:107], v[208:211], v[40:43], v[104:107]
    v_mul_f32 v69, v69, v133
    v_mul_f32 v70, v70, v134
    v_mfma_f32_16x16x32_bf16 v[108:111], v[208:211], v[44:47], v[108:111]
    v_mul_f32 v71, v71, v135
    s_waitcnt lgkmcnt(4)
    v_mfma_f32_16x16x32_bf16 v[160:163], v[212:215], v[32:35], v[160:163]
    ds_read_b64_tr_b16 v[200:201], v12 offset:0
    buffer_load_dwordx4 v2, s[24:27], s51 offen offset:1024 lds
    v_mfma_f32_16x16x32_bf16 v[164:167], v[212:215], v[36:39], v[164:167]
    ds_read_b64_tr_b16 v[202:203], v12 offset:512
    v_cvt_pk_bf16_f32 v228, v68, v69
    v_mfma_f32_16x16x32_bf16 v[168:171], v[212:215], v[40:43], v[168:171]
    v_cvt_pk_bf16_f32 v229, v70, v71
    v_max_f32 v72, 0, v72
    v_mfma_f32_16x16x32_bf16 v[172:175], v[212:215], v[44:47], v[172:175]
    v_max_f32 v73, 0, v73
    s_waitcnt lgkmcnt(4)
    v_mfma_f32_16x16x32_bf16 v[96:99], v[192:195], v[48:51], v[96:99]
    ds_read_b64_tr_b16 v[204:205], v12 offset:8192
    v_max_f32 v74, 0, v74
    v_mfma_f32_16x16x32_bf16 v[100:103], v[192:195], v[52:55], v[100:103]
    ds_read_b64_tr_b16 v[206:207], v12 offset:8704
    v_max_f32 v75, 0, v75
    v_mfma_f32_16x16x32_bf16 v[104:107], v[192:195], v[56:59], v[104:107]
    buffer_load_dwordx4 v3, s[24:27], s51 offen offset:2048 lds
    v_mul_f32 v72, v72, v136
    v_mfma_f32_16x16x32_bf16 v[108:111], v[192:195], v[60:63], v[108:111]
    v_mul_f32 v73, v73, v137
    s_waitcnt lgkmcnt(4)
    v_mfma_f32_16x16x32_bf16 v[160:163], v[196:199], v[48:51], v[160:163]
    ds_read_b64_tr_b16 v[208:209], v12 offset:4096
    v_mul_f32 v74, v74, v138
    v_mfma_f32_16x16x32_bf16 v[164:167], v[196:199], v[52:55], v[164:167]
    ds_read_b64_tr_b16 v[210:211], v12 offset:4608
    v_mul_f32 v75, v75, v139
    v_mfma_f32_16x16x32_bf16 v[168:171], v[196:199], v[56:59], v[168:171]
    v_cvt_pk_bf16_f32 v232, v72, v73
    v_cvt_pk_bf16_f32 v233, v74, v75
    v_mfma_f32_16x16x32_bf16 v[172:175], v[196:199], v[60:63], v[172:175]
    v_max_f32 v76, 0, v76
    s_waitcnt lgkmcnt(4)
    v_mfma_f32_16x16x32_bf16 v[112:115], v[200:203], v[32:35], v[112:115]
    ds_read_b64_tr_b16 v[212:213], v12 offset:12288
    buffer_load_dwordx4 v4, s[24:27], s51 offen offset:3072 lds
    v_mfma_f32_16x16x32_bf16 v[116:119], v[200:203], v[36:39], v[116:119]
    ds_read_b64_tr_b16 v[214:215], v12 offset:12800
    s_mul_i32 s51, s74, 4608
    s_add_u32 s51, s51, s48
    s_add_u32 s51, s51, 128
    v_mfma_f32_16x16x32_bf16 v[120:123], v[200:203], v[40:43], v[120:123]
    s_add_u32 m0, s52, 18432
    v_max_f32 v77, 0, v77
    v_mfma_f32_16x16x32_bf16 v[124:127], v[200:203], v[44:47], v[124:127]
    buffer_load_dwordx4 v1, s[24:27], s51 offen offset:0 lds
    s_waitcnt lgkmcnt(4)
    v_mfma_f32_16x16x32_bf16 v[176:179], v[204:207], v[32:35], v[176:179]
    s_waitcnt vmcnt(13)
    s_barrier
    v_add_u32 v9, 73728, v13
    ds_read_b64_tr_b16 v[192:193], v9 offset:0
    v_max_f32 v78, 0, v78
    v_mfma_f32_16x16x32_bf16 v[180:183], v[204:207], v[36:39], v[180:183]
    ds_read_b64_tr_b16 v[194:195], v9 offset:256
    v_max_f32 v79, 0, v79
    v_mfma_f32_16x16x32_bf16 v[184:187], v[204:207], v[40:43], v[184:187]
    v_mul_f32 v76, v76, v140
    v_mul_f32 v77, v77, v141
    v_mfma_f32_16x16x32_bf16 v[188:191], v[204:207], v[44:47], v[188:191]
    v_mul_f32 v78, v78, v142
    s_waitcnt lgkmcnt(4)
    v_mfma_f32_16x16x32_bf16 v[112:115], v[208:211], v[48:51], v[112:115]
    ds_read_b64_tr_b16 v[196:197], v9 offset:1024
    v_mul_f32 v79, v79, v143
    v_mfma_f32_16x16x32_bf16 v[116:119], v[208:211], v[52:55], v[116:119]
    ds_read_b64_tr_b16 v[198:199], v9 offset:1280
    buffer_load_dwordx4 v2, s[24:27], s51 offen offset:1024 lds
    v_mfma_f32_16x16x32_bf16 v[120:123], v[208:211], v[56:59], v[120:123]
    v_cvt_pk_bf16_f32 v236, v76, v77
    v_cvt_pk_bf16_f32 v237, v78, v79
    v_mfma_f32_16x16x32_bf16 v[124:127], v[208:211], v[60:63], v[124:127]
    v_max_f32 v80, 0, v80
    s_waitcnt lgkmcnt(4)
    v_mfma_f32_16x16x32_bf16 v[176:179], v[212:215], v[48:51], v[176:179]
    ds_read_b64_tr_b16 v[200:201], v9 offset:2048
    v_max_f32 v81, 0, v81
    v_mfma_f32_16x16x32_bf16 v[180:183], v[212:215], v[52:55], v[180:183]
    ds_read_b64_tr_b16 v[202:203], v9 offset:2304
    v_max_f32 v82, 0, v82
    v_mfma_f32_16x16x32_bf16 v[184:187], v[212:215], v[56:59], v[184:187]
    v_max_f32 v83, 0, v83
    v_mul_f32 v80, v80, v144
    v_mfma_f32_16x16x32_bf16 v[188:191], v[212:215], v[60:63], v[188:191]
    buffer_load_dwordx4 v3, s[24:27], s51 offen offset:2048 lds
    s_waitcnt lgkmcnt(4)
    v_mfma_f32_16x16x32_bf16 v[64:67], v[192:195], a[0:3], 0
    ds_read_b64_tr_b16 v[204:205], v9 offset:3072
    v_mul_f32 v81, v81, v145
    v_mfma_f32_16x16x32_bf16 v[68:71], v[192:195], a[4:7], 0
    ds_read_b64_tr_b16 v[206:207], v9 offset:3328
    v_mul_f32 v82, v82, v146
    v_mfma_f32_16x16x32_bf16 v[72:75], v[192:195], a[8:11], 0
    v_mul_f32 v83, v83, v147
    v_cvt_pk_bf16_f32 v226, v80, v81
    v_mfma_f32_16x16x32_bf16 v[76:79], v[192:195], a[12:15], 0
    v_cvt_pk_bf16_f32 v227, v82, v83
    s_waitcnt lgkmcnt(4)
    v_mfma_f32_16x16x32_bf16 v[128:131], v[196:199], a[0:3], 0
    ds_read_b64_tr_b16 v[208:209], v9 offset:4096
    v_max_f32 v84, 0, v84
    v_mfma_f32_16x16x32_bf16 v[132:135], v[196:199], a[4:7], 0
    ds_read_b64_tr_b16 v[210:211], v9 offset:4352
    buffer_load_dwordx4 v4, s[24:27], s51 offen offset:3072 lds
    v_mfma_f32_16x16x32_bf16 v[136:139], v[196:199], a[8:11], 0
    s_mul_i32 s51, s75, 4608
    s_add_u32 s51, s51, s48
    s_add_u32 s51, s51, 128
    v_max_f32 v85, 0, v85
    v_mfma_f32_16x16x32_bf16 v[140:143], v[196:199], a[12:15], 0
    s_add_u32 m0, s52, 36864
    s_waitcnt lgkmcnt(4)
    v_mfma_f32_16x16x32_bf16 v[64:67], v[200:203], a[16:19], v[64:67]
    ds_read_b64_tr_b16 v[212:213], v9 offset:5120
    buffer_load_dwordx4 v1, s[24:27], s51 offen offset:0 lds
    v_mfma_f32_16x16x32_bf16 v[68:71], v[200:203], a[20:23], v[68:71]
    ds_read_b64_tr_b16 v[214:215], v9 offset:5376
    v_max_f32 v86, 0, v86
    v_mfma_f32_16x16x32_bf16 v[72:75], v[200:203], a[24:27], v[72:75]
    v_max_f32 v87, 0, v87
    v_mul_f32 v84, v84, v148
    v_mfma_f32_16x16x32_bf16 v[76:79], v[200:203], a[28:31], v[76:79]
    v_mul_f32 v85, v85, v149
    s_waitcnt lgkmcnt(4)
    v_mfma_f32_16x16x32_bf16 v[128:131], v[204:207], a[16:19], v[128:131]
    ds_read_b64_tr_b16 v[192:193], v9 offset:6144
    v_mul_f32 v86, v86, v150
    v_mfma_f32_16x16x32_bf16 v[132:135], v[204:207], a[20:23], v[132:135]
    ds_read_b64_tr_b16 v[194:195], v9 offset:6400
    v_mul_f32 v87, v87, v151
    v_mfma_f32_16x16x32_bf16 v[136:139], v[204:207], a[24:27], v[136:139]
    buffer_load_dwordx4 v2, s[24:27], s51 offen offset:1024 lds
    v_cvt_pk_bf16_f32 v230, v84, v85
    v_mfma_f32_16x16x32_bf16 v[140:143], v[204:207], a[28:31], v[140:143]
    v_cvt_pk_bf16_f32 v231, v86, v87
    s_waitcnt lgkmcnt(4)
    v_mfma_f32_16x16x32_bf16 v[64:67], v[208:211], a[32:35], v[64:67]
    ds_read_b64_tr_b16 v[196:197], v9 offset:7168
    v_max_f32 v88, 0, v88
    v_mfma_f32_16x16x32_bf16 v[68:71], v[208:211], a[36:39], v[68:71]
    ds_read_b64_tr_b16 v[198:199], v9 offset:7424
    v_max_f32 v89, 0, v89
    v_mfma_f32_16x16x32_bf16 v[72:75], v[208:211], a[40:43], v[72:75]
    v_max_f32 v90, 0, v90
    v_max_f32 v91, 0, v91
    v_mfma_f32_16x16x32_bf16 v[76:79], v[208:211], a[44:47], v[76:79]
    v_mul_f32 v88, v88, v152
    s_waitcnt lgkmcnt(4)
    v_mfma_f32_16x16x32_bf16 v[128:131], v[212:215], a[32:35], v[128:131]
    ds_read_b64_tr_b16 v[200:201], v9 offset:8192
    buffer_load_dwordx4 v3, s[24:27], s51 offen offset:2048 lds
    v_mfma_f32_16x16x32_bf16 v[132:135], v[212:215], a[36:39], v[132:135]
    ds_read_b64_tr_b16 v[202:203], v9 offset:8448
    v_mul_f32 v89, v89, v153
    v_mfma_f32_16x16x32_bf16 v[136:139], v[212:215], a[40:43], v[136:139]
    v_mul_f32 v90, v90, v154
    v_mul_f32 v91, v91, v155
    v_mfma_f32_16x16x32_bf16 v[140:143], v[212:215], a[44:47], v[140:143]
    v_cvt_pk_bf16_f32 v234, v88, v89
    s_waitcnt lgkmcnt(4)
    v_mfma_f32_16x16x32_bf16 v[64:67], v[192:195], a[48:51], v[64:67]
    ds_read_b64_tr_b16 v[204:205], v9 offset:9216
    v_cvt_pk_bf16_f32 v235, v90, v91
    v_mfma_f32_16x16x32_bf16 v[68:71], v[192:195], a[52:55], v[68:71]
    ds_read_b64_tr_b16 v[206:207], v9 offset:9472
    v_max_f32 v92, 0, v92
    v_mfma_f32_16x16x32_bf16 v[72:75], v[192:195], a[56:59], v[72:75]
    buffer_load_dwordx4 v4, s[24:27], s51 offen offset:3072 lds
    v_max_f32 v93, 0, v93
    v_mfma_f32_16x16x32_bf16 v[76:79], v[192:195], a[60:63], v[76:79]
    s_mul_i32 s51, s76, 4608
    s_add_u32 s51, s51, s48
    s_add_u32 s51, s51, 128
    s_waitcnt lgkmcnt(4)
    v_mfma_f32_16x16x32_bf16 v[128:131], v[196:199], a[48:51], v[128:131]
    ds_read_b64_tr_b16 v[208:209], v9 offset:10240
    s_add_u32 m0, s52, 55296
    v_mfma_f32_16x16x32_bf16 v[132:135], v[196:199], a[52:55], v[132:135]
    ds_read_b64_tr_b16 v[210:211], v9 offset:10496
    buffer_load_dwordx4 v1, s[24:27], s51 offen offset:0 lds
    v_mfma_f32_16x16x32_bf16 v[136:139], v[196:199], a[56:59], v[136:139]
    v_max_f32 v94, 0, v94
    v_max_f32 v95, 0, v95
    v_mfma_f32_16x16x32_bf16 v[140:143], v[196:199], a[60:63], v[140:143]
    v_mul_f32 v92, v92, v156
    s_waitcnt lgkmcnt(4)
    v_mfma_f32_16x16x32_bf16 v[64:67], v[200:203], a[64:67], v[64:67]
    ds_read_b64_tr_b16 v[212:213], v9 offset:11264
    v_mul_f32 v93, v93, v157
    v_mfma_f32_16x16x32_bf16 v[68:71], v[200:203], a[68:71], v[68:71]
    ds_read_b64_tr_b16 v[214:215], v9 offset:11520
    v_mul_f32 v94, v94, v158
    v_mfma_f32_16x16x32_bf16 v[72:75], v[200:203], a[72:75], v[72:75]
    v_mul_f32 v95, v95, v159
    v_cvt_pk_bf16_f32 v238, v92, v93
    v_mfma_f32_16x16x32_bf16 v[76:79], v[200:203], a[76:79], v[76:79]
    buffer_load_dwordx4 v2, s[24:27], s51 offen offset:1024 lds
    s_waitcnt lgkmcnt(4)
    v_mfma_f32_16x16x32_bf16 v[128:131], v[204:207], a[64:67], v[128:131]
    ds_read_b64_tr_b16 v[192:193], v9 offset:12288
    v_cvt_pk_bf16_f32 v239, v94, v95
    v_mfma_f32_16x16x32_bf16 v[132:135], v[204:207], a[68:71], v[132:135]
    ds_read_b64_tr_b16 v[194:195], v9 offset:12544
    v_max_f32 v96, 0, v96
    v_mfma_f32_16x16x32_bf16 v[136:139], v[204:207], a[72:75], v[136:139]
    v_max_f32 v97, 0, v97
    v_max_f32 v98, 0, v98
    v_mfma_f32_16x16x32_bf16 v[140:143], v[204:207], a[76:79], v[140:143]
    v_max_f32 v99, 0, v99
    s_waitcnt lgkmcnt(4)
    v_mfma_f32_16x16x32_bf16 v[64:67], v[208:211], a[80:83], v[64:67]
    ds_read_b64_tr_b16 v[196:197], v9 offset:13312
    v_mul_f32 v96, v96, v160
    v_mfma_f32_16x16x32_bf16 v[68:71], v[208:211], a[84:87], v[68:71]
    ds_read_b64_tr_b16 v[198:199], v9 offset:13568
    buffer_load_dwordx4 v3, s[24:27], s51 offen offset:2048 lds
    v_mfma_f32_16x16x32_bf16 v[72:75], v[208:211], a[88:91], v[72:75]
    v_mul_f32 v97, v97, v161
    v_mul_f32 v98, v98, v162
    v_mfma_f32_16x16x32_bf16 v[76:79], v[208:211], a[92:95], v[76:79]
    v_mul_f32 v99, v99, v163
    s_waitcnt lgkmcnt(4)
    v_mfma_f32_16x16x32_bf16 v[128:131], v[212:215], a[80:83], v[128:131]
    ds_read_b64_tr_b16 v[200:201], v9 offset:14336
    s_add_u32 s66, s13, 0
    buffer_load_dword v216, v218, s[28:31], s66 offen
    v_mfma_f32_16x16x32_bf16 v[132:135], v[212:215], a[84:87], v[132:135]
    ds_read_b64_tr_b16 v[202:203], v9 offset:14592
    v_cvt_pk_bf16_f32 v240, v96, v97
    v_mfma_f32_16x16x32_bf16 v[136:139], v[212:215], a[88:91], v[136:139]
    v_cvt_pk_bf16_f32 v241, v98, v99
    v_max_f32 v100, 0, v100
    v_mfma_f32_16x16x32_bf16 v[140:143], v[212:215], a[92:95], v[140:143]
    buffer_load_dwordx4 v4, s[24:27], s51 offen offset:3072 lds
    s_waitcnt lgkmcnt(4)
    v_mfma_f32_16x16x32_bf16 v[64:67], v[192:195], a[96:99], v[64:67]
    ds_read_b64_tr_b16 v[204:205], v9 offset:15360
    v_max_f32 v101, 0, v101
    v_mfma_f32_16x16x32_bf16 v[68:71], v[192:195], a[100:103], v[68:71]
    ds_read_b64_tr_b16 v[206:207], v9 offset:15616
    v_max_f32 v102, 0, v102
    v_mfma_f32_16x16x32_bf16 v[72:75], v[192:195], a[104:107], v[72:75]
    v_max_f32 v103, 0, v103
    v_mul_f32 v100, v100, v164
    v_mfma_f32_16x16x32_bf16 v[76:79], v[192:195], a[108:111], v[76:79]
    v_mul_f32 v101, v101, v165
    s_waitcnt lgkmcnt(4)
    v_mfma_f32_16x16x32_bf16 v[128:131], v[196:199], a[96:99], v[128:131]
    ds_read_b64_tr_b16 v[208:209], v9 offset:16384
    v_mul_f32 v102, v102, v166
    v_mfma_f32_16x16x32_bf16 v[132:135], v[196:199], a[100:103], v[132:135]
    ds_read_b64_tr_b16 v[210:211], v9 offset:16640
    v_mul_f32 v103, v103, v167
    v_mfma_f32_16x16x32_bf16 v[136:139], v[196:199], a[104:107], v[136:139]
    s_add_u32 s66, s13, 768
    buffer_load_dword v216, v218, s[28:31], s66 offen
    v_cvt_pk_bf16_f32 v244, v100, v101
    v_mfma_f32_16x16x32_bf16 v[140:143], v[196:199], a[108:111], v[140:143]
    v_cvt_pk_bf16_f32 v245, v102, v103
    s_waitcnt lgkmcnt(4)
    v_mfma_f32_16x16x32_bf16 v[64:67], v[200:203], a[112:115], v[64:67]
    ds_read_b64_tr_b16 v[212:213], v9 offset:17408
    v_max_f32 v104, 0, v104
    v_mfma_f32_16x16x32_bf16 v[68:71], v[200:203], a[116:119], v[68:71]
    ds_read_b64_tr_b16 v[214:215], v9 offset:17664
    v_max_f32 v105, 0, v105
    v_mfma_f32_16x16x32_bf16 v[72:75], v[200:203], a[120:123], v[72:75]
    v_max_f32 v106, 0, v106
    v_max_f32 v107, 0, v107
    v_mfma_f32_16x16x32_bf16 v[76:79], v[200:203], a[124:127], v[76:79]
    v_mul_f32 v104, v104, v168
    s_waitcnt lgkmcnt(4)
    v_mfma_f32_16x16x32_bf16 v[128:131], v[204:207], a[112:115], v[128:131]
    ds_read_b64_tr_b16 v[192:193], v9 offset:18432
    v_mul_f32 v105, v105, v169
    v_mfma_f32_16x16x32_bf16 v[132:135], v[204:207], a[116:119], v[132:135]
    ds_read_b64_tr_b16 v[194:195], v9 offset:18688
    v_mul_f32 v106, v106, v170
    v_mfma_f32_16x16x32_bf16 v[136:139], v[204:207], a[120:123], v[136:139]
    v_mul_f32 v107, v107, v171
    v_cvt_pk_bf16_f32 v248, v104, v105
    v_mfma_f32_16x16x32_bf16 v[140:143], v[204:207], a[124:127], v[140:143]
    v_cvt_pk_bf16_f32 v249, v106, v107
    s_waitcnt lgkmcnt(4)
    v_mfma_f32_16x16x32_bf16 v[64:67], v[208:211], a[128:131], v[64:67]
    ds_read_b64_tr_b16 v[196:197], v9 offset:19456
    s_add_u32 s66, s13, 1536
    buffer_load_dword v216, v218, s[28:31], s66 offen
    v_mfma_f32_16x16x32_bf16 v[68:71], v[208:211], a[132:135], v[68:71]
    ds_read_b64_tr_b16 v[198:199], v9 offset:19712
    v_max_f32 v108, 0, v108
    v_mfma_f32_16x16x32_bf16 v[72:75], v[208:211], a[136:139], v[72:75]
    v_max_f32 v109, 0, v109
    v_max_f32 v110, 0, v110
    v_mfma_f32_16x16x32_bf16 v[76:79], v[208:211], a[140:143], v[76:79]
    v_max_f32 v111, 0, v111
    s_waitcnt lgkmcnt(4)
    v_mfma_f32_16x16x32_bf16 v[128:131], v[212:215], a[128:131], v[128:131]
    s_waitcnt vmcnt(23)
    s_barrier
    v_add_u32 v9, 73728, v13
    ds_read_b64_tr_b16 v[200:201], v9 offset:20480
    v_mul_f32 v108, v108, v172
    v_mfma_f32_16x16x32_bf16 v[132:135], v[212:215], a[132:135], v[132:135]
    ds_read_b64_tr_b16 v[202:203], v9 offset:20736
    s_mul_i32 s51, s77, 4608
    s_add_u32 s51, s51, s48
    s_add_u32 s51, s51, 128
    v_mfma_f32_16x16x32_bf16 v[136:139], v[212:215], a[136:139], v[136:139]
    s_add_u32 m0, s52, 0
    v_mul_f32 v109, v109, v173
    v_mfma_f32_16x16x32_bf16 v[140:143], v[212:215], a[140:143], v[140:143]
    buffer_load_dwordx4 v1, s[24:27], s51 offen offset:0 lds
    s_waitcnt lgkmcnt(4)
    v_mfma_f32_16x16x32_bf16 v[64:67], v[192:195], a[144:147], v[64:67]
    ds_read_b64_tr_b16 v[204:205], v9 offset:21504
    v_mul_f32 v110, v110, v174
    v_mfma_f32_16x16x32_bf16 v[68:71], v[192:195], a[148:151], v[68:71]
    ds_read_b64_tr_b16 v[206:207], v9 offset:21760
    v_mul_f32 v111, v111, v175
    v_mfma_f32_16x16x32_bf16 v[72:75], v[192:195], a[152:155], v[72:75]
    s_add_u32 s66, s13, 2304
    buffer_load_dword v216, v218, s[28:31], s66 offen
    v_cvt_pk_bf16_f32 v252, v108, v109
    v_mfma_f32_16x16x32_bf16 v[76:79], v[192:195], a[156:159], v[76:79]
    v_cvt_pk_bf16_f32 v253, v110, v111
    s_waitcnt lgkmcnt(4)
    v_mfma_f32_16x16x32_bf16 v[128:131], v[196:199], a[144:147], v[128:131]
    ds_read_b64_tr_b16 v[208:209], v9 offset:22528
    v_max_f32 v112, 0, v112
    v_mfma_f32_16x16x32_bf16 v[132:135], v[196:199], a[148:151], v[132:135]
    ds_read_b64_tr_b16 v[210:211], v9 offset:22784
    buffer_load_dwordx4 v2, s[24:27], s51 offen offset:1024 lds
    v_mfma_f32_16x16x32_bf16 v[136:139], v[196:199], a[152:155], v[136:139]
    v_max_f32 v113, 0, v113
    v_max_f32 v114, 0, v114
    v_mfma_f32_16x16x32_bf16 v[140:143], v[196:199], a[156:159], v[140:143]
    v_max_f32 v115, 0, v115
    s_waitcnt lgkmcnt(4)
    v_mfma_f32_16x16x32_bf16 v[64:67], v[200:203], a[160:163], v[64:67]
    ds_read_b64_tr_b16 v[212:213], v9 offset:23552
    v_mul_f32 v112, v112, v176
    v_mfma_f32_16x16x32_bf16 v[68:71], v[200:203], a[164:167], v[68:71]
    ds_read_b64_tr_b16 v[214:215], v9 offset:23808
    v_mul_f32 v113, v113, v177
    v_mfma_f32_16x16x32_bf16 v[72:75], v[200:203], a[168:171], v[72:75]
    v_mul_f32 v114, v114, v178
    v_mul_f32 v115, v115, v179
    v_mfma_f32_16x16x32_bf16 v[76:79], v[200:203], a[172:175], v[76:79]
    buffer_load_dwordx4 v3, s[24:27], s51 offen offset:2048 lds
    s_waitcnt lgkmcnt(4)
    v_mfma_f32_16x16x32_bf16 v[128:131], v[204:207], a[160:163], v[128:131]
    ds_read_b64_tr_b16 v[192:193], v9 offset:24576
    s_add_u32 s66, s13, 3072
    buffer_load_dword v216, v218, s[28:31], s66 offen
    v_mfma_f32_16x16x32_bf16 v[132:135], v[204:207], a[164:167], v[132:135]
    ds_read_b64_tr_b16 v[194:195], v9 offset:24832
    v_cvt_pk_bf16_f32 v242, v112, v113
    v_mfma_f32_16x16x32_bf16 v[136:139], v[204:207], a[168:171], v[136:139]
    v_cvt_pk_bf16_f32 v243, v114, v115
    v_max_f32 v116, 0, v116
    v_mfma_f32_16x16x32_bf16 v[140:143], v[204:207], a[172:175], v[140:143]
    v_max_f32 v117, 0, v117
    s_waitcnt lgkmcnt(4)
    v_mfma_f32_16x16x32_bf16 v[64:67], v[208:211], a[176:179], v[64:67]
    ds_read_b64_tr_b16 v[196:197], v9 offset:25600
    v_max_f32 v118, 0, v118
    v_mfma_f32_16x16x32_bf16 v[68:71], v[208:211], a[180:183], v[68:71]
    ds_read_b64_tr_b16 v[198:199], v9 offset:25856
    buffer_load_dwordx4 v4, s[24:27], s51 offen offset:3072 lds
    v_mfma_f32_16x16x32_bf16 v[72:75], v[208:211], a[184:187], v[72:75]
    v_max_f32 v119, 0, v119
    v_mul_f32 v116, v116, v180
    v_mfma_f32_16x16x32_bf16 v[76:79], v[208:211], a[188:191], v[76:79]
    v_mul_f32 v117, v117, v181
    s_waitcnt lgkmcnt(4)
    v_mfma_f32_16x16x32_bf16 v[128:131], v[212:215], a[176:179], v[128:131]
    ds_read_b64_tr_b16 v[200:201], v9 offset:26624
    v_mul_f32 v118, v118, v182
    v_mfma_f32_16x16x32_bf16 v[132:135], v[212:215], a[180:183], v[132:135]
    ds_read_b64_tr_b16 v[202:203], v9 offset:26880
    v_mul_f32 v119, v119, v183
    v_mfma_f32_16x16x32_bf16 v[136:139], v[212:215], a[184:187], v[136:139]
    s_add_u32 s66, s13, 3840
    buffer_load_dword v216, v218, s[28:31], s66 offen
    v_cvt_pk_bf16_f32 v246, v116, v117
    v_mfma_f32_16x16x32_bf16 v[140:143], v[212:215], a[188:191], v[140:143]
    v_cvt_pk_bf16_f32 v247, v118, v119
    s_waitcnt lgkmcnt(4)
    v_mfma_f32_16x16x32_bf16 v[64:67], v[192:195], a[192:195], v[64:67]
    ds_read_b64_tr_b16 v[204:205], v9 offset:27648
    v_max_f32 v120, 0, v120
    v_mfma_f32_16x16x32_bf16 v[68:71], v[192:195], a[196:199], v[68:71]
    ds_read_b64_tr_b16 v[206:207], v9 offset:27904
    v_max_f32 v121, 0, v121
    v_mfma_f32_16x16x32_bf16 v[72:75], v[192:195], a[200:203], v[72:75]
    v_max_f32 v122, 0, v122
    v_max_f32 v123, 0, v123
    v_mfma_f32_16x16x32_bf16 v[76:79], v[192:195], a[204:207], v[76:79]
    v_mul_f32 v120, v120, v184
    s_waitcnt lgkmcnt(4)
    v_mfma_f32_16x16x32_bf16 v[128:131], v[196:199], a[192:195], v[128:131]
    ds_read_b64_tr_b16 v[208:209], v9 offset:28672
    v_mul_f32 v121, v121, v185
    v_mfma_f32_16x16x32_bf16 v[132:135], v[196:199], a[196:199], v[132:135]
    ds_read_b64_tr_b16 v[210:211], v9 offset:28928
    v_mul_f32 v122, v122, v186
    v_mfma_f32_16x16x32_bf16 v[136:139], v[196:199], a[200:203], v[136:139]
    v_mul_f32 v123, v123, v187
    v_cvt_pk_bf16_f32 v250, v120, v121
    v_mfma_f32_16x16x32_bf16 v[140:143], v[196:199], a[204:207], v[140:143]
    v_cvt_pk_bf16_f32 v251, v122, v123
    s_waitcnt lgkmcnt(4)
    v_mfma_f32_16x16x32_bf16 v[64:67], v[200:203], a[208:211], v[64:67]
    ds_read_b64_tr_b16 v[212:213], v9 offset:29696
    s_add_u32 s66, s13, 4608
    buffer_load_dword v216, v218, s[28:31], s66 offen
    v_mfma_f32_16x16x32_bf16 v[68:71], v[200:203], a[212:215], v[68:71]
    ds_read_b64_tr_b16 v[214:215], v9 offset:29952
    v_max_f32 v124, 0, v124
    v_mfma_f32_16x16x32_bf16 v[72:75], v[200:203], a[216:219], v[72:75]
    v_max_f32 v125, 0, v125
    v_max_f32 v126, 0, v126
    v_mfma_f32_16x16x32_bf16 v[76:79], v[200:203], a[220:223], v[76:79]
    v_max_f32 v127, 0, v127
    s_waitcnt lgkmcnt(4)
    v_mfma_f32_16x16x32_bf16 v[128:131], v[204:207], a[208:211], v[128:131]
    ds_read_b64_tr_b16 v[192:193], v9 offset:30720
    v_mul_f32 v124, v124, v188
    v_mfma_f32_16x16x32_bf16 v[132:135], v[204:207], a[212:215], v[132:135]
    ds_read_b64_tr_b16 v[194:195], v9 offset:30976
    v_mul_f32 v125, v125, v189
    v_mfma_f32_16x16x32_bf16 v[136:139], v[204:207], a[216:219], v[136:139]
    v_mul_f32 v126, v126, v190
    v_mul_f32 v127, v127, v191
    v_mfma_f32_16x16x32_bf16 v[140:143], v[204:207], a[220:223], v[140:143]
    v_cvt_pk_bf16_f32 v254, v124, v125
    s_waitcnt lgkmcnt(4)
    v_mfma_f32_16x16x32_bf16 v[64:67], v[208:211], a[224:227], v[64:67]
    ds_read_b64_tr_b16 v[196:197], v9 offset:31744
    v_cvt_pk_bf16_f32 v255, v126, v127
    v_mfma_f32_16x16x32_bf16 v[68:71], v[208:211], a[228:231], v[68:71]
    ds_read_b64_tr_b16 v[198:199], v9 offset:32000
    v_mfma_f32_16x16x32_bf16 v[72:75], v[208:211], a[232:235], v[72:75]
    v_mfma_f32_16x16x32_bf16 v[76:79], v[208:211], a[236:239], v[76:79]
    s_waitcnt lgkmcnt(4)
    v_mfma_f32_16x16x32_bf16 v[128:131], v[212:215], a[224:227], v[128:131]
    ds_read_b64_tr_b16 v[200:201], v9 offset:32768
    v_mfma_f32_16x16x32_bf16 v[132:135], v[212:215], a[228:231], v[132:135]
    ds_read_b64_tr_b16 v[202:203], v9 offset:33024
    v_mfma_f32_16x16x32_bf16 v[136:139], v[212:215], a[232:235], v[136:139]
    v_mfma_f32_16x16x32_bf16 v[140:143], v[212:215], a[236:239], v[140:143]
    s_waitcnt lgkmcnt(4)
    v_mfma_f32_16x16x32_bf16 v[64:67], v[192:195], a[240:243], v[64:67]
    ds_read_b64_tr_b16 v[204:205], v9 offset:33792
    v_mfma_f32_16x16x32_bf16 v[68:71], v[192:195], a[244:247], v[68:71]
    ds_read_b64_tr_b16 v[206:207], v9 offset:34048
    v_mfma_f32_16x16x32_bf16 v[72:75], v[192:195], a[248:251], v[72:75]
    v_mfma_f32_16x16x32_bf16 v[76:79], v[192:195], a[252:255], v[76:79]
    s_waitcnt lgkmcnt(4)
    v_mfma_f32_16x16x32_bf16 v[128:131], v[196:199], a[240:243], v[128:131]
    ds_read_b64_tr_b16 v[208:209], v9 offset:34816
    v_mfma_f32_16x16x32_bf16 v[132:135], v[196:199], a[244:247], v[132:135]
    ds_read_b64_tr_b16 v[210:211], v9 offset:35072
    v_mfma_f32_16x16x32_bf16 v[136:139], v[196:199], a[248:251], v[136:139]
    v_mfma_f32_16x16x32_bf16 v[140:143], v[196:199], a[252:255], v[140:143]
    s_waitcnt lgkmcnt(4)
    v_mfma_f32_16x16x32_bf16 v[64:67], v[200:203], v[32:35], v[64:67]
    ds_read_b64_tr_b16 v[212:213], v9 offset:35840
    v_mfma_f32_16x16x32_bf16 v[68:71], v[200:203], v[36:39], v[68:71]
    ds_read_b64_tr_b16 v[214:215], v9 offset:36096
    v_mfma_f32_16x16x32_bf16 v[72:75], v[200:203], v[40:43], v[72:75]
    v_mfma_f32_16x16x32_bf16 v[76:79], v[200:203], v[44:47], v[76:79]
    s_waitcnt lgkmcnt(4)
    v_mfma_f32_16x16x32_bf16 v[128:131], v[204:207], v[32:35], v[128:131]
    s_waitcnt vmcnt(23)
    s_barrier
    v_add_u32 v9, 110592, v5
    v_add_u32 v10, 110592, v6
    v_add_u32 v11, 110592, v7
    v_add_u32 v12, 110592, v8
    ds_read_b64_tr_b16 v[192:193], v10 offset:0
    v_mfma_f32_16x16x32_bf16 v[132:135], v[204:207], v[36:39], v[132:135]
    ds_read_b64_tr_b16 v[194:195], v10 offset:512
    s_mul_i32 s51, s78, 4608
    s_add_u32 s51, s51, s48
    s_add_u32 s51, s51, 128
    v_mfma_f32_16x16x32_bf16 v[136:139], v[204:207], v[40:43], v[136:139]
    s_add_u32 m0, s52, 73728
    v_mfma_f32_16x16x32_bf16 v[140:143], v[204:207], v[44:47], v[140:143]
    buffer_load_dwordx4 v1, s[24:27], s51 offen offset:0 lds
    s_waitcnt lgkmcnt(4)
    v_mfma_f32_16x16x32_bf16 v[64:67], v[208:211], v[48:51], v[64:67]
    ds_read_b64_tr_b16 v[196:197], v10 offset:8192
    v_mfma_f32_16x16x32_bf16 v[68:71], v[208:211], v[52:55], v[68:71]
    ds_read_b64_tr_b16 v[198:199], v10 offset:8704
    v_mfma_f32_16x16x32_bf16 v[72:75], v[208:211], v[56:59], v[72:75]
    v_mfma_f32_16x16x32_bf16 v[76:79], v[208:211], v[60:63], v[76:79]
    s_waitcnt lgkmcnt(4)
    v_mfma_f32_16x16x32_bf16 v[128:131], v[212:215], v[48:51], v[128:131]
    ds_read_b64_tr_b16 v[200:201], v10 offset:4096
    v_mfma_f32_16x16x32_bf16 v[132:135], v[212:215], v[52:55], v[132:135]
    ds_read_b64_tr_b16 v[202:203], v10 offset:4608
    v_mfma_f32_16x16x32_bf16 v[136:139], v[212:215], v[56:59], v[136:139]
    v_mfma_f32_16x16x32_bf16 v[140:143], v[212:215], v[60:63], v[140:143]
    s_waitcnt lgkmcnt(4)
    v_mfma_f32_16x16x32_bf16 v[80:83], v[192:195], a[0:3], 0
    ds_read_b64_tr_b16 v[204:205], v10 offset:12288
    v_mfma_f32_16x16x32_bf16 v[84:87], v[192:195], a[4:7], 0
    ds_read_b64_tr_b16 v[206:207], v10 offset:12800
    v_mfma_f32_16x16x32_bf16 v[88:91], v[192:195], a[8:11], 0
    v_mfma_f32_16x16x32_bf16 v[92:95], v[192:195], a[12:15], 0
    buffer_load_dwordx4 v2, s[24:27], s51 offen offset:1024 lds
    v_max_f32 v64, 0, v64
    s_waitcnt lgkmcnt(4)
    v_mfma_f32_16x16x32_bf16 v[144:147], v[196:199], a[0:3], 0
    ds_read_b64_tr_b16 v[208:209], v11 offset:0
    v_max_f32 v65, 0, v65
    v_max_f32 v66, 0, v66
    v_mfma_f32_16x16x32_bf16 v[148:151], v[196:199], a[4:7], 0
    ds_read_b64_tr_b16 v[210:211], v11 offset:512
    v_max_f32 v67, 0, v67
    v_mul_f32 v64, v64, v128
    v_mfma_f32_16x16x32_bf16 v[152:155], v[196:199], a[8:11], 0
    v_mul_f32 v65, v65, v129
    v_mul_f32 v66, v66, v130
    v_mfma_f32_16x16x32_bf16 v[156:159], v[196:199], a[12:15], 0
    v_mul_f32 v67, v67, v131
    v_cvt_pk_bf16_f32 v128, v64, v65
    s_waitcnt lgkmcnt(4)
    v_mfma_f32_16x16x32_bf16 v[80:83], v[200:203], a[16:19], v[80:83]
    ds_read_b64_tr_b16 v[212:213], v11 offset:8192
    v_cvt_pk_bf16_f32 v129, v66, v67
    v_max_f32 v68, 0, v68
    v_mfma_f32_16x16x32_bf16 v[84:87], v[200:203], a[20:23], v[84:87]
    ds_read_b64_tr_b16 v[214:215], v11 offset:8704
    v_max_f32 v69, 0, v69
    v_max_f32 v70, 0, v70
    v_mfma_f32_16x16x32_bf16 v[88:91], v[200:203], a[24:27], v[88:91]
    v_max_f32 v71, 0, v71
    v_mul_f32 v68, v68, v132
    v_mfma_f32_16x16x32_bf16 v[92:95], v[200:203], a[28:31], v[92:95]
    v_mul_f32 v69, v69, v133
    v_mul_f32 v70, v70, v134
    s_waitcnt lgkmcnt(4)
    v_mfma_f32_16x16x32_bf16 v[144:147], v[204:207], a[16:19], v[144:147]
    ds_read_b64_tr_b16 v[192:193], v11 offset:4096
    v_mul_f32 v71, v71, v135
    v_cvt_pk_bf16_f32 v132, v68, v69
    v_mfma_f32_16x16x32_bf16 v[148:151], v[204:207], a[20:23], v[148:151]
    ds_read_b64_tr_b16 v[194:195], v11 offset:4608
    v_cvt_pk_bf16_f32 v133, v70, v71
    v_max_f32 v72, 0, v72
    v_mfma_f32_16x16x32_bf16 v[152:155], v[204:207], a[24:27], v[152:155]
    v_max_f32 v73, 0, v73
    v_max_f32 v74, 0, v74
    v_mfma_f32_16x16x32_bf16 v[156:159], v[204:207], a[28:31], v[156:159]
    buffer_load_dwordx4 v3, s[24:27], s51 offen offset:2048 lds
    v_max_f32 v75, 0, v75
    s_waitcnt lgkmcnt(4)
    v_mfma_f32_16x16x32_bf16 v[96:99], v[208:211], a[0:3], 0
    ds_read_b64_tr_b16 v[196:197], v11 offset:12288
    v_mul_f32 v72, v72, v136
    v_mul_f32 v73, v73, v137
    v_mfma_f32_16x16x32_bf16 v[100:103], v[208:211], a[4:7], 0
    ds_read_b64_tr_b16 v[198:199], v11 offset:12800
    v_mul_f32 v74, v74, v138
    v_mul_f32 v75, v75, v139
    v_mfma_f32_16x16x32_bf16 v[104:107], v[208:211], a[8:11], 0
    v_cvt_pk_bf16_f32 v136, v72, v73
    v_cvt_pk_bf16_f32 v137, v74, v75
    v_mfma_f32_16x16x32_bf16 v[108:111], v[208:211], a[12:15], 0
    v_max_f32 v76, 0, v76
    v_max_f32 v77, 0, v77
    s_waitcnt lgkmcnt(4)
    v_mfma_f32_16x16x32_bf16 v[160:163], v[212:215], a[0:3], 0
    ds_read_b64_tr_b16 v[200:201], v12 offset:0
    v_max_f32 v78, 0, v78
    v_max_f32 v79, 0, v79
    v_mfma_f32_16x16x32_bf16 v[164:167], v[212:215], a[4:7], 0
    ds_read_b64_tr_b16 v[202:203], v12 offset:512
    v_mul_f32 v76, v76, v140
    v_mul_f32 v77, v77, v141
    v_mfma_f32_16x16x32_bf16 v[168:171], v[212:215], a[8:11], 0
    v_mul_f32 v78, v78, v142
    v_mul_f32 v79, v79, v143
    v_mfma_f32_16x16x32_bf16 v[172:175], v[212:215], a[12:15], 0
    v_cvt_pk_bf16_f32 v140, v76, v77
    v_cvt_pk_bf16_f32 v141, v78, v79
    s_waitcnt lgkmcnt(4)
    v_mfma_f32_16x16x32_bf16 v[96:99], v[192:195], a[16:19], v[96:99]
    ds_read_b64_tr_b16 v[204:205], v12 offset:8192
    s_add_u32 s66, s62, 0
    buffer_store_dwordx2 v[128:129], v16, s[32:35], s66 offen sc1
    v_mfma_f32_16x16x32_bf16 v[100:103], v[192:195], a[20:23], v[100:103]
    ds_read_b64_tr_b16 v[206:207], v12 offset:8704
    v_mfma_f32_16x16x32_bf16 v[104:107], v[192:195], a[24:27], v[104:107]
    s_add_u32 s66, s62, 512
    buffer_store_dwordx2 v[132:133], v16, s[32:35], s66 offen sc1
    v_mfma_f32_16x16x32_bf16 v[108:111], v[192:195], a[28:31], v[108:111]
    buffer_load_dwordx4 v4, s[24:27], s51 offen offset:3072 lds
    s_waitcnt lgkmcnt(4)
    v_mfma_f32_16x16x32_bf16 v[160:163], v[196:199], a[16:19], v[160:163]
    ds_read_b64_tr_b16 v[208:209], v12 offset:4096
    v_mfma_f32_16x16x32_bf16 v[164:167], v[196:199], a[20:23], v[164:167]
    ds_read_b64_tr_b16 v[210:211], v12 offset:4608
    s_add_u32 s66, s62, 1024
    buffer_store_dwordx2 v[136:137], v16, s[32:35], s66 offen sc1
    v_mfma_f32_16x16x32_bf16 v[168:171], v[196:199], a[24:27], v[168:171]
    v_mfma_f32_16x16x32_bf16 v[172:175], v[196:199], a[28:31], v[172:175]
    s_add_u32 s66, s62, 1536
    buffer_store_dwordx2 v[140:141], v16, s[32:35], s66 offen sc1
    s_waitcnt lgkmcnt(4)
    v_mfma_f32_16x16x32_bf16 v[112:115], v[200:203], a[0:3], 0
    ds_read_b64_tr_b16 v[212:213], v12 offset:12288
    v_mfma_f32_16x16x32_bf16 v[116:119], v[200:203], a[4:7], 0
    ds_read_b64_tr_b16 v[214:215], v12 offset:12800
    v_mfma_f32_16x16x32_bf16 v[120:123], v[200:203], a[8:11], 0
    v_mfma_f32_16x16x32_bf16 v[124:127], v[200:203], a[12:15], 0
    s_waitcnt lgkmcnt(4)
    v_mfma_f32_16x16x32_bf16 v[176:179], v[204:207], a[0:3], 0
    ds_read_b64_tr_b16 v[192:193], v9 offset:0
    v_mfma_f32_16x16x32_bf16 v[180:183], v[204:207], a[4:7], 0
    ds_read_b64_tr_b16 v[194:195], v9 offset:512
    v_mfma_f32_16x16x32_bf16 v[184:187], v[204:207], a[8:11], 0
    v_mfma_f32_16x16x32_bf16 v[188:191], v[204:207], a[12:15], 0
    s_waitcnt lgkmcnt(4)
    v_mfma_f32_16x16x32_bf16 v[112:115], v[208:211], a[16:19], v[112:115]
    ds_read_b64_tr_b16 v[196:197], v9 offset:8192
    v_mfma_f32_16x16x32_bf16 v[116:119], v[208:211], a[20:23], v[116:119]
    ds_read_b64_tr_b16 v[198:199], v9 offset:8704
    v_mfma_f32_16x16x32_bf16 v[120:123], v[208:211], a[24:27], v[120:123]
    v_mfma_f32_16x16x32_bf16 v[124:127], v[208:211], a[28:31], v[124:127]
    s_waitcnt lgkmcnt(4)
    v_mfma_f32_16x16x32_bf16 v[176:179], v[212:215], a[16:19], v[176:179]
    ds_read_b64_tr_b16 v[200:201], v9 offset:4096
    v_mfma_f32_16x16x32_bf16 v[180:183], v[212:215], a[20:23], v[180:183]
    ds_read_b64_tr_b16 v[202:203], v9 offset:4608
    v_mfma_f32_16x16x32_bf16 v[184:187], v[212:215], a[24:27], v[184:187]
    v_mfma_f32_16x16x32_bf16 v[188:191], v[212:215], a[28:31], v[188:191]
    s_waitcnt lgkmcnt(4)
    v_mfma_f32_16x16x32_bf16 v[64:67], v[192:195], a[0:3], 0
    ds_read_b64_tr_b16 v[204:205], v9 offset:12288
    v_mfma_f32_16x16x32_bf16 v[68:71], v[192:195], a[4:7], 0
    ds_read_b64_tr_b16 v[206:207], v9 offset:12800
    v_mfma_f32_16x16x32_bf16 v[72:75], v[192:195], a[8:11], 0
    v_mfma_f32_16x16x32_bf16 v[76:79], v[192:195], a[12:15], 0
    s_waitcnt lgkmcnt(4)
    v_mfma_f32_16x16x32_bf16 v[128:131], v[196:199], a[0:3], 0
    v_add_u32 v9, 129024, v5
    v_add_u32 v10, 129024, v6
    v_add_u32 v11, 129024, v7
    v_add_u32 v12, 129024, v8
    ds_read_b64_tr_b16 v[208:209], v9 offset:0
    v_mfma_f32_16x16x32_bf16 v[132:135], v[196:199], a[4:7], 0
    ds_read_b64_tr_b16 v[210:211], v9 offset:512
    v_mfma_f32_16x16x32_bf16 v[136:139], v[196:199], a[8:11], 0
    v_mfma_f32_16x16x32_bf16 v[140:143], v[196:199], a[12:15], 0
    s_waitcnt lgkmcnt(4)
    v_mfma_f32_16x16x32_bf16 v[64:67], v[200:203], a[16:19], v[64:67]
    ds_read_b64_tr_b16 v[212:213], v10 offset:0
    v_mfma_f32_16x16x32_bf16 v[68:71], v[200:203], a[20:23], v[68:71]
    ds_read_b64_tr_b16 v[214:215], v10 offset:512
    v_mfma_f32_16x16x32_bf16 v[72:75], v[200:203], a[24:27], v[72:75]
    v_mfma_f32_16x16x32_bf16 v[76:79], v[200:203], a[28:31], v[76:79]
    s_waitcnt lgkmcnt(4)
    v_mfma_f32_16x16x32_bf16 v[128:131], v[204:207], a[16:19], v[128:131]
    ds_read_b64_tr_b16 v[192:193], v11 offset:0
    v_mfma_f32_16x16x32_bf16 v[132:135], v[204:207], a[20:23], v[132:135]
    ds_read_b64_tr_b16 v[194:195], v11 offset:512
    v_mfma_f32_16x16x32_bf16 v[136:139], v[204:207], a[24:27], v[136:139]
    v_mfma_f32_16x16x32_bf16 v[140:143], v[204:207], a[28:31], v[140:143]
    s_waitcnt lgkmcnt(4)
    v_mfma_f32_16x16x32_bf16 v[64:67], v[208:211], a[32:35], v[64:67]
    ds_read_b64_tr_b16 v[196:197], v12 offset:0
    v_mfma_f32_16x16x32_bf16 v[68:71], v[208:211], a[36:39], v[68:71]
    ds_read_b64_tr_b16 v[198:199], v12 offset:512
    v_mfma_f32_16x16x32_bf16 v[72:75], v[208:211], a[40:43], v[72:75]
    v_accvgpr_write_b32 a0, v224
    v_accvgpr_write_b32 a1, v225
    v_mfma_f32_16x16x32_bf16 v[76:79], v[208:211], a[44:47], v[76:79]
    v_accvgpr_write_b32 a2, v226
    s_waitcnt lgkmcnt(4)
    v_mfma_f32_16x16x32_bf16 v[80:83], v[212:215], a[32:35], v[80:83]
    ds_read_b64_tr_b16 v[200:201], v9 offset:8192
    v_accvgpr_write_b32 a3, v227
    v_mfma_f32_16x16x32_bf16 v[84:87], v[212:215], a[36:39], v[84:87]
    ds_read_b64_tr_b16 v[202:203], v9 offset:8704
    v_accvgpr_write_b32 a4, v228
    v_mfma_f32_16x16x32_bf16 v[88:91], v[212:215], a[40:43], v[88:91]
    s_add_u32 s66, s54, 0
    buffer_store_dwordx4 v[224:227], v15, s[32:35], s66 offen sc1
    v_accvgpr_write_b32 a5, v229
    v_mfma_f32_16x16x32_bf16 v[92:95], v[212:215], a[44:47], v[92:95]
    v_accvgpr_write_b32 a6, v230
    s_waitcnt lgkmcnt(4)
    v_mfma_f32_16x16x32_bf16 v[96:99], v[192:195], a[32:35], v[96:99]
    ds_read_b64_tr_b16 v[204:205], v10 offset:8192
    v_accvgpr_write_b32 a7, v231
    v_mfma_f32_16x16x32_bf16 v[100:103], v[192:195], a[36:39], v[100:103]
    ds_read_b64_tr_b16 v[206:207], v10 offset:8704
    v_accvgpr_write_b32 a8, v232
    v_mfma_f32_16x16x32_bf16 v[104:107], v[192:195], a[40:43], v[104:107]
    v_accvgpr_write_b32 a9, v233
    v_accvgpr_write_b32 a10, v234
    v_mfma_f32_16x16x32_bf16 v[108:111], v[192:195], a[44:47], v[108:111]
    v_accvgpr_write_b32 a11, v235
    s_waitcnt lgkmcnt(4)
    v_mfma_f32_16x16x32_bf16 v[112:115], v[196:199], a[32:35], v[112:115]
    ds_read_b64_tr_b16 v[208:209], v11 offset:8192
    v_accvgpr_write_b32 a12, v236
    v_mfma_f32_16x16x32_bf16 v[116:119], v[196:199], a[36:39], v[116:119]
    ds_read_b64_tr_b16 v[210:211], v11 offset:8704
    v_accvgpr_write_b32 a13, v237
    v_mfma_f32_16x16x32_bf16 v[120:123], v[196:199], a[40:43], v[120:123]
    v_accvgpr_write_b32 a14, v238
    v_accvgpr_write_b32 a15, v239
    v_mfma_f32_16x16x32_bf16 v[124:127], v[196:199], a[44:47], v[124:127]
    v_accvgpr_write_b32 a16, v240
    s_waitcnt lgkmcnt(4)
    v_mfma_f32_16x16x32_bf16 v[128:131], v[200:203], a[32:35], v[128:131]
    ds_read_b64_tr_b16 v[212:213], v12 offset:8192
    v_accvgpr_write_b32 a17, v241
    v_mfma_f32_16x16x32_bf16 v[132:135], v[200:203], a[36:39], v[132:135]
    ds_read_b64_tr_b16 v[214:215], v12 offset:8704
    v_accvgpr_write_b32 a18, v242
    v_mfma_f32_16x16x32_bf16 v[136:139], v[200:203], a[40:43], v[136:139]
    v_accvgpr_write_b32 a19, v243
    v_accvgpr_write_b32 a20, v244
    v_mfma_f32_16x16x32_bf16 v[140:143], v[200:203], a[44:47], v[140:143]
    v_accvgpr_write_b32 a21, v245
    s_waitcnt lgkmcnt(4)
    v_mfma_f32_16x16x32_bf16 v[144:147], v[204:207], a[32:35], v[144:147]
    ds_read_b64_tr_b16 v[192:193], v9 offset:4096
    v_accvgpr_write_b32 a22, v246
    v_mfma_f32_16x16x32_bf16 v[148:151], v[204:207], a[36:39], v[148:151]
    ds_read_b64_tr_b16 v[194:195], v9 offset:4608
    v_accvgpr_write_b32 a23, v247
    v_mfma_f32_16x16x32_bf16 v[152:155], v[204:207], a[40:43], v[152:155]
    v_accvgpr_write_b32 a24, v248
    v_accvgpr_write_b32 a25, v249
    v_mfma_f32_16x16x32_bf16 v[156:159], v[204:207], a[44:47], v[156:159]
    v_accvgpr_write_b32 a26, v250
    s_waitcnt lgkmcnt(4)
    v_mfma_f32_16x16x32_bf16 v[160:163], v[208:211], a[32:35], v[160:163]
    ds_read_b64_tr_b16 v[196:197], v10 offset:4096
    v_accvgpr_write_b32 a27, v251
    v_mfma_f32_16x16x32_bf16 v[164:167], v[208:211], a[36:39], v[164:167]
    ds_read_b64_tr_b16 v[198:199], v10 offset:4608
    v_accvgpr_write_b32 a28, v252
    v_mfma_f32_16x16x32_bf16 v[168:171], v[208:211], a[40:43], v[168:171]
    s_add_u32 s66, s54, 1024
    buffer_store_dwordx4 v[228:231], v15, s[32:35], s66 offen sc1
    v_accvgpr_write_b32 a29, v253
    v_mfma_f32_16x16x32_bf16 v[172:175], v[208:211], a[44:47], v[172:175]
    v_accvgpr_write_b32 a30, v254
    s_waitcnt lgkmcnt(4)
    v_mfma_f32_16x16x32_bf16 v[176:179], v[212:215], a[32:35], v[176:179]
    ds_read_b64_tr_b16 v[200:201], v11 offset:4096
    v_accvgpr_write_b32 a31, v255
    v_mfma_f32_16x16x32_bf16 v[180:183], v[212:215], a[36:39], v[180:183]
    ds_read_b64_tr_b16 v[202:203], v11 offset:4608
    v_mfma_f32_16x16x32_bf16 v[184:187], v[212:215], a[40:43], v[184:187]
    v_mfma_f32_16x16x32_bf16 v[188:191], v[212:215], a[44:47], v[188:191]
    s_waitcnt lgkmcnt(4)
    v_mfma_f32_16x16x32_bf16 v[64:67], v[192:195], a[48:51], v[64:67]
    ds_read_b64_tr_b16 v[204:205], v12 offset:4096
    v_mfma_f32_16x16x32_bf16 v[68:71], v[192:195], a[52:55], v[68:71]
    ds_read_b64_tr_b16 v[206:207], v12 offset:4608
    v_mfma_f32_16x16x32_bf16 v[72:75], v[192:195], a[56:59], v[72:75]
    v_mfma_f32_16x16x32_bf16 v[76:79], v[192:195], a[60:63], v[76:79]
    s_waitcnt lgkmcnt(4)
    v_mfma_f32_16x16x32_bf16 v[80:83], v[196:199], a[48:51], v[80:83]
    ds_read_b64_tr_b16 v[208:209], v9 offset:12288
    v_mfma_f32_16x16x32_bf16 v[84:87], v[196:199], a[52:55], v[84:87]
    ds_read_b64_tr_b16 v[210:211], v9 offset:12800
    v_mfma_f32_16x16x32_bf16 v[88:91], v[196:199], a[56:59], v[88:91]
    v_mfma_f32_16x16x32_bf16 v[92:95], v[196:199], a[60:63], v[92:95]
    s_waitcnt lgkmcnt(4)
    v_mfma_f32_16x16x32_bf16 v[96:99], v[200:203], a[48:51], v[96:99]
    ds_read_b64_tr_b16 v[212:213], v10 offset:12288
    v_mfma_f32_16x16x32_bf16 v[100:103], v[200:203], a[52:55], v[100:103]
    ds_read_b64_tr_b16 v[214:215], v10 offset:12800
    v_mfma_f32_16x16x32_bf16 v[104:107], v[200:203], a[56:59], v[104:107]
    v_mfma_f32_16x16x32_bf16 v[108:111], v[200:203], a[60:63], v[108:111]
    s_waitcnt lgkmcnt(4)
    v_mfma_f32_16x16x32_bf16 v[112:115], v[204:207], a[48:51], v[112:115]
    ds_read_b64_tr_b16 v[192:193], v11 offset:12288
    v_mfma_f32_16x16x32_bf16 v[116:119], v[204:207], a[52:55], v[116:119]
    ds_read_b64_tr_b16 v[194:195], v11 offset:12800
    v_mfma_f32_16x16x32_bf16 v[120:123], v[204:207], a[56:59], v[120:123]
    s_add_u32 s66, s54, 2048
    buffer_store_dwordx4 v[232:235], v15, s[32:35], s66 offen sc1
    v_mfma_f32_16x16x32_bf16 v[124:127], v[204:207], a[60:63], v[124:127]
    s_waitcnt lgkmcnt(4)
    v_mfma_f32_16x16x32_bf16 v[128:131], v[208:211], a[48:51], v[128:131]
    ds_read_b64_tr_b16 v[196:197], v12 offset:12288
    v_mfma_f32_16x16x32_bf16 v[132:135], v[208:211], a[52:55], v[132:135]
    ds_read_b64_tr_b16 v[198:199], v12 offset:12800
    v_mfma_f32_16x16x32_bf16 v[136:139], v[208:211], a[56:59], v[136:139]
    v_mfma_f32_16x16x32_bf16 v[140:143], v[208:211], a[60:63], v[140:143]
    s_waitcnt lgkmcnt(4)
    v_mfma_f32_16x16x32_bf16 v[144:147], v[212:215], a[48:51], v[144:147]
    s_waitcnt vmcnt(26)
    s_barrier
    v_add_u32 v9, 18432, v5
    v_add_u32 v10, 18432, v6
    v_add_u32 v11, 18432, v7
    v_add_u32 v12, 18432, v8
    ds_read_b64_tr_b16 v[200:201], v9 offset:0
    v_mfma_f32_16x16x32_bf16 v[148:151], v[212:215], a[52:55], v[148:151]
    ds_read_b64_tr_b16 v[202:203], v9 offset:512
    s_mul_i32 s51, s79, 4608
    s_add_u32 s51, s51, s48
    s_add_u32 s51, s51, 128
    v_mfma_f32_16x16x32_bf16 v[152:155], v[212:215], a[56:59], v[152:155]
    s_add_u32 m0, s52, 92160
    v_mfma_f32_16x16x32_bf16 v[156:159], v[212:215], a[60:63], v[156:159]
    buffer_load_dwordx4 v1, s[24:27], s51 offen offset:0 lds
    s_waitcnt lgkmcnt(4)
    v_mfma_f32_16x16x32_bf16 v[160:163], v[192:195], a[48:51], v[160:163]
    ds_read_b64_tr_b16 v[204:205], v10 offset:0
    v_mfma_f32_16x16x32_bf16 v[164:167], v[192:195], a[52:55], v[164:167]
    ds_read_b64_tr_b16 v[206:207], v10 offset:512
    v_mfma_f32_16x16x32_bf16 v[168:171], v[192:195], a[56:59], v[168:171]
    v_mfma_f32_16x16x32_bf16 v[172:175], v[192:195], a[60:63], v[172:175]
    s_waitcnt lgkmcnt(4)
    v_mfma_f32_16x16x32_bf16 v[176:179], v[196:199], a[48:51], v[176:179]
    ds_read_b64_tr_b16 v[208:209], v11 offset:0
    v_mfma_f32_16x16x32_bf16 v[180:183], v[196:199], a[52:55], v[180:183]
    ds_read_b64_tr_b16 v[210:211], v11 offset:512
    v_mfma_f32_16x16x32_bf16 v[184:187], v[196:199], a[56:59], v[184:187]
    v_mfma_f32_16x16x32_bf16 v[188:191], v[196:199], a[60:63], v[188:191]
    s_waitcnt lgkmcnt(4)
    v_mfma_f32_16x16x32_bf16 v[64:67], v[200:203], a[64:67], v[64:67]
    ds_read_b64_tr_b16 v[212:213], v12 offset:0
    v_mfma_f32_16x16x32_bf16 v[68:71], v[200:203], a[68:71], v[68:71]
    ds_read_b64_tr_b16 v[214:215], v12 offset:512
    v_mfma_f32_16x16x32_bf16 v[72:75], v[200:203], a[72:75], v[72:75]
    s_add_u32 s66, s54, 3072
    buffer_store_dwordx4 v[236:239], v15, s[32:35], s66 offen sc1
    v_mfma_f32_16x16x32_bf16 v[76:79], v[200:203], a[76:79], v[76:79]
    buffer_load_dwordx4 v2, s[24:27], s51 offen offset:1024 lds
    s_waitcnt lgkmcnt(4)
    v_mfma_f32_16x16x32_bf16 v[80:83], v[204:207], a[64:67], v[80:83]
    ds_read_b64_tr_b16 v[192:193], v9 offset:8192
    v_mfma_f32_16x16x32_bf16 v[84:87], v[204:207], a[68:71], v[84:87]
    ds_read_b64_tr_b16 v[194:195], v9 offset:8704
    v_mfma_f32_16x16x32_bf16 v[88:91], v[204:207], a[72:75], v[88:91]
    v_mfma_f32_16x16x32_bf16 v[92:95], v[204:207], a[76:79], v[92:95]
    s_waitcnt lgkmcnt(4)
    v_mfma_f32_16x16x32_bf16 v[96:99], v[208:211], a[64:67], v[96:99]
    ds_read_b64_tr_b16 v[196:197], v10 offset:8192
    v_mfma_f32_16x16x32_bf16 v[100:103], v[208:211], a[68:71], v[100:103]
    ds_read_b64_tr_b16 v[198:199], v10 offset:8704
    v_mfma_f32_16x16x32_bf16 v[104:107], v[208:211], a[72:75], v[104:107]
    v_mfma_f32_16x16x32_bf16 v[108:111], v[208:211], a[76:79], v[108:111]
    s_waitcnt lgkmcnt(4)
    v_mfma_f32_16x16x32_bf16 v[112:115], v[212:215], a[64:67], v[112:115]
    ds_read_b64_tr_b16 v[200:201], v11 offset:8192
    v_mfma_f32_16x16x32_bf16 v[116:119], v[212:215], a[68:71], v[116:119]
    ds_read_b64_tr_b16 v[202:203], v11 offset:8704
    v_mfma_f32_16x16x32_bf16 v[120:123], v[212:215], a[72:75], v[120:123]
    v_mfma_f32_16x16x32_bf16 v[124:127], v[212:215], a[76:79], v[124:127]
    buffer_load_dwordx4 v3, s[24:27], s51 offen offset:2048 lds
    s_waitcnt lgkmcnt(4)
    v_mfma_f32_16x16x32_bf16 v[128:131], v[192:195], a[64:67], v[128:131]
    ds_read_b64_tr_b16 v[204:205], v12 offset:8192
    v_mfma_f32_16x16x32_bf16 v[132:135], v[192:195], a[68:71], v[132:135]
    ds_read_b64_tr_b16 v[206:207], v12 offset:8704
    v_mfma_f32_16x16x32_bf16 v[136:139], v[192:195], a[72:75], v[136:139]
    v_mfma_f32_16x16x32_bf16 v[140:143], v[192:195], a[76:79], v[140:143]
    s_waitcnt lgkmcnt(4)
    v_mfma_f32_16x16x32_bf16 v[144:147], v[196:199], a[64:67], v[144:147]
    ds_read_b64_tr_b16 v[208:209], v9 offset:4096
    v_mfma_f32_16x16x32_bf16 v[148:151], v[196:199], a[68:71], v[148:151]
    ds_read_b64_tr_b16 v[210:211], v9 offset:4608
    v_mfma_f32_16x16x32_bf16 v[152:155], v[196:199], a[72:75], v[152:155]
    s_add_u32 s66, s54, 4096
    buffer_store_dwordx4 v[240:243], v15, s[32:35], s66 offen sc1
    v_mfma_f32_16x16x32_bf16 v[156:159], v[196:199], a[76:79], v[156:159]
    s_waitcnt lgkmcnt(4)
    v_mfma_f32_16x16x32_bf16 v[160:163], v[200:203], a[64:67], v[160:163]
    ds_read_b64_tr_b16 v[212:213], v10 offset:4096
    v_mfma_f32_16x16x32_bf16 v[164:167], v[200:203], a[68:71], v[164:167]
    ds_read_b64_tr_b16 v[214:215], v10 offset:4608
    v_mfma_f32_16x16x32_bf16 v[168:171], v[200:203], a[72:75], v[168:171]
    v_mfma_f32_16x16x32_bf16 v[172:175], v[200:203], a[76:79], v[172:175]
    buffer_load_dwordx4 v4, s[24:27], s51 offen offset:3072 lds
    s_waitcnt lgkmcnt(4)
    v_mfma_f32_16x16x32_bf16 v[176:179], v[204:207], a[64:67], v[176:179]
    ds_read_b64_tr_b16 v[192:193], v11 offset:4096
    s_mul_i32 s51, s80, 4608
    s_add_u32 s51, s51, s48
    s_add_u32 s51, s51, 128
    v_mfma_f32_16x16x32_bf16 v[180:183], v[204:207], a[68:71], v[180:183]
    ds_read_b64_tr_b16 v[194:195], v11 offset:4608
    s_add_u32 m0, s52, 110592
    v_mfma_f32_16x16x32_bf16 v[184:187], v[204:207], a[72:75], v[184:187]
    buffer_load_dwordx4 v1, s[24:27], s51 offen offset:0 lds
    v_mfma_f32_16x16x32_bf16 v[188:191], v[204:207], a[76:79], v[188:191]
    s_waitcnt lgkmcnt(4)
    v_mfma_f32_16x16x32_bf16 v[64:67], v[208:211], a[80:83], v[64:67]
    ds_read_b64_tr_b16 v[196:197], v12 offset:4096
    v_mfma_f32_16x16x32_bf16 v[68:71], v[208:211], a[84:87], v[68:71]
    ds_read_b64_tr_b16 v[198:199], v12 offset:4608
    v_mfma_f32_16x16x32_bf16 v[72:75], v[208:211], a[88:91], v[72:75]
    v_mfma_f32_16x16x32_bf16 v[76:79], v[208:211], a[92:95], v[76:79]
    s_waitcnt lgkmcnt(4)
    v_mfma_f32_16x16x32_bf16 v[80:83], v[212:215], a[80:83], v[80:83]
    ds_read_b64_tr_b16 v[200:201], v9 offset:12288
    v_mfma_f32_16x16x32_bf16 v[84:87], v[212:215], a[84:87], v[84:87]
    ds_read_b64_tr_b16 v[202:203], v9 offset:12800
    v_mfma_f32_16x16x32_bf16 v[88:91], v[212:215], a[88:91], v[88:91]
    v_mfma_f32_16x16x32_bf16 v[92:95], v[212:215], a[92:95], v[92:95]
    s_waitcnt lgkmcnt(4)
    v_mfma_f32_16x16x32_bf16 v[96:99], v[192:195], a[80:83], v[96:99]
    ds_read_b64_tr_b16 v[204:205], v10 offset:12288
    v_mfma_f32_16x16x32_bf16 v[100:103], v[192:195], a[84:87], v[100:103]
    ds_read_b64_tr_b16 v[206:207], v10 offset:12800
    v_mfma_f32_16x16x32_bf16 v[104:107], v[192:195], a[88:91], v[104:107]
    buffer_load_dwordx4 v2, s[24:27], s51 offen offset:1024 lds
    v_mfma_f32_16x16x32_bf16 v[108:111], v[192:195], a[92:95], v[108:111]
    s_waitcnt lgkmcnt(4)
    v_mfma_f32_16x16x32_bf16 v[112:115], v[196:199], a[80:83], v[112:115]
    ds_read_b64_tr_b16 v[208:209], v11 offset:12288
    s_add_u32 s66, s54, 5120
    buffer_store_dwordx4 v[244:247], v15, s[32:35], s66 offen sc1
    v_mfma_f32_16x16x32_bf16 v[116:119], v[196:199], a[84:87], v[116:119]
    ds_read_b64_tr_b16 v[210:211], v11 offset:12800
    v_mfma_f32_16x16x32_bf16 v[120:123], v[196:199], a[88:91], v[120:123]
    v_mfma_f32_16x16x32_bf16 v[124:127], v[196:199], a[92:95], v[124:127]
    s_waitcnt lgkmcnt(4)
    v_mfma_f32_16x16x32_bf16 v[128:131], v[200:203], a[80:83], v[128:131]
    ds_read_b64_tr_b16 v[212:213], v12 offset:12288
    v_mfma_f32_16x16x32_bf16 v[132:135], v[200:203], a[84:87], v[132:135]
    ds_read_b64_tr_b16 v[214:215], v12 offset:12800
    v_mfma_f32_16x16x32_bf16 v[136:139], v[200:203], a[88:91], v[136:139]
    v_mfma_f32_16x16x32_bf16 v[140:143], v[200:203], a[92:95], v[140:143]
    s_waitcnt lgkmcnt(4)
    v_mfma_f32_16x16x32_bf16 v[144:147], v[204:207], a[80:83], v[144:147]
    v_add_u32 v9, 36864, v5
    v_add_u32 v10, 36864, v6
    v_add_u32 v11, 36864, v7
    v_add_u32 v12, 36864, v8
    ds_read_b64_tr_b16 v[192:193], v9 offset:0
    v_mfma_f32_16x16x32_bf16 v[148:151], v[204:207], a[84:87], v[148:151]
    ds_read_b64_tr_b16 v[194:195], v9 offset:512
    v_mfma_f32_16x16x32_bf16 v[152:155], v[204:207], a[88:91], v[152:155]
    buffer_load_dwordx4 v3, s[24:27], s51 offen offset:2048 lds
    v_mfma_f32_16x16x32_bf16 v[156:159], v[204:207], a[92:95], v[156:159]
    s_waitcnt lgkmcnt(4)
    v_mfma_f32_16x16x32_bf16 v[160:163], v[208:211], a[80:83], v[160:163]
    ds_read_b64_tr_b16 v[196:197], v10 offset:0
    v_mfma_f32_16x16x32_bf16 v[164:167], v[208:211], a[84:87], v[164:167]
    ds_read_b64_tr_b16 v[198:199], v10 offset:512
    v_mfma_f32_16x16x32_bf16 v[168:171], v[208:211], a[88:91], v[168:171]
    v_mfma_f32_16x16x32_bf16 v[172:175], v[208:211], a[92:95], v[172:175]
    s_waitcnt lgkmcnt(4)
    v_mfma_f32_16x16x32_bf16 v[176:179], v[212:215], a[80:83], v[176:179]
    ds_read_b64_tr_b16 v[200:201], v11 offset:0
    v_mfma_f32_16x16x32_bf16 v[180:183], v[212:215], a[84:87], v[180:183]
    ds_read_b64_tr_b16 v[202:203], v11 offset:512
    v_mfma_f32_16x16x32_bf16 v[184:187], v[212:215], a[88:91], v[184:187]
    v_mfma_f32_16x16x32_bf16 v[188:191], v[212:215], a[92:95], v[188:191]
    s_waitcnt lgkmcnt(4)
    v_mfma_f32_16x16x32_bf16 v[64:67], v[192:195], a[96:99], v[64:67]
    ds_read_b64_tr_b16 v[204:205], v12 offset:0
    s_add_u32 s66, s54, 6144
    buffer_store_dwordx4 v[248:251], v15, s[32:35], s66 offen sc1
    v_mfma_f32_16x16x32_bf16 v[68:71], v[192:195], a[100:103], v[68:71]
    ds_read_b64_tr_b16 v[206:207], v12 offset:512
    v_mfma_f32_16x16x32_bf16 v[72:75], v[192:195], a[104:107], v[72:75]
    buffer_load_dwordx4 v4, s[24:27], s51 offen offset:3072 lds
    v_mfma_f32_16x16x32_bf16 v[76:79], v[192:195], a[108:111], v[76:79]
    s_waitcnt lgkmcnt(4)
    v_mfma_f32_16x16x32_bf16 v[80:83], v[196:199], a[96:99], v[80:83]
    ds_read_b64_tr_b16 v[208:209], v9 offset:8192
    v_mfma_f32_16x16x32_bf16 v[84:87], v[196:199], a[100:103], v[84:87]
    ds_read_b64_tr_b16 v[210:211], v9 offset:8704
    v_mfma_f32_16x16x32_bf16 v[88:91], v[196:199], a[104:107], v[88:91]
    v_mfma_f32_16x16x32_bf16 v[92:95], v[196:199], a[108:111], v[92:95]
    s_waitcnt lgkmcnt(4)
    v_mfma_f32_16x16x32_bf16 v[96:99], v[200:203], a[96:99], v[96:99]
    ds_read_b64_tr_b16 v[212:213], v10 offset:8192
    v_mfma_f32_16x16x32_bf16 v[100:103], v[200:203], a[100:103], v[100:103]
    ds_read_b64_tr_b16 v[214:215], v10 offset:8704
    v_mfma_f32_16x16x32_bf16 v[104:107], v[200:203], a[104:107], v[104:107]
    v_mfma_f32_16x16x32_bf16 v[108:111], v[200:203], a[108:111], v[108:111]
    s_waitcnt lgkmcnt(4)
    v_mfma_f32_16x16x32_bf16 v[112:115], v[204:207], a[96:99], v[112:115]
    ds_read_b64_tr_b16 v[192:193], v11 offset:8192
    v_mfma_f32_16x16x32_bf16 v[116:119], v[204:207], a[100:103], v[116:119]
    ds_read_b64_tr_b16 v[194:195], v11 offset:8704
    v_mfma_f32_16x16x32_bf16 v[120:123], v[204:207], a[104:107], v[120:123]
    v_mfma_f32_16x16x32_bf16 v[124:127], v[204:207], a[108:111], v[124:127]
    s_waitcnt lgkmcnt(4)
    v_mfma_f32_16x16x32_bf16 v[128:131], v[208:211], a[96:99], v[128:131]
    ds_read_b64_tr_b16 v[196:197], v12 offset:8192
    v_mfma_f32_16x16x32_bf16 v[132:135], v[208:211], a[100:103], v[132:135]
    ds_read_b64_tr_b16 v[198:199], v12 offset:8704
    v_mfma_f32_16x16x32_bf16 v[136:139], v[208:211], a[104:107], v[136:139]
    v_mfma_f32_16x16x32_bf16 v[140:143], v[208:211], a[108:111], v[140:143]
    s_waitcnt lgkmcnt(4)
    v_mfma_f32_16x16x32_bf16 v[144:147], v[212:215], a[96:99], v[144:147]
    ds_read_b64_tr_b16 v[200:201], v9 offset:4096
    s_add_u32 s66, s54, 7168
    buffer_store_dwordx4 v[252:255], v15, s[32:35], s66 offen sc1
    v_mfma_f32_16x16x32_bf16 v[148:151], v[212:215], a[100:103], v[148:151]
    ds_read_b64_tr_b16 v[202:203], v9 offset:4608
    v_mfma_f32_16x16x32_bf16 v[152:155], v[212:215], a[104:107], v[152:155]
    v_mfma_f32_16x16x32_bf16 v[156:159], v[212:215], a[108:111], v[156:159]
    s_waitcnt lgkmcnt(4)
    v_mfma_f32_16x16x32_bf16 v[160:163], v[192:195], a[96:99], v[160:163]
    ds_read_b64_tr_b16 v[204:205], v10 offset:4096
    v_mfma_f32_16x16x32_bf16 v[164:167], v[192:195], a[100:103], v[164:167]
    ds_read_b64_tr_b16 v[206:207], v10 offset:4608
    v_mfma_f32_16x16x32_bf16 v[168:171], v[192:195], a[104:107], v[168:171]
    v_mfma_f32_16x16x32_bf16 v[172:175], v[192:195], a[108:111], v[172:175]
    s_waitcnt lgkmcnt(4)
    v_mfma_f32_16x16x32_bf16 v[176:179], v[196:199], a[96:99], v[176:179]
    ds_read_b64_tr_b16 v[208:209], v11 offset:4096
    v_mfma_f32_16x16x32_bf16 v[180:183], v[196:199], a[100:103], v[180:183]
    ds_read_b64_tr_b16 v[210:211], v11 offset:4608
    v_mfma_f32_16x16x32_bf16 v[184:187], v[196:199], a[104:107], v[184:187]
    v_mfma_f32_16x16x32_bf16 v[188:191], v[196:199], a[108:111], v[188:191]
    s_waitcnt lgkmcnt(4)
    v_mfma_f32_16x16x32_bf16 v[64:67], v[200:203], a[112:115], v[64:67]
    ds_read_b64_tr_b16 v[212:213], v12 offset:4096
    v_mfma_f32_16x16x32_bf16 v[68:71], v[200:203], a[116:119], v[68:71]
    ds_read_b64_tr_b16 v[214:215], v12 offset:4608
    v_mfma_f32_16x16x32_bf16 v[72:75], v[200:203], a[120:123], v[72:75]
    v_mfma_f32_16x16x32_bf16 v[76:79], v[200:203], a[124:127], v[76:79]
    s_waitcnt lgkmcnt(4)
    v_mfma_f32_16x16x32_bf16 v[80:83], v[204:207], a[112:115], v[80:83]
    ds_read_b64_tr_b16 v[192:193], v9 offset:12288
    v_mfma_f32_16x16x32_bf16 v[84:87], v[204:207], a[116:119], v[84:87]
    ds_read_b64_tr_b16 v[194:195], v9 offset:12800
    v_mfma_f32_16x16x32_bf16 v[88:91], v[204:207], a[120:123], v[88:91]
    v_mfma_f32_16x16x32_bf16 v[92:95], v[204:207], a[124:127], v[92:95]
    s_waitcnt lgkmcnt(4)
    v_mfma_f32_16x16x32_bf16 v[96:99], v[208:211], a[112:115], v[96:99]
    ds_read_b64_tr_b16 v[196:197], v10 offset:12288
    v_mfma_f32_16x16x32_bf16 v[100:103], v[208:211], a[116:119], v[100:103]
    ds_read_b64_tr_b16 v[198:199], v10 offset:12800
    v_mfma_f32_16x16x32_bf16 v[104:107], v[208:211], a[120:123], v[104:107]
    v_mfma_f32_16x16x32_bf16 v[108:111], v[208:211], a[124:127], v[108:111]
    s_waitcnt lgkmcnt(4)
    v_mfma_f32_16x16x32_bf16 v[112:115], v[212:215], a[112:115], v[112:115]
    ds_read_b64_tr_b16 v[200:201], v11 offset:12288
    v_mfma_f32_16x16x32_bf16 v[116:119], v[212:215], a[116:119], v[116:119]
    ds_read_b64_tr_b16 v[202:203], v11 offset:12800
    v_mfma_f32_16x16x32_bf16 v[120:123], v[212:215], a[120:123], v[120:123]
    v_mfma_f32_16x16x32_bf16 v[124:127], v[212:215], a[124:127], v[124:127]
    s_waitcnt lgkmcnt(4)
    v_mfma_f32_16x16x32_bf16 v[128:131], v[192:195], a[112:115], v[128:131]
    ds_read_b64_tr_b16 v[204:205], v12 offset:12288
    v_mfma_f32_16x16x32_bf16 v[132:135], v[192:195], a[116:119], v[132:135]
    ds_read_b64_tr_b16 v[206:207], v12 offset:12800
    v_mfma_f32_16x16x32_bf16 v[136:139], v[192:195], a[120:123], v[136:139]
    v_mfma_f32_16x16x32_bf16 v[140:143], v[192:195], a[124:127], v[140:143]
    s_waitcnt lgkmcnt(4)
    v_mfma_f32_16x16x32_bf16 v[144:147], v[196:199], a[112:115], v[144:147]
    s_waitcnt vmcnt(34)
    s_barrier
    v_add_u32 v9, 55296, v5
    v_add_u32 v10, 55296, v6
    v_add_u32 v11, 55296, v7
    v_add_u32 v12, 55296, v8
    ds_read_b64_tr_b16 v[208:209], v9 offset:0
    v_mfma_f32_16x16x32_bf16 v[148:151], v[196:199], a[116:119], v[148:151]
    ds_read_b64_tr_b16 v[210:211], v9 offset:512
    s_add_u32 s51, s58, s8
    s_sub_u32 s51, s51, 73728
    v_mfma_f32_16x16x32_bf16 v[152:155], v[196:199], a[120:123], v[152:155]
    s_add_u32 m0, s59, 129024
    v_mfma_f32_16x16x32_bf16 v[156:159], v[196:199], a[124:127], v[156:159]
    buffer_load_dwordx4 v27, s[28:31], s51 offen offset:0 lds
    s_waitcnt lgkmcnt(4)
    v_mfma_f32_16x16x32_bf16 v[160:163], v[200:203], a[112:115], v[160:163]
    ds_read_b64_tr_b16 v[212:213], v10 offset:0
    s_add_u32 m0, s59, 133120
    v_mfma_f32_16x16x32_bf16 v[164:167], v[200:203], a[116:119], v[164:167]
    ds_read_b64_tr_b16 v[214:215], v10 offset:512
    v_mfma_f32_16x16x32_bf16 v[168:171], v[200:203], a[120:123], v[168:171]
    v_mfma_f32_16x16x32_bf16 v[172:175], v[200:203], a[124:127], v[172:175]
    s_waitcnt lgkmcnt(4)
    v_mfma_f32_16x16x32_bf16 v[176:179], v[204:207], a[112:115], v[176:179]
    ds_read_b64_tr_b16 v[192:193], v11 offset:0
    v_mfma_f32_16x16x32_bf16 v[180:183], v[204:207], a[116:119], v[180:183]
    ds_read_b64_tr_b16 v[194:195], v11 offset:512
    v_mfma_f32_16x16x32_bf16 v[184:187], v[204:207], a[120:123], v[184:187]
    v_mfma_f32_16x16x32_bf16 v[188:191], v[204:207], a[124:127], v[188:191]
    s_waitcnt lgkmcnt(4)
    v_mfma_f32_16x16x32_bf16 v[64:67], v[208:211], a[128:131], v[64:67]
    ds_read_b64_tr_b16 v[196:197], v12 offset:0
    v_mfma_f32_16x16x32_bf16 v[68:71], v[208:211], a[132:135], v[68:71]
    ds_read_b64_tr_b16 v[198:199], v12 offset:512
    v_mfma_f32_16x16x32_bf16 v[72:75], v[208:211], a[136:139], v[72:75]
    v_mfma_f32_16x16x32_bf16 v[76:79], v[208:211], a[140:143], v[76:79]
    buffer_load_dwordx4 v28, s[28:31], s51 offen offset:0 lds
    s_waitcnt lgkmcnt(4)
    v_mfma_f32_16x16x32_bf16 v[80:83], v[212:215], a[128:131], v[80:83]
    ds_read_b64_tr_b16 v[200:201], v9 offset:8192
    s_add_u32 m0, s59, 137216
    v_mfma_f32_16x16x32_bf16 v[84:87], v[212:215], a[132:135], v[84:87]
    ds_read_b64_tr_b16 v[202:203], v9 offset:8704
    v_mfma_f32_16x16x32_bf16 v[88:91], v[212:215], a[136:139], v[88:91]
    v_mfma_f32_16x16x32_bf16 v[92:95], v[212:215], a[140:143], v[92:95]
    s_waitcnt lgkmcnt(4)
    v_mfma_f32_16x16x32_bf16 v[96:99], v[192:195], a[128:131], v[96:99]
    ds_read_b64_tr_b16 v[204:205], v10 offset:8192
    v_mfma_f32_16x16x32_bf16 v[100:103], v[192:195], a[132:135], v[100:103]
    ds_read_b64_tr_b16 v[206:207], v10 offset:8704
    v_mfma_f32_16x16x32_bf16 v[104:107], v[192:195], a[136:139], v[104:107]
    v_mfma_f32_16x16x32_bf16 v[108:111], v[192:195], a[140:143], v[108:111]
    s_waitcnt lgkmcnt(4)
    v_mfma_f32_16x16x32_bf16 v[112:115], v[196:199], a[128:131], v[112:115]
    ds_read_b64_tr_b16 v[208:209], v11 offset:8192
    v_mfma_f32_16x16x32_bf16 v[116:119], v[196:199], a[132:135], v[116:119]
    ds_read_b64_tr_b16 v[210:211], v11 offset:8704
    v_mfma_f32_16x16x32_bf16 v[120:123], v[196:199], a[136:139], v[120:123]
    v_mfma_f32_16x16x32_bf16 v[124:127], v[196:199], a[140:143], v[124:127]
    buffer_load_dwordx4 v29, s[28:31], s51 offen offset:0 lds
    s_waitcnt lgkmcnt(4)
    v_mfma_f32_16x16x32_bf16 v[128:131], v[200:203], a[128:131], v[128:131]
    ds_read_b64_tr_b16 v[212:213], v12 offset:8192
    s_add_u32 m0, s59, 141312
    v_mfma_f32_16x16x32_bf16 v[132:135], v[200:203], a[132:135], v[132:135]
    ds_read_b64_tr_b16 v[214:215], v12 offset:8704
    v_mfma_f32_16x16x32_bf16 v[136:139], v[200:203], a[136:139], v[136:139]
    v_mfma_f32_16x16x32_bf16 v[140:143], v[200:203], a[140:143], v[140:143]
    s_waitcnt lgkmcnt(4)
    v_mfma_f32_16x16x32_bf16 v[144:147], v[204:207], a[128:131], v[144:147]
    ds_read_b64_tr_b16 v[192:193], v9 offset:4096
    v_mfma_f32_16x16x32_bf16 v[148:151], v[204:207], a[132:135], v[148:151]
    ds_read_b64_tr_b16 v[194:195], v9 offset:4608
    v_mfma_f32_16x16x32_bf16 v[152:155], v[204:207], a[136:139], v[152:155]
    v_mfma_f32_16x16x32_bf16 v[156:159], v[204:207], a[140:143], v[156:159]
    s_waitcnt lgkmcnt(4)
    v_mfma_f32_16x16x32_bf16 v[160:163], v[208:211], a[128:131], v[160:163]
    ds_read_b64_tr_b16 v[196:197], v10 offset:4096
    v_mfma_f32_16x16x32_bf16 v[164:167], v[208:211], a[132:135], v[164:167]
    ds_read_b64_tr_b16 v[198:199], v10 offset:4608
    v_mfma_f32_16x16x32_bf16 v[168:171], v[208:211], a[136:139], v[168:171]
    v_mfma_f32_16x16x32_bf16 v[172:175], v[208:211], a[140:143], v[172:175]
    buffer_load_dwordx4 v30, s[28:31], s51 offen offset:0 lds
    s_waitcnt lgkmcnt(4)
    v_mfma_f32_16x16x32_bf16 v[176:179], v[212:215], a[128:131], v[176:179]
    ds_read_b64_tr_b16 v[200:201], v11 offset:4096
    s_add_u32 m0, s60, 129024
    v_mfma_f32_16x16x32_bf16 v[180:183], v[212:215], a[132:135], v[180:183]
    ds_read_b64_tr_b16 v[202:203], v11 offset:4608
    v_mfma_f32_16x16x32_bf16 v[184:187], v[212:215], a[136:139], v[184:187]
    v_mfma_f32_16x16x32_bf16 v[188:191], v[212:215], a[140:143], v[188:191]
    s_waitcnt lgkmcnt(4)
    v_mfma_f32_16x16x32_bf16 v[64:67], v[192:195], a[144:147], v[64:67]
    ds_read_b64_tr_b16 v[204:205], v12 offset:4096
    v_mfma_f32_16x16x32_bf16 v[68:71], v[192:195], a[148:151], v[68:71]
    ds_read_b64_tr_b16 v[206:207], v12 offset:4608
    v_mfma_f32_16x16x32_bf16 v[72:75], v[192:195], a[152:155], v[72:75]
    v_mfma_f32_16x16x32_bf16 v[76:79], v[192:195], a[156:159], v[76:79]
    s_waitcnt lgkmcnt(4)
    v_mfma_f32_16x16x32_bf16 v[80:83], v[196:199], a[144:147], v[80:83]
    ds_read_b64_tr_b16 v[208:209], v9 offset:12288
    v_mfma_f32_16x16x32_bf16 v[84:87], v[196:199], a[148:151], v[84:87]
    ds_read_b64_tr_b16 v[210:211], v9 offset:12800
    v_mfma_f32_16x16x32_bf16 v[88:91], v[196:199], a[152:155], v[88:91]
    v_mfma_f32_16x16x32_bf16 v[92:95], v[196:199], a[156:159], v[92:95]
    buffer_load_dwordx4 v31, s[28:31], s51 offen offset:0 lds
    s_waitcnt lgkmcnt(4)
    v_mfma_f32_16x16x32_bf16 v[96:99], v[200:203], a[144:147], v[96:99]
    ds_read_b64_tr_b16 v[212:213], v10 offset:12288
    s_add_u32 s51, s58, s9
    s_sub_u32 s51, s51, 73728
    v_mfma_f32_16x16x32_bf16 v[100:103], v[200:203], a[148:151], v[100:103]
    ds_read_b64_tr_b16 v[214:215], v10 offset:12800
    s_add_u32 m0, s59, 18432
    v_mfma_f32_16x16x32_bf16 v[104:107], v[200:203], a[152:155], v[104:107]
    buffer_load_dwordx4 v27, s[28:31], s51 offen offset:0 lds
    v_mfma_f32_16x16x32_bf16 v[108:111], v[200:203], a[156:159], v[108:111]
    s_add_u32 m0, s59, 22528
    s_waitcnt lgkmcnt(4)
    v_mfma_f32_16x16x32_bf16 v[112:115], v[204:207], a[144:147], v[112:115]
    ds_read_b64_tr_b16 v[192:193], v11 offset:12288
    v_mfma_f32_16x16x32_bf16 v[116:119], v[204:207], a[148:151], v[116:119]
    ds_read_b64_tr_b16 v[194:195], v11 offset:12800
    v_mfma_f32_16x16x32_bf16 v[120:123], v[204:207], a[152:155], v[120:123]
    v_mfma_f32_16x16x32_bf16 v[124:127], v[204:207], a[156:159], v[124:127]
    s_waitcnt lgkmcnt(4)
    v_mfma_f32_16x16x32_bf16 v[128:131], v[208:211], a[144:147], v[128:131]
    ds_read_b64_tr_b16 v[196:197], v12 offset:12288
    v_mfma_f32_16x16x32_bf16 v[132:135], v[208:211], a[148:151], v[132:135]
    ds_read_b64_tr_b16 v[198:199], v12 offset:12800
    v_mfma_f32_16x16x32_bf16 v[136:139], v[208:211], a[152:155], v[136:139]
    v_mfma_f32_16x16x32_bf16 v[140:143], v[208:211], a[156:159], v[140:143]
    s_waitcnt lgkmcnt(4)
    v_mfma_f32_16x16x32_bf16 v[144:147], v[212:215], a[144:147], v[144:147]
    s_waitcnt vmcnt(6)
    s_barrier
    s_lshl_b32 s66, s47, 2
    s_add_u32 s66, s66, s68
    s_add_u32 s66, s66, 0
    buffer_store_dword v0, off, s[32:35], s66 sc1
    v_add_u32 v9, 0, v5
    v_add_u32 v10, 0, v6
    v_add_u32 v11, 0, v7
    v_add_u32 v12, 0, v8
    ds_read_b64_tr_b16 v[200:201], v9 offset:0
    v_mfma_f32_16x16x32_bf16 v[148:151], v[212:215], a[148:151], v[148:151]
    ds_read_b64_tr_b16 v[202:203], v9 offset:512
    v_mfma_f32_16x16x32_bf16 v[152:155], v[212:215], a[152:155], v[152:155]
    buffer_load_dwordx4 v28, s[28:31], s51 offen offset:0 lds
    v_mfma_f32_16x16x32_bf16 v[156:159], v[212:215], a[156:159], v[156:159]
    s_add_u32 m0, s59, 26624
    s_waitcnt lgkmcnt(4)
    v_mfma_f32_16x16x32_bf16 v[160:163], v[192:195], a[144:147], v[160:163]
    ds_read_b64_tr_b16 v[204:205], v10 offset:0
    v_mfma_f32_16x16x32_bf16 v[164:167], v[192:195], a[148:151], v[164:167]
    ds_read_b64_tr_b16 v[206:207], v10 offset:512
    v_mfma_f32_16x16x32_bf16 v[168:171], v[192:195], a[152:155], v[168:171]
    v_mfma_f32_16x16x32_bf16 v[172:175], v[192:195], a[156:159], v[172:175]
    s_waitcnt lgkmcnt(4)
    v_mfma_f32_16x16x32_bf16 v[176:179], v[196:199], a[144:147], v[176:179]
    ds_read_b64_tr_b16 v[208:209], v11 offset:0
    v_mfma_f32_16x16x32_bf16 v[180:183], v[196:199], a[148:151], v[180:183]
    ds_read_b64_tr_b16 v[210:211], v11 offset:512
    v_mfma_f32_16x16x32_bf16 v[184:187], v[196:199], a[152:155], v[184:187]
    v_mfma_f32_16x16x32_bf16 v[188:191], v[196:199], a[156:159], v[188:191]
    s_waitcnt lgkmcnt(4)
    v_mfma_f32_16x16x32_bf16 v[64:67], v[200:203], a[160:163], v[64:67]
    ds_read_b64_tr_b16 v[212:213], v12 offset:0
    v_mfma_f32_16x16x32_bf16 v[68:71], v[200:203], a[164:167], v[68:71]
    ds_read_b64_tr_b16 v[214:215], v12 offset:512
    v_mfma_f32_16x16x32_bf16 v[72:75], v[200:203], a[168:171], v[72:75]
    buffer_load_dwordx4 v29, s[28:31], s51 offen offset:0 lds
    v_mfma_f32_16x16x32_bf16 v[76:79], v[200:203], a[172:175], v[76:79]
    s_add_u32 m0, s59, 30720
    s_waitcnt lgkmcnt(4)
    v_mfma_f32_16x16x32_bf16 v[80:83], v[204:207], a[160:163], v[80:83]
    ds_read_b64_tr_b16 v[192:193], v9 offset:8192
    v_mfma_f32_16x16x32_bf16 v[84:87], v[204:207], a[164:167], v[84:87]
    ds_read_b64_tr_b16 v[194:195], v9 offset:8704
    v_mfma_f32_16x16x32_bf16 v[88:91], v[204:207], a[168:171], v[88:91]
    v_mfma_f32_16x16x32_bf16 v[92:95], v[204:207], a[172:175], v[92:95]
    s_waitcnt lgkmcnt(4)
    v_mfma_f32_16x16x32_bf16 v[96:99], v[208:211], a[160:163], v[96:99]
    ds_read_b64_tr_b16 v[196:197], v10 offset:8192
    v_mfma_f32_16x16x32_bf16 v[100:103], v[208:211], a[164:167], v[100:103]
    ds_read_b64_tr_b16 v[198:199], v10 offset:8704
    v_mfma_f32_16x16x32_bf16 v[104:107], v[208:211], a[168:171], v[104:107]
    v_mfma_f32_16x16x32_bf16 v[108:111], v[208:211], a[172:175], v[108:111]
    s_waitcnt lgkmcnt(4)
    v_mfma_f32_16x16x32_bf16 v[112:115], v[212:215], a[160:163], v[112:115]
    ds_read_b64_tr_b16 v[200:201], v11 offset:8192
    v_mfma_f32_16x16x32_bf16 v[116:119], v[212:215], a[164:167], v[116:119]
    ds_read_b64_tr_b16 v[202:203], v11 offset:8704
    v_mfma_f32_16x16x32_bf16 v[120:123], v[212:215], a[168:171], v[120:123]
    buffer_load_dwordx4 v30, s[28:31], s51 offen offset:0 lds
    v_mfma_f32_16x16x32_bf16 v[124:127], v[212:215], a[172:175], v[124:127]
    s_add_u32 m0, s60, 18432
    s_waitcnt lgkmcnt(4)
    v_mfma_f32_16x16x32_bf16 v[128:131], v[192:195], a[160:163], v[128:131]
    ds_read_b64_tr_b16 v[204:205], v12 offset:8192
    v_mfma_f32_16x16x32_bf16 v[132:135], v[192:195], a[164:167], v[132:135]
    ds_read_b64_tr_b16 v[206:207], v12 offset:8704
    v_mfma_f32_16x16x32_bf16 v[136:139], v[192:195], a[168:171], v[136:139]
    v_mfma_f32_16x16x32_bf16 v[140:143], v[192:195], a[172:175], v[140:143]
    s_waitcnt lgkmcnt(4)
    v_mfma_f32_16x16x32_bf16 v[144:147], v[196:199], a[160:163], v[144:147]
    ds_read_b64_tr_b16 v[208:209], v9 offset:4096
    v_mfma_f32_16x16x32_bf16 v[148:151], v[196:199], a[164:167], v[148:151]
    ds_read_b64_tr_b16 v[210:211], v9 offset:4608
    v_mfma_f32_16x16x32_bf16 v[152:155], v[196:199], a[168:171], v[152:155]
    v_mfma_f32_16x16x32_bf16 v[156:159], v[196:199], a[172:175], v[156:159]
    s_waitcnt lgkmcnt(4)
    v_mfma_f32_16x16x32_bf16 v[160:163], v[200:203], a[160:163], v[160:163]
    ds_read_b64_tr_b16 v[212:213], v10 offset:4096
    v_mfma_f32_16x16x32_bf16 v[164:167], v[200:203], a[164:167], v[164:167]
    ds_read_b64_tr_b16 v[214:215], v10 offset:4608
    v_mfma_f32_16x16x32_bf16 v[168:171], v[200:203], a[168:171], v[168:171]
    buffer_load_dwordx4 v31, s[28:31], s51 offen offset:0 lds
    v_mfma_f32_16x16x32_bf16 v[172:175], v[200:203], a[172:175], v[172:175]
    s_add_u32 s51, s58, s10
    s_sub_u32 s51, s51, 73728
    s_waitcnt lgkmcnt(4)
    v_mfma_f32_16x16x32_bf16 v[176:179], v[204:207], a[160:163], v[176:179]
    ds_read_b64_tr_b16 v[192:193], v11 offset:4096
    s_add_u32 m0, s59, 36864
    v_mfma_f32_16x16x32_bf16 v[180:183], v[204:207], a[164:167], v[180:183]
    ds_read_b64_tr_b16 v[194:195], v11 offset:4608
    buffer_load_dwordx4 v27, s[28:31], s51 offen offset:0 lds
    v_mfma_f32_16x16x32_bf16 v[184:187], v[204:207], a[168:171], v[184:187]
    s_add_u32 m0, s59, 40960
    v_mfma_f32_16x16x32_bf16 v[188:191], v[204:207], a[172:175], v[188:191]
    s_waitcnt lgkmcnt(4)
    v_mfma_f32_16x16x32_bf16 v[64:67], v[208:211], a[176:179], v[64:67]
    ds_read_b64_tr_b16 v[196:197], v12 offset:4096
    v_mfma_f32_16x16x32_bf16 v[68:71], v[208:211], a[180:183], v[68:71]
    ds_read_b64_tr_b16 v[198:199], v12 offset:4608
    v_mfma_f32_16x16x32_bf16 v[72:75], v[208:211], a[184:187], v[72:75]
    v_mfma_f32_16x16x32_bf16 v[76:79], v[208:211], a[188:191], v[76:79]
    s_waitcnt lgkmcnt(4)
    v_mfma_f32_16x16x32_bf16 v[80:83], v[212:215], a[176:179], v[80:83]
    ds_read_b64_tr_b16 v[200:201], v9 offset:12288
    v_mfma_f32_16x16x32_bf16 v[84:87], v[212:215], a[180:183], v[84:87]
    ds_read_b64_tr_b16 v[202:203], v9 offset:12800
    v_mfma_f32_16x16x32_bf16 v[88:91], v[212:215], a[184:187], v[88:91]
    v_mfma_f32_16x16x32_bf16 v[92:95], v[212:215], a[188:191], v[92:95]
    s_waitcnt lgkmcnt(4)
    v_mfma_f32_16x16x32_bf16 v[96:99], v[192:195], a[176:179], v[96:99]
    ds_read_b64_tr_b16 v[204:205], v10 offset:12288
    v_mfma_f32_16x16x32_bf16 v[100:103], v[192:195], a[180:183], v[100:103]
    ds_read_b64_tr_b16 v[206:207], v10 offset:12800
    buffer_load_dwordx4 v28, s[28:31], s51 offen offset:0 lds
    v_mfma_f32_16x16x32_bf16 v[104:107], v[192:195], a[184:187], v[104:107]
    s_add_u32 m0, s59, 45056
    v_mfma_f32_16x16x32_bf16 v[108:111], v[192:195], a[188:191], v[108:111]
    s_waitcnt lgkmcnt(4)
    v_mfma_f32_16x16x32_bf16 v[112:115], v[196:199], a[176:179], v[112:115]
    ds_read_b64_tr_b16 v[208:209], v11 offset:12288
    v_mfma_f32_16x16x32_bf16 v[116:119], v[196:199], a[180:183], v[116:119]
    ds_read_b64_tr_b16 v[210:211], v11 offset:12800
    v_mfma_f32_16x16x32_bf16 v[120:123], v[196:199], a[184:187], v[120:123]
    v_mfma_f32_16x16x32_bf16 v[124:127], v[196:199], a[188:191], v[124:127]
    s_waitcnt lgkmcnt(4)
    v_mfma_f32_16x16x32_bf16 v[128:131], v[200:203], a[176:179], v[128:131]
    ds_read_b64_tr_b16 v[212:213], v12 offset:12288
    v_mfma_f32_16x16x32_bf16 v[132:135], v[200:203], a[180:183], v[132:135]
    ds_read_b64_tr_b16 v[214:215], v12 offset:12800
    v_mfma_f32_16x16x32_bf16 v[136:139], v[200:203], a[184:187], v[136:139]
    v_mfma_f32_16x16x32_bf16 v[140:143], v[200:203], a[188:191], v[140:143]
    s_waitcnt lgkmcnt(4)
    v_mfma_f32_16x16x32_bf16 v[144:147], v[204:207], a[176:179], v[144:147]
    s_barrier
    v_add_u32 v9, 73728, v5
    v_add_u32 v10, 73728, v6
    v_add_u32 v11, 73728, v7
    v_add_u32 v12, 73728, v8
    ds_read_b64_tr_b16 v[192:193], v9 offset:0
    v_mfma_f32_16x16x32_bf16 v[148:151], v[204:207], a[180:183], v[148:151]
    ds_read_b64_tr_b16 v[194:195], v9 offset:512
    buffer_load_dwordx4 v29, s[28:31], s51 offen offset:0 lds
    v_mfma_f32_16x16x32_bf16 v[152:155], v[204:207], a[184:187], v[152:155]
    s_add_u32 m0, s59, 49152
    v_mfma_f32_16x16x32_bf16 v[156:159], v[204:207], a[188:191], v[156:159]
    s_waitcnt lgkmcnt(4)
    v_mfma_f32_16x16x32_bf16 v[160:163], v[208:211], a[176:179], v[160:163]
    ds_read_b64_tr_b16 v[196:197], v10 offset:0
    v_mfma_f32_16x16x32_bf16 v[164:167], v[208:211], a[180:183], v[164:167]
    ds_read_b64_tr_b16 v[198:199], v10 offset:512
    v_mfma_f32_16x16x32_bf16 v[168:171], v[208:211], a[184:187], v[168:171]
    v_mfma_f32_16x16x32_bf16 v[172:175], v[208:211], a[188:191], v[172:175]
    s_waitcnt lgkmcnt(4)
    v_mfma_f32_16x16x32_bf16 v[176:179], v[212:215], a[176:179], v[176:179]
    ds_read_b64_tr_b16 v[200:201], v11 offset:0
    v_mfma_f32_16x16x32_bf16 v[180:183], v[212:215], a[180:183], v[180:183]
    ds_read_b64_tr_b16 v[202:203], v11 offset:512
    v_mfma_f32_16x16x32_bf16 v[184:187], v[212:215], a[184:187], v[184:187]
    v_mfma_f32_16x16x32_bf16 v[188:191], v[212:215], a[188:191], v[188:191]
    s_waitcnt lgkmcnt(4)
    v_mfma_f32_16x16x32_bf16 v[64:67], v[192:195], a[192:195], v[64:67]
    ds_read_b64_tr_b16 v[204:205], v12 offset:0
    v_mfma_f32_16x16x32_bf16 v[68:71], v[192:195], a[196:199], v[68:71]
    ds_read_b64_tr_b16 v[206:207], v12 offset:512
    buffer_load_dwordx4 v30, s[28:31], s51 offen offset:0 lds
    v_mfma_f32_16x16x32_bf16 v[72:75], v[192:195], a[200:203], v[72:75]
    s_add_u32 m0, s60, 36864
    v_mfma_f32_16x16x32_bf16 v[76:79], v[192:195], a[204:207], v[76:79]
    s_waitcnt lgkmcnt(4)
    v_mfma_f32_16x16x32_bf16 v[80:83], v[196:199], a[192:195], v[80:83]
    ds_read_b64_tr_b16 v[208:209], v9 offset:8192
    v_mfma_f32_16x16x32_bf16 v[84:87], v[196:199], a[196:199], v[84:87]
    ds_read_b64_tr_b16 v[210:211], v9 offset:8704
    v_mfma_f32_16x16x32_bf16 v[88:91], v[196:199], a[200:203], v[88:91]
    v_mfma_f32_16x16x32_bf16 v[92:95], v[196:199], a[204:207], v[92:95]
    s_waitcnt lgkmcnt(4)
    v_mfma_f32_16x16x32_bf16 v[96:99], v[200:203], a[192:195], v[96:99]
    ds_read_b64_tr_b16 v[212:213], v10 offset:8192
    v_mfma_f32_16x16x32_bf16 v[100:103], v[200:203], a[196:199], v[100:103]
    ds_read_b64_tr_b16 v[214:215], v10 offset:8704
    v_mfma_f32_16x16x32_bf16 v[104:107], v[200:203], a[200:203], v[104:107]
    v_mfma_f32_16x16x32_bf16 v[108:111], v[200:203], a[204:207], v[108:111]
    s_waitcnt lgkmcnt(4)
    v_mfma_f32_16x16x32_bf16 v[112:115], v[204:207], a[192:195], v[112:115]
    ds_read_b64_tr_b16 v[192:193], v11 offset:8192
    v_mfma_f32_16x16x32_bf16 v[116:119], v[204:207], a[196:199], v[116:119]
    ds_read_b64_tr_b16 v[194:195], v11 offset:8704
    buffer_load_dwordx4 v31, s[28:31], s51 offen offset:0 lds
    v_mfma_f32_16x16x32_bf16 v[120:123], v[204:207], a[200:203], v[120:123]
    s_add_u32 s51, s58, s11
    s_sub_u32 s51, s51, 73728
    v_mfma_f32_16x16x32_bf16 v[124:127], v[204:207], a[204:207], v[124:127]
    s_add_u32 m0, s59, 55296
    s_waitcnt lgkmcnt(4)
    v_mfma_f32_16x16x32_bf16 v[128:131], v[208:211], a[192:195], v[128:131]
    ds_read_b64_tr_b16 v[196:197], v12 offset:8192
    buffer_load_dwordx4 v27, s[28:31], s51 offen offset:0 lds
    v_mfma_f32_16x16x32_bf16 v[132:135], v[208:211], a[196:199], v[132:135]
    ds_read_b64_tr_b16 v[198:199], v12 offset:8704
    s_add_u32 m0, s59, 59392
    v_mfma_f32_16x16x32_bf16 v[136:139], v[208:211], a[200:203], v[136:139]
    v_mfma_f32_16x16x32_bf16 v[140:143], v[208:211], a[204:207], v[140:143]
    s_waitcnt lgkmcnt(4)
    v_mfma_f32_16x16x32_bf16 v[144:147], v[212:215], a[192:195], v[144:147]
    ds_read_b64_tr_b16 v[200:201], v9 offset:4096
    v_mfma_f32_16x16x32_bf16 v[148:151], v[212:215], a[196:199], v[148:151]
    ds_read_b64_tr_b16 v[202:203], v9 offset:4608
    v_mfma_f32_16x16x32_bf16 v[152:155], v[212:215], a[200:203], v[152:155]
    v_mfma_f32_16x16x32_bf16 v[156:159], v[212:215], a[204:207], v[156:159]
    s_waitcnt lgkmcnt(4)
    v_mfma_f32_16x16x32_bf16 v[160:163], v[192:195], a[192:195], v[160:163]
    ds_read_b64_tr_b16 v[204:205], v10 offset:4096
    v_mfma_f32_16x16x32_bf16 v[164:167], v[192:195], a[196:199], v[164:167]
    ds_read_b64_tr_b16 v[206:207], v10 offset:4608
    v_mfma_f32_16x16x32_bf16 v[168:171], v[192:195], a[200:203], v[168:171]
    v_mfma_f32_16x16x32_bf16 v[172:175], v[192:195], a[204:207], v[172:175]
    s_waitcnt lgkmcnt(4)
    v_mfma_f32_16x16x32_bf16 v[176:179], v[196:199], a[192:195], v[176:179]
    ds_read_b64_tr_b16 v[208:209], v11 offset:4096
    buffer_load_dwordx4 v28, s[28:31], s51 offen offset:0 lds
    v_mfma_f32_16x16x32_bf16 v[180:183], v[196:199], a[196:199], v[180:183]
    ds_read_b64_tr_b16 v[210:211], v11 offset:4608
    s_add_u32 m0, s59, 63488
    v_mfma_f32_16x16x32_bf16 v[184:187], v[196:199], a[200:203], v[184:187]
    v_mfma_f32_16x16x32_bf16 v[188:191], v[196:199], a[204:207], v[188:191]
    s_waitcnt lgkmcnt(4)
    v_mfma_f32_16x16x32_bf16 v[64:67], v[200:203], a[208:211], v[64:67]
    ds_read_b64_tr_b16 v[212:213], v12 offset:4096
    v_mfma_f32_16x16x32_bf16 v[68:71], v[200:203], a[212:215], v[68:71]
    ds_read_b64_tr_b16 v[214:215], v12 offset:4608
    v_mfma_f32_16x16x32_bf16 v[72:75], v[200:203], a[216:219], v[72:75]
    v_mfma_f32_16x16x32_bf16 v[76:79], v[200:203], a[220:223], v[76:79]
    s_waitcnt lgkmcnt(4)
    v_mfma_f32_16x16x32_bf16 v[80:83], v[204:207], a[208:211], v[80:83]
    ds_read_b64_tr_b16 v[192:193], v9 offset:12288
    v_mfma_f32_16x16x32_bf16 v[84:87], v[204:207], a[212:215], v[84:87]
    ds_read_b64_tr_b16 v[194:195], v9 offset:12800
    v_mfma_f32_16x16x32_bf16 v[88:91], v[204:207], a[216:219], v[88:91]
    v_mfma_f32_16x16x32_bf16 v[92:95], v[204:207], a[220:223], v[92:95]
    s_waitcnt lgkmcnt(4)
    v_mfma_f32_16x16x32_bf16 v[96:99], v[208:211], a[208:211], v[96:99]
    ds_read_b64_tr_b16 v[196:197], v10 offset:12288
    buffer_load_dwordx4 v29, s[28:31], s51 offen offset:0 lds
    v_mfma_f32_16x16x32_bf16 v[100:103], v[208:211], a[212:215], v[100:103]
    ds_read_b64_tr_b16 v[198:199], v10 offset:12800
    s_add_u32 m0, s59, 67584
    v_mfma_f32_16x16x32_bf16 v[104:107], v[208:211], a[216:219], v[104:107]
    v_mfma_f32_16x16x32_bf16 v[108:111], v[208:211], a[220:223], v[108:111]
    s_waitcnt lgkmcnt(4)
    v_mfma_f32_16x16x32_bf16 v[112:115], v[212:215], a[208:211], v[112:115]
    ds_read_b64_tr_b16 v[200:201], v11 offset:12288
    v_mfma_f32_16x16x32_bf16 v[116:119], v[212:215], a[212:215], v[116:119]
    ds_read_b64_tr_b16 v[202:203], v11 offset:12800
    v_mfma_f32_16x16x32_bf16 v[120:123], v[212:215], a[216:219], v[120:123]
    v_mfma_f32_16x16x32_bf16 v[124:127], v[212:215], a[220:223], v[124:127]
    s_waitcnt lgkmcnt(4)
    v_mfma_f32_16x16x32_bf16 v[128:131], v[192:195], a[208:211], v[128:131]
    ds_read_b64_tr_b16 v[204:205], v12 offset:12288
    s_add_u32 s66, s68, 0
    buffer_load_dword v19, v17, s[32:35], s66 offen sc1
    v_mfma_f32_16x16x32_bf16 v[132:135], v[192:195], a[212:215], v[132:135]
    ds_read_b64_tr_b16 v[206:207], v12 offset:12800
    v_mfma_f32_16x16x32_bf16 v[136:139], v[192:195], a[216:219], v[136:139]
    v_mfma_f32_16x16x32_bf16 v[140:143], v[192:195], a[220:223], v[140:143]
    s_waitcnt lgkmcnt(4)
    v_mfma_f32_16x16x32_bf16 v[144:147], v[196:199], a[208:211], v[144:147]
    v_add_u32 v9, 92160, v5
    v_add_u32 v10, 92160, v6
    v_add_u32 v11, 92160, v7
    v_add_u32 v12, 92160, v8
    ds_read_b64_tr_b16 v[208:209], v9 offset:0
    buffer_load_dwordx4 v30, s[28:31], s51 offen offset:0 lds
    v_mfma_f32_16x16x32_bf16 v[148:151], v[196:199], a[212:215], v[148:151]
    ds_read_b64_tr_b16 v[210:211], v9 offset:512
    s_add_u32 m0, s60, 55296
    v_mfma_f32_16x16x32_bf16 v[152:155], v[196:199], a[216:219], v[152:155]
    v_mfma_f32_16x16x32_bf16 v[156:159], v[196:199], a[220:223], v[156:159]
    s_waitcnt lgkmcnt(4)
    v_mfma_f32_16x16x32_bf16 v[160:163], v[200:203], a[208:211], v[160:163]
    ds_read_b64_tr_b16 v[212:213], v10 offset:0
    v_mfma_f32_16x16x32_bf16 v[164:167], v[200:203], a[212:215], v[164:167]
    ds_read_b64_tr_b16 v[214:215], v10 offset:512
    v_mfma_f32_16x16x32_bf16 v[168:171], v[200:203], a[216:219], v[168:171]
    v_mfma_f32_16x16x32_bf16 v[172:175], v[200:203], a[220:223], v[172:175]
    s_waitcnt lgkmcnt(4)
    v_mfma_f32_16x16x32_bf16 v[176:179], v[204:207], a[208:211], v[176:179]
    ds_read_b64_tr_b16 v[192:193], v11 offset:0
    v_mfma_f32_16x16x32_bf16 v[180:183], v[204:207], a[212:215], v[180:183]
    ds_read_b64_tr_b16 v[194:195], v11 offset:512
    v_mfma_f32_16x16x32_bf16 v[184:187], v[204:207], a[216:219], v[184:187]
    v_mfma_f32_16x16x32_bf16 v[188:191], v[204:207], a[220:223], v[188:191]
    s_waitcnt lgkmcnt(4)
    v_mfma_f32_16x16x32_bf16 v[64:67], v[208:211], a[224:227], v[64:67]
    ds_read_b64_tr_b16 v[196:197], v12 offset:0
    buffer_load_dwordx4 v31, s[28:31], s51 offen offset:0 lds
    v_mfma_f32_16x16x32_bf16 v[68:71], v[208:211], a[228:231], v[68:71]
    ds_read_b64_tr_b16 v[198:199], v12 offset:512
    v_mfma_f32_16x16x32_bf16 v[72:75], v[208:211], a[232:235], v[72:75]
    v_mfma_f32_16x16x32_bf16 v[76:79], v[208:211], a[236:239], v[76:79]
    s_waitcnt lgkmcnt(4)
    v_mfma_f32_16x16x32_bf16 v[80:83], v[212:215], a[224:227], v[80:83]
    ds_read_b64_tr_b16 v[200:201], v9 offset:8192
    v_mfma_f32_16x16x32_bf16 v[84:87], v[212:215], a[228:231], v[84:87]
    ds_read_b64_tr_b16 v[202:203], v9 offset:8704
    v_mfma_f32_16x16x32_bf16 v[88:91], v[212:215], a[232:235], v[88:91]
    v_mfma_f32_16x16x32_bf16 v[92:95], v[212:215], a[236:239], v[92:95]
    s_waitcnt lgkmcnt(4)
    v_mfma_f32_16x16x32_bf16 v[96:99], v[192:195], a[224:227], v[96:99]
    ds_read_b64_tr_b16 v[204:205], v10 offset:8192
    v_mfma_f32_16x16x32_bf16 v[100:103], v[192:195], a[228:231], v[100:103]
    ds_read_b64_tr_b16 v[206:207], v10 offset:8704
    v_mfma_f32_16x16x32_bf16 v[104:107], v[192:195], a[232:235], v[104:107]
    v_mfma_f32_16x16x32_bf16 v[108:111], v[192:195], a[236:239], v[108:111]
    s_waitcnt lgkmcnt(4)
    v_mfma_f32_16x16x32_bf16 v[112:115], v[196:199], a[224:227], v[112:115]
    ds_read_b64_tr_b16 v[208:209], v11 offset:8192
    v_mfma_f32_16x16x32_bf16 v[116:119], v[196:199], a[228:231], v[116:119]
    ds_read_b64_tr_b16 v[210:211], v11 offset:8704
    v_mfma_f32_16x16x32_bf16 v[120:123], v[196:199], a[232:235], v[120:123]
    v_mfma_f32_16x16x32_bf16 v[124:127], v[196:199], a[236:239], v[124:127]
    s_waitcnt lgkmcnt(4)
    v_mfma_f32_16x16x32_bf16 v[128:131], v[200:203], a[224:227], v[128:131]
    ds_read_b64_tr_b16 v[212:213], v12 offset:8192
    v_mfma_f32_16x16x32_bf16 v[132:135], v[200:203], a[228:231], v[132:135]
    ds_read_b64_tr_b16 v[214:215], v12 offset:8704
    v_mfma_f32_16x16x32_bf16 v[136:139], v[200:203], a[232:235], v[136:139]
    v_mfma_f32_16x16x32_bf16 v[140:143], v[200:203], a[236:239], v[140:143]
    s_waitcnt lgkmcnt(4)
    v_mfma_f32_16x16x32_bf16 v[144:147], v[204:207], a[224:227], v[144:147]
    ds_read_b64_tr_b16 v[192:193], v9 offset:4096
    v_mfma_f32_16x16x32_bf16 v[148:151], v[204:207], a[228:231], v[148:151]
    ds_read_b64_tr_b16 v[194:195], v9 offset:4608
    v_mfma_f32_16x16x32_bf16 v[152:155], v[204:207], a[232:235], v[152:155]
    v_mfma_f32_16x16x32_bf16 v[156:159], v[204:207], a[236:239], v[156:159]
    s_waitcnt lgkmcnt(4)
    v_mfma_f32_16x16x32_bf16 v[160:163], v[208:211], a[224:227], v[160:163]
    ds_read_b64_tr_b16 v[196:197], v10 offset:4096
    v_mfma_f32_16x16x32_bf16 v[164:167], v[208:211], a[228:231], v[164:167]
    ds_read_b64_tr_b16 v[198:199], v10 offset:4608
    v_mfma_f32_16x16x32_bf16 v[168:171], v[208:211], a[232:235], v[168:171]
    v_mfma_f32_16x16x32_bf16 v[172:175], v[208:211], a[236:239], v[172:175]
    s_waitcnt lgkmcnt(4)
    v_mfma_f32_16x16x32_bf16 v[176:179], v[212:215], a[224:227], v[176:179]
    ds_read_b64_tr_b16 v[200:201], v11 offset:4096
    v_mfma_f32_16x16x32_bf16 v[180:183], v[212:215], a[228:231], v[180:183]
    ds_read_b64_tr_b16 v[202:203], v11 offset:4608
    v_mfma_f32_16x16x32_bf16 v[184:187], v[212:215], a[232:235], v[184:187]
    v_mfma_f32_16x16x32_bf16 v[188:191], v[212:215], a[236:239], v[188:191]
    s_waitcnt lgkmcnt(4)
    v_mfma_f32_16x16x32_bf16 v[64:67], v[192:195], a[240:243], v[64:67]
    ds_read_b64_tr_b16 v[204:205], v12 offset:4096
    v_mfma_f32_16x16x32_bf16 v[68:71], v[192:195], a[244:247], v[68:71]
    ds_read_b64_tr_b16 v[206:207], v12 offset:4608
    v_mfma_f32_16x16x32_bf16 v[72:75], v[192:195], a[248:251], v[72:75]
    s_waitcnt vmcnt(2)
    v_cmp_ne_u32 vcc, v19, v0
    s_nop 4
    s_cbranch_vccz L_ok1
    s_mov_b32 s67, 1000000
L_sp1:
    s_add_u32 s66, s68, 0
    buffer_load_dword v19, v17, s[32:35], s66 offen sc1
    s_waitcnt vmcnt(0)
    v_cmp_ne_u32 vcc, v19, v0
    s_sub_u32 s67, s67, 1
    s_nop 4
    s_cbranch_vccz L_ok1
    s_cmp_lg_u32 s67, 0
    s_cbranch_scc1 L_sp1
L_ok1:
    v_mfma_f32_16x16x32_bf16 v[76:79], v[192:195], a[252:255], v[76:79]
    s_add_u32 s66, s61, s5
    s_add_u32 s66, s66, -32768
    buffer_load_dwordx4 a[32:35], v15, s[32:35], s66 offen sc1
    s_waitcnt lgkmcnt(4)
    v_mfma_f32_16x16x32_bf16 v[80:83], v[196:199], a[240:243], v[80:83]
    ds_read_b64_tr_b16 v[208:209], v9 offset:12288
    v_mfma_f32_16x16x32_bf16 v[84:87], v[196:199], a[244:247], v[84:87]
    ds_read_b64_tr_b16 v[210:211], v9 offset:12800
    v_mfma_f32_16x16x32_bf16 v[88:91], v[196:199], a[248:251], v[88:91]
    v_mfma_f32_16x16x32_bf16 v[92:95], v[196:199], a[252:255], v[92:95]
    s_waitcnt lgkmcnt(4)
    v_mfma_f32_16x16x32_bf16 v[96:99], v[200:203], a[240:243], v[96:99]
    ds_read_b64_tr_b16 v[212:213], v10 offset:12288
    v_mfma_f32_16x16x32_bf16 v[100:103], v[200:203], a[244:247], v[100:103]
    ds_read_b64_tr_b16 v[214:215], v10 offset:12800
    s_add_u32 s66, s61, s5
    s_add_u32 s66, s66, -31744
    buffer_load_dwordx4 a[36:39], v15, s[32:35], s66 offen sc1
    v_mfma_f32_16x16x32_bf16 v[104:107], v[200:203], a[248:251], v[104:107]
    v_mfma_f32_16x16x32_bf16 v[108:111], v[200:203], a[252:255], v[108:111]
    s_waitcnt lgkmcnt(4)
    v_mfma_f32_16x16x32_bf16 v[112:115], v[204:207], a[240:243], v[112:115]
    ds_read_b64_tr_b16 v[192:193], v11 offset:12288
    v_mfma_f32_16x16x32_bf16 v[116:119], v[204:207], a[244:247], v[116:119]
    ds_read_b64_tr_b16 v[194:195], v11 offset:12800
    v_mfma_f32_16x16x32_bf16 v[120:123], v[204:207], a[248:251], v[120:123]
    v_mfma_f32_16x16x32_bf16 v[124:127], v[204:207], a[252:255], v[124:127]
    s_add_u32 s66, s61, s5
    s_add_u32 s66, s66, -30720
    buffer_load_dwordx4 a[40:43], v15, s[32:35], s66 offen sc1
    s_waitcnt lgkmcnt(4)
    v_mfma_f32_16x16x32_bf16 v[128:131], v[208:211], a[240:243], v[128:131]
    ds_read_b64_tr_b16 v[196:197], v12 offset:12288
    v_mfma_f32_16x16x32_bf16 v[132:135], v[208:211], a[244:247], v[132:135]
    ds_read_b64_tr_b16 v[198:199], v12 offset:12800
    v_mfma_f32_16x16x32_bf16 v[136:139], v[208:211], a[248:251], v[136:139]
    v_mfma_f32_16x16x32_bf16 v[140:143], v[208:211], a[252:255], v[140:143]
    s_waitcnt lgkmcnt(4)
    v_mfma_f32_16x16x32_bf16 v[144:147], v[212:215], a[240:243], v[144:147]
    s_barrier
    v_add_u32 v9, 110592, v5
    v_add_u32 v10, 110592, v6
    v_add_u32 v11, 110592, v7
    v_add_u32 v12, 110592, v8
    ds_read_b64_tr_b16 v[200:201], v9 offset:0
    v_mfma_f32_16x16x32_bf16 v[148:151], v[212:215], a[244:247], v[148:151]
    ds_read_b64_tr_b16 v[202:203], v9 offset:512
    s_add_u32 s51, s58, 589824
    v_mfma_f32_16x16x32_bf16 v[152:155], v[212:215], a[248:251], v[152:155]
    s_add_u32 m0, s59, 0
    v_mfma_f32_16x16x32_bf16 v[156:159], v[212:215], a[252:255], v[156:159]
    buffer_load_dwordx4 v27, s[28:31], s51 offen offset:0 lds
    s_waitcnt lgkmcnt(4)
    v_mfma_f32_16x16x32_bf16 v[160:163], v[192:195], a[240:243], v[160:163]
    ds_read_b64_tr_b16 v[204:205], v9 offset:8192
    s_add_u32 m0, s59, 4096
    v_mfma_f32_16x16x32_bf16 v[164:167], v[192:195], a[244:247], v[164:167]
    ds_read_b64_tr_b16 v[206:207], v9 offset:8704
    s_add_u32 s66, s61, s5
    s_add_u32 s66, s66, -29696
    buffer_load_dwordx4 a[44:47], v15, s[32:35], s66 offen sc1
    v_mfma_f32_16x16x32_bf16 v[168:171], v[192:195], a[248:251], v[168:171]
    v_mfma_f32_16x16x32_bf16 v[172:175], v[192:195], a[252:255], v[172:175]
    s_waitcnt lgkmcnt(4)
    v_mfma_f32_16x16x32_bf16 v[176:179], v[196:199], a[240:243], v[176:179]
    ds_read_b64_tr_b16 v[208:209], v9 offset:4096
    v_mfma_f32_16x16x32_bf16 v[180:183], v[196:199], a[244:247], v[180:183]
    ds_read_b64_tr_b16 v[210:211], v9 offset:4608
    v_mfma_f32_16x16x32_bf16 v[184:187], v[196:199], a[248:251], v[184:187]
    v_mfma_f32_16x16x32_bf16 v[188:191], v[196:199], a[252:255], v[188:191]
    s_add_u32 s66, s61, s5
    s_add_u32 s66, s66, -28672
    buffer_load_dwordx4 a[48:51], v15, s[32:35], s66 offen sc1
    s_waitcnt lgkmcnt(4)
    v_mfma_f32_16x16x32_bf16 v[64:67], v[200:203], v[32:35], v[64:67]
    ds_read_b64_tr_b16 v[212:213], v9 offset:12288
    v_mfma_f32_16x16x32_bf16 v[68:71], v[200:203], v[36:39], v[68:71]
    ds_read_b64_tr_b16 v[214:215], v9 offset:12800
    v_mfma_f32_16x16x32_bf16 v[72:75], v[200:203], v[40:43], v[72:75]
    v_mfma_f32_16x16x32_bf16 v[76:79], v[200:203], v[44:47], v[76:79]
    buffer_load_dwordx4 v28, s[28:31], s51 offen offset:0 lds
    s_waitcnt lgkmcnt(4)
    v_mfma_f32_16x16x32_bf16 v[128:131], v[204:207], v[32:35], v[128:131]
    ds_read_b64_tr_b16 v[192:193], v10 offset:0
    s_add_u32 m0, s59, 8192
    v_mfma_f32_16x16x32_bf16 v[132:135], v[204:207], v[36:39], v[132:135]
    ds_read_b64_tr_b16 v[194:195], v10 offset:512
    s_add_u32 s66, s61, s5
    s_add_u32 s66, s66, -27648
    buffer_load_dwordx4 a[52:55], v15, s[32:35], s66 offen sc1
    v_mfma_f32_16x16x32_bf16 v[136:139], v[204:207], v[40:43], v[136:139]
    v_mfma_f32_16x16x32_bf16 v[140:143], v[204:207], v[44:47], v[140:143]
    s_waitcnt lgkmcnt(4)
    v_mfma_f32_16x16x32_bf16 v[64:67], v[208:211], v[48:51], v[64:67]
    ds_read_b64_tr_b16 v[196:197], v10 offset:8192
    v_mfma_f32_16x16x32_bf16 v[68:71], v[208:211], v[52:55], v[68:71]
    ds_read_b64_tr_b16 v[198:199], v10 offset:8704
    v_mfma_f32_16x16x32_bf16 v[72:75], v[208:211], v[56:59], v[72:75]
    v_mfma_f32_16x16x32_bf16 v[76:79], v[208:211], v[60:63], v[76:79]
    s_add_u32 s66, s61, s5
    s_add_u32 s66, s66, -26624
    buffer_load_dwordx4 a[56:59], v15, s[32:35], s66 offen sc1
    s_waitcnt lgkmcnt(4)
    v_mfma_f32_16x16x32_bf16 v[128:131], v[212:215], v[48:51], v[128:131]
    ds_read_b64_tr_b16 v[200:201], v10 offset:4096
    v_mfma_f32_16x16x32_bf16 v[132:135], v[212:215], v[52:55], v[132:135]
    ds_read_b64_tr_b16 v[202:203], v10 offset:4608
    v_mfma_f32_16x16x32_bf16 v[136:139], v[212:215], v[56:59], v[136:139]
    v_mfma_f32_16x16x32_bf16 v[140:143], v[212:215], v[60:63], v[140:143]
    buffer_load_dwordx4 v29, s[28:31], s51 offen offset:0 lds
    s_waitcnt lgkmcnt(4)
    v_mfma_f32_16x16x32_bf16 v[80:83], v[192:195], v[32:35], v[80:83]
    ds_read_b64_tr_b16 v[204:205], v10 offset:12288
    s_add_u32 m0, s59, 12288
    v_mfma_f32_16x16x32_bf16 v[84:87], v[192:195], v[36:39], v[84:87]
    ds_read_b64_tr_b16 v[206:207], v10 offset:12800
    s_add_u32 s66, s61, s5
    s_add_u32 s66, s66, -25600
    buffer_load_dwordx4 a[60:63], v15, s[32:35], s66 offen sc1
    v_mfma_f32_16x16x32_bf16 v[88:91], v[192:195], v[40:43], v[88:91]
    v_max_f32 v64, 0, v64
    v_max_f32 v65, 0, v65
    v_max_f32 v66, 0, v66
    v_mfma_f32_16x16x32_bf16 v[92:95], v[192:195], v[44:47], v[92:95]
    v_max_f32 v67, 0, v67
    v_mul_f32 v64, v64, v128
    v_mul_f32 v65, v65, v129
    s_waitcnt lgkmcnt(4)
    v_mfma_f32_16x16x32_bf16 v[144:147], v[196:199], v[32:35], v[144:147]
    ds_read_b64_tr_b16 v[208:209], v11 offset:0
    v_mul_f32 v66, v66, v130
    v_mul_f32 v67, v67, v131
    v_cvt_pk_bf16_f32 v224, v64, v65
    v_mfma_f32_16x16x32_bf16 v[148:151], v[196:199], v[36:39], v[148:151]
    ds_read_b64_tr_b16 v[210:211], v11 offset:512
    v_cvt_pk_bf16_f32 v225, v66, v67
    v_max_f32 v68, 0, v68
    v_max_f32 v69, 0, v69
    v_mfma_f32_16x16x32_bf16 v[152:155], v[196:199], v[40:43], v[152:155]
    v_max_f32 v70, 0, v70
    v_max_f32 v71, 0, v71
    v_mul_f32 v68, v68, v132
    v_mfma_f32_16x16x32_bf16 v[156:159], v[196:199], v[44:47], v[156:159]
    v_mul_f32 v69, v69, v133
    v_mul_f32 v70, v70, v134
    v_mul_f32 v71, v71, v135
    s_waitcnt lgkmcnt(4)
    v_mfma_f32_16x16x32_bf16 v[80:83], v[200:203], v[48:51], v[80:83]
    ds_read_b64_tr_b16 v[212:213], v11 offset:8192
    v_cvt_pk_bf16_f32 v228, v68, v69
    v_cvt_pk_bf16_f32 v229, v70, v71
    v_max_f32 v72, 0, v72
    v_mfma_f32_16x16x32_bf16 v[84:87], v[200:203], v[52:55], v[84:87]
    ds_read_b64_tr_b16 v[214:215], v11 offset:8704
    v_max_f32 v73, 0, v73
    v_max_f32 v74, 0, v74
    v_max_f32 v75, 0, v75
    v_mfma_f32_16x16x32_bf16 v[88:91], v[200:203], v[56:59], v[88:91]
    v_mul_f32 v72, v72, v136
    v_mul_f32 v73, v73, v137
    v_mul_f32 v74, v74, v138
    v_mfma_f32_16x16x32_bf16 v[92:95], v[200:203], v[60:63], v[92:95]
    buffer_load_dwordx4 v30, s[28:31], s51 offen offset:0 lds
    v_mul_f32 v75, v75, v139
    v_cvt_pk_bf16_f32 v232, v72, v73
    s_waitcnt lgkmcnt(4)
    v_mfma_f32_16x16x32_bf16 v[144:147], v[204:207], v[48:51], v[144:147]
    ds_read_b64_tr_b16 v[192:193], v11 offset:4096
    s_add_u32 m0, s60, 0
    v_cvt_pk_bf16_f32 v233, v74, v75
    v_max_f32 v76, 0, v76
    v_mfma_f32_16x16x32_bf16 v[148:151], v[204:207], v[52:55], v[148:151]
    ds_read_b64_tr_b16 v[194:195], v11 offset:4608
    v_max_f32 v77, 0, v77
    v_max_f32 v78, 0, v78
    v_max_f32 v79, 0, v79
    v_mfma_f32_16x16x32_bf16 v[152:155], v[204:207], v[56:59], v[152:155]
    v_mul_f32 v76, v76, v140
    v_mul_f32 v77, v77, v141
    v_mul_f32 v78, v78, v142
    v_mfma_f32_16x16x32_bf16 v[156:159], v[204:207], v[60:63], v[156:159]
    v_mul_f32 v79, v79, v143
    v_cvt_pk_bf16_f32 v236, v76, v77
    v_cvt_pk_bf16_f32 v237, v78, v79
    s_waitcnt lgkmcnt(4)
    v_mfma_f32_16x16x32_bf16 v[96:99], v[208:211], v[32:35], v[96:99]
    ds_read_b64_tr_b16 v[196:197], v11 offset:12288
    s_add_u32 s66, s61, s6
    s_add_u32 s66, s66, -32768
    buffer_load_dwordx4 a[64:67], v15, s[32:35], s66 offen sc1
    v_mfma_f32_16x16x32_bf16 v[100:103], v[208:211], v[36:39], v[100:103]
    ds_read_b64_tr_b16 v[198:199], v11 offset:12800
    v_mfma_f32_16x16x32_bf16 v[104:107], v[208:211], v[40:43], v[104:107]
    v_max_f32 v80, 0, v80
    v_max_f32 v81, 0, v81
    v_max_f32 v82, 0, v82
    v_mfma_f32_16x16x32_bf16 v[108:111], v[208:211], v[44:47], v[108:111]
    v_max_f32 v83, 0, v83
    v_mul_f32 v80, v80, v144
    v_mul_f32 v81, v81, v145
    s_waitcnt lgkmcnt(4)
    v_mfma_f32_16x16x32_bf16 v[160:163], v[212:215], v[32:35], v[160:163]
    ds_read_b64_tr_b16 v[200:201], v12 offset:0
    v_mul_f32 v82, v82, v146
    v_mul_f32 v83, v83, v147
    v_cvt_pk_bf16_f32 v226, v80, v81
    v_mfma_f32_16x16x32_bf16 v[164:167], v[212:215], v[36:39], v[164:167]
    ds_read_b64_tr_b16 v[202:203], v12 offset:512
    v_cvt_pk_bf16_f32 v227, v82, v83
    v_max_f32 v84, 0, v84
    v_max_f32 v85, 0, v85
    v_mfma_f32_16x16x32_bf16 v[168:171], v[212:215], v[40:43], v[168:171]
    v_max_f32 v86, 0, v86
    v_max_f32 v87, 0, v87
    v_mul_f32 v84, v84, v148
    v_mfma_f32_16x16x32_bf16 v[172:175], v[212:215], v[44:47], v[172:175]
    buffer_load_dwordx4 v31, s[28:31], s51 offen offset:0 lds
    v_mul_f32 v85, v85, v149
    v_mul_f32 v86, v86, v150
    s_waitcnt lgkmcnt(4)
    v_mfma_f32_16x16x32_bf16 v[96:99], v[192:195], v[48:51], v[96:99]
    ds_read_b64_tr_b16 v[204:205], v12 offset:8192
    s_add_u32 s51, s58, s8
    v_mul_f32 v87, v87, v151
    v_cvt_pk_bf16_f32 v230, v84, v85
    v_mfma_f32_16x16x32_bf16 v[100:103], v[192:195], v[52:55], v[100:103]
    ds_read_b64_tr_b16 v[206:207], v12 offset:8704
    s_add_u32 m0, s59, 73728
    v_cvt_pk_bf16_f32 v231, v86, v87
    v_max_f32 v88, 0, v88
    v_mfma_f32_16x16x32_bf16 v[104:107], v[192:195], v[56:59], v[104:107]
    buffer_load_dwordx4 v27, s[28:31], s51 offen offset:0 lds
    v_max_f32 v89, 0, v89
    v_max_f32 v90, 0, v90
    v_mfma_f32_16x16x32_bf16 v[108:111], v[192:195], v[60:63], v[108:111]
    s_add_u32 m0, s59, 77824
    v_max_f32 v91, 0, v91
    v_mul_f32 v88, v88, v152
    s_waitcnt lgkmcnt(4)
    v_mfma_f32_16x16x32_bf16 v[160:163], v[196:199], v[48:51], v[160:163]
    ds_read_b64_tr_b16 v[208:209], v12 offset:4096
    v_mul_f32 v89, v89, v153
    v_mul_f32 v90, v90, v154
    v_mul_f32 v91, v91, v155
    v_mfma_f32_16x16x32_bf16 v[164:167], v[196:199], v[52:55], v[164:167]
    ds_read_b64_tr_b16 v[210:211], v12 offset:4608
    v_cvt_pk_bf16_f32 v234, v88, v89
    v_cvt_pk_bf16_f32 v235, v90, v91
    v_max_f32 v92, 0, v92
    v_mfma_f32_16x16x32_bf16 v[168:171], v[196:199], v[56:59], v[168:171]
    v_max_f32 v93, 0, v93
    v_max_f32 v94, 0, v94
    v_max_f32 v95, 0, v95
    v_mfma_f32_16x16x32_bf16 v[172:175], v[196:199], v[60:63], v[172:175]
    v_mul_f32 v92, v92, v156
    v_mul_f32 v93, v93, v157
    v_mul_f32 v94, v94, v158
    s_waitcnt lgkmcnt(4)
    v_mfma_f32_16x16x32_bf16 v[112:115], v[200:203], v[32:35], v[112:115]
    ds_read_b64_tr_b16 v[212:213], v12 offset:12288
    v_mul_f32 v95, v95, v159
    v_cvt_pk_bf16_f32 v238, v92, v93
    v_cvt_pk_bf16_f32 v239, v94, v95
    v_mfma_f32_16x16x32_bf16 v[116:119], v[200:203], v[36:39], v[116:119]
    ds_read_b64_tr_b16 v[214:215], v12 offset:12800
    s_add_u32 s66, s54, 32768
    buffer_store_dwordx4 v[224:227], v15, s[32:35], s66 offen sc1
    v_mfma_f32_16x16x32_bf16 v[120:123], v[200:203], v[40:43], v[120:123]
    v_max_f32 v96, 0, v96
    v_max_f32 v97, 0, v97
    v_max_f32 v98, 0, v98
    v_mfma_f32_16x16x32_bf16 v[124:127], v[200:203], v[44:47], v[124:127]
    v_max_f32 v99, 0, v99
    v_mul_f32 v96, v96, v160
    v_mul_f32 v97, v97, v161
    s_waitcnt lgkmcnt(4)
    v_mfma_f32_16x16x32_bf16 v[176:179], v[204:207], v[32:35], v[176:179]
    s_barrier
    v_add_u32 v9, 129024, v14
    ds_read_b64_tr_b16 v[192:193], v9 offset:0
    v_mul_f32 v98, v98, v162
    v_mul_f32 v99, v99, v163
    v_cvt_pk_bf16_f32 v240, v96, v97
    v_mfma_f32_16x16x32_bf16 v[180:183], v[204:207], v[36:39], v[180:183]
    ds_read_b64_tr_b16 v[194:195], v9 offset:4608
    v_cvt_pk_bf16_f32 v241, v98, v99
    v_max_f32 v100, 0, v100
    v_max_f32 v101, 0, v101
    v_mfma_f32_16x16x32_bf16 v[184:187], v[204:207], v[40:43], v[184:187]
    buffer_load_dwordx4 v28, s[28:31], s51 offen offset:0 lds
    v_max_f32 v102, 0, v102
    v_max_f32 v103, 0, v103
    v_mfma_f32_16x16x32_bf16 v[188:191], v[204:207], v[44:47], v[188:191]
    s_add_u32 m0, s59, 81920
    v_mul_f32 v100, v100, v164
    v_mul_f32 v101, v101, v165
    s_waitcnt lgkmcnt(4)
    v_mfma_f32_16x16x32_bf16 v[112:115], v[208:211], v[48:51], v[112:115]
    ds_read_b64_tr_b16 v[196:197], v9 offset:32
    s_add_u32 s66, s54, 33792
    buffer_store_dwordx4 v[228:231], v15, s[32:35], s66 offen sc1
    v_mul_f32 v102, v102, v166
    v_mul_f32 v103, v103, v167
    v_mfma_f32_16x16x32_bf16 v[116:119], v[208:211], v[52:55], v[116:119]
    ds_read_b64_tr_b16 v[198:199], v9 offset:4640
    v_cvt_pk_bf16_f32 v244, v100, v101
    v_cvt_pk_bf16_f32 v245, v102, v103
    v_max_f32 v104, 0, v104
    v_mfma_f32_16x16x32_bf16 v[120:123], v[208:211], v[56:59], v[120:123]
    v_max_f32 v105, 0, v105
    v_max_f32 v106, 0, v106
    v_max_f32 v107, 0, v107
    v_mfma_f32_16x16x32_bf16 v[124:127], v[208:211], v[60:63], v[124:127]
    v_mul_f32 v104, v104, v168
    v_mul_f32 v105, v105, v169
    v_mul_f32 v106, v106, v170
    s_waitcnt lgkmcnt(4)
    v_mfma_f32_16x16x32_bf16 v[176:179], v[212:215], v[48:51], v[176:179]
    ds_read_b64_tr_b16 v[200:201], v9 offset:64
    v_mul_f32 v107, v107, v171
    v_cvt_pk_bf16_f32 v248, v104, v105
    v_cvt_pk_bf16_f32 v249, v106, v107
    v_mfma_f32_16x16x32_bf16 v[180:183], v[212:215], v[52:55], v[180:183]
    ds_read_b64_tr_b16 v[202:203], v9 offset:4672
    v_max_f32 v108, 0, v108
    v_max_f32 v109, 0, v109
    v_max_f32 v110, 0, v110
    v_mfma_f32_16x16x32_bf16 v[184:187], v[212:215], v[56:59], v[184:187]
    s_add_u32 s66, s54, 34816
    buffer_store_dwordx4 v[232:235], v15, s[32:35], s66 offen sc1
    v_max_f32 v111, 0, v111
    v_mul_f32 v108, v108, v172
    v_mfma_f32_16x16x32_bf16 v[188:191], v[212:215], v[60:63], v[188:191]
    v_mul_f32 v109, v109, v173
    v_mul_f32 v110, v110, v174
    v_mul_f32 v111, v111, v175
    s_waitcnt lgkmcnt(4)
    v_mfma_f32_16x16x32_bf16 v[32:35], v[192:195], a[0:3], 0
    ds_read_b64_tr_b16 v[204:205], v9 offset:96
    v_cvt_pk_bf16_f32 v252, v108, v109
    v_cvt_pk_bf16_f32 v253, v110, v111
    v_mfma_f32_16x16x32_bf16 v[36:39], v[192:195], a[4:7], 0
    ds_read_b64_tr_b16 v[206:207], v9 offset:4704
    s_add_u32 s66, s61, s6
    s_add_u32 s66, s66, -31744
    buffer_load_dwordx4 a[68:71], v15, s[32:35], s66 offen sc1
    v_mfma_f32_16x16x32_bf16 v[40:43], v[192:195], a[8:11], 0
    buffer_load_dwordx4 v29, s[28:31], s51 offen offset:0 lds
    v_max_f32 v112, 0, v112
    v_max_f32 v113, 0, v113
    v_mfma_f32_16x16x32_bf16 v[44:47], v[192:195], a[12:15], 0
    s_add_u32 m0, s59, 86016
    v_max_f32 v114, 0, v114
    v_max_f32 v115, 0, v115
    s_waitcnt lgkmcnt(4)
    v_mfma_f32_16x16x32_bf16 v[64:67], v[196:199], a[0:3], 0
    ds_read_b64_tr_b16 v[208:209], v9 offset:128
    s_add_u32 s66, s54, 35840
    buffer_store_dwordx4 v[236:239], v15, s[32:35], s66 offen sc1
    v_mul_f32 v112, v112, v176
    v_mul_f32 v113, v113, v177
    v_mfma_f32_16x16x32_bf16 v[68:71], v[196:199], a[4:7], 0
    ds_read_b64_tr_b16 v[210:211], v9 offset:4736
    v_mul_f32 v114, v114, v178
    v_mul_f32 v115, v115, v179
    v_cvt_pk_bf16_f32 v242, v112, v113
    v_mfma_f32_16x16x32_bf16 v[72:75], v[196:199], a[8:11], 0
    v_cvt_pk_bf16_f32 v243, v114, v115
    v_max_f32 v116, 0, v116
    v_max_f32 v117, 0, v117
    v_mfma_f32_16x16x32_bf16 v[76:79], v[196:199], a[12:15], 0
    v_max_f32 v118, 0, v118
    v_max_f32 v119, 0, v119
    v_mul_f32 v116, v116, v180
    s_waitcnt lgkmcnt(4)
    v_mfma_f32_16x16x32_bf16 v[128:131], v[200:203], a[0:3], 0
    ds_read_b64_tr_b16 v[212:213], v9 offset:160
    v_mul_f32 v117, v117, v181
    v_mul_f32 v118, v118, v182
    v_mul_f32 v119, v119, v183
    v_mfma_f32_16x16x32_bf16 v[132:135], v[200:203], a[4:7], 0
    ds_read_b64_tr_b16 v[214:215], v9 offset:4768
    v_cvt_pk_bf16_f32 v246, v116, v117
    v_cvt_pk_bf16_f32 v247, v118, v119
    v_max_f32 v120, 0, v120
    v_mfma_f32_16x16x32_bf16 v[136:139], v[200:203], a[8:11], 0
    v_max_f32 v121, 0, v121
    v_max_f32 v122, 0, v122
    v_max_f32 v123, 0, v123
    v_mfma_f32_16x16x32_bf16 v[140:143], v[200:203], a[12:15], 0
    v_mul_f32 v120, v120, v184
    v_mul_f32 v121, v121, v185
    v_mul_f32 v122, v122, v186
    s_waitcnt lgkmcnt(4)
    v_mfma_f32_16x16x32_bf16 v[80:83], v[204:207], a[0:3], 0
    ds_read_b64_tr_b16 v[192:193], v9 offset:192
    v_mul_f32 v123, v123, v187
    v_cvt_pk_bf16_f32 v250, v120, v121
    v_cvt_pk_bf16_f32 v251, v122, v123
    v_mfma_f32_16x16x32_bf16 v[84:87], v[204:207], a[4:7], 0
    ds_read_b64_tr_b16 v[194:195], v9 offset:4800
    v_max_f32 v124, 0, v124
    v_max_f32 v125, 0, v125
    v_max_f32 v126, 0, v126
    v_mfma_f32_16x16x32_bf16 v[88:91], v[204:207], a[8:11], 0
    buffer_load_dwordx4 v30, s[28:31], s51 offen offset:0 lds
    v_max_f32 v127, 0, v127
    v_mul_f32 v124, v124, v188
    v_mfma_f32_16x16x32_bf16 v[92:95], v[204:207], a[12:15], 0
    s_add_u32 m0, s60, 73728
    v_mul_f32 v125, v125, v189
    v_mul_f32 v126, v126, v190
    s_waitcnt lgkmcnt(4)
    v_mfma_f32_16x16x32_bf16 v[144:147], v[208:211], a[0:3], 0
    ds_read_b64_tr_b16 v[196:197], v9 offset:9216
    v_mul_f32 v127, v127, v191
    v_cvt_pk_bf16_f32 v254, v124, v125
    v_cvt_pk_bf16_f32 v255, v126, v127
    v_mfma_f32_16x16x32_bf16 v[148:151], v[208:211], a[4:7], 0
    ds_read_b64_tr_b16 v[198:199], v9 offset:13824
    s_add_u32 s66, s54, 36864
    buffer_store_dwordx4 v[240:243], v15, s[32:35], s66 offen sc1
    v_mfma_f32_16x16x32_bf16 v[152:155], v[208:211], a[8:11], 0
    v_mfma_f32_16x16x32_bf16 v[156:159], v[208:211], a[12:15], 0
    s_add_u32 s66, s61, s6
    s_add_u32 s66, s66, -30720
    buffer_load_dwordx4 a[72:75], v15, s[32:35], s66 offen sc1
    s_waitcnt lgkmcnt(4)
    v_mfma_f32_16x16x32_bf16 v[96:99], v[212:215], a[0:3], 0
    ds_read_b64_tr_b16 v[200:201], v9 offset:9248
    v_mfma_f32_16x16x32_bf16 v[100:103], v[212:215], a[4:7], 0
    ds_read_b64_tr_b16 v[202:203], v9 offset:13856
    v_mfma_f32_16x16x32_bf16 v[104:107], v[212:215], a[8:11], 0
    v_mfma_f32_16x16x32_bf16 v[108:111], v[212:215], a[12:15], 0
    s_add_u32 s66, s54, 37888
    buffer_store_dwordx4 v[244:247], v15, s[32:35], s66 offen sc1
    s_waitcnt lgkmcnt(4)
    v_mfma_f32_16x16x32_bf16 v[160:163], v[192:195], a[0:3], 0
    ds_read_b64_tr_b16 v[204:205], v9 offset:9280
    v_mfma_f32_16x16x32_bf16 v[164:167], v[192:195], a[4:7], 0
    ds_read_b64_tr_b16 v[206:207], v9 offset:13888
    s_add_u32 s66, s61, s6
    s_add_u32 s66, s66, -29696
    buffer_load_dwordx4 a[76:79], v15, s[32:35], s66 offen sc1
    v_mfma_f32_16x16x32_bf16 v[168:171], v[192:195], a[8:11], 0
    buffer_load_dwordx4 v31, s[28:31], s51 offen offset:0 lds
    v_mfma_f32_16x16x32_bf16 v[172:175], v[192:195], a[12:15], 0
    s_add_u32 s51, s58, s9
    s_waitcnt lgkmcnt(4)
    v_mfma_f32_16x16x32_bf16 v[32:35], v[196:199], a[16:19], v[32:35]
    ds_read_b64_tr_b16 v[208:209], v9 offset:9312
    s_add_u32 m0, s59, 92160
    v_mfma_f32_16x16x32_bf16 v[36:39], v[196:199], a[20:23], v[36:39]
    ds_read_b64_tr_b16 v[210:211], v9 offset:13920
    buffer_load_dwordx4 v27, s[28:31], s51 offen offset:0 lds
    v_mfma_f32_16x16x32_bf16 v[40:43], v[196:199], a[24:27], v[40:43]
    s_add_u32 m0, s59, 96256
    v_mfma_f32_16x16x32_bf16 v[44:47], v[196:199], a[28:31], v[44:47]
    s_add_u32 s66, s54, 38912
    buffer_store_dwordx4 v[248:251], v15, s[32:35], s66 offen sc1
    s_waitcnt lgkmcnt(4)
    v_mfma_f32_16x16x32_bf16 v[64:67], v[200:203], a[16:19], v[64:67]
    ds_read_b64_tr_b16 v[212:213], v9 offset:9344
    v_mfma_f32_16x16x32_bf16 v[68:71], v[200:203], a[20:23], v[68:71]
    ds_read_b64_tr_b16 v[214:215], v9 offset:13952
    s_add_u32 s66, s61, s6
    s_add_u32 s66, s66, -28672
    buffer_load_dwordx4 a[80:83], v15, s[32:35], s66 offen sc1
    v_mfma_f32_16x16x32_bf16 v[72:75], v[200:203], a[24:27], v[72:75]
    v_mfma_f32_16x16x32_bf16 v[76:79], v[200:203], a[28:31], v[76:79]
    s_waitcnt lgkmcnt(4)
    v_mfma_f32_16x16x32_bf16 v[128:131], v[204:207], a[16:19], v[128:131]
    ds_read_b64_tr_b16 v[192:193], v9 offset:9376
    v_mfma_f32_16x16x32_bf16 v[132:135], v[204:207], a[20:23], v[132:135]
    ds_read_b64_tr_b16 v[194:195], v9 offset:13984
    s_add_u32 s66, s54, 39936
    buffer_store_dwordx4 v[252:255], v15, s[32:35], s66 offen sc1
    v_mfma_f32_16x16x32_bf16 v[136:139], v[204:207], a[24:27], v[136:139]
    v_mfma_f32_16x16x32_bf16 v[140:143], v[204:207], a[28:31], v[140:143]
    s_add_u32 s66, s61, s6
    s_add_u32 s66, s66, -27648
    buffer_load_dwordx4 a[84:87], v15, s[32:35], s66 offen sc1
    s_waitcnt lgkmcnt(4)
    v_mfma_f32_16x16x32_bf16 v[80:83], v[208:211], a[16:19], v[80:83]
    ds_read_b64_tr_b16 v[196:197], v9 offset:9408
    v_mfma_f32_16x16x32_bf16 v[84:87], v[208:211], a[20:23], v[84:87]
    ds_read_b64_tr_b16 v[198:199], v9 offset:14016
    buffer_load_dwordx4 v28, s[28:31], s51 offen offset:0 lds
    v_mfma_f32_16x16x32_bf16 v[88:91], v[208:211], a[24:27], v[88:91]
    s_add_u32 m0, s59, 100352
    v_mfma_f32_16x16x32_bf16 v[92:95], v[208:211], a[28:31], v[92:95]
    s_waitcnt lgkmcnt(4)
    v_mfma_f32_16x16x32_bf16 v[144:147], v[212:215], a[16:19], v[144:147]
    ds_read_b64_tr_b16 v[200:201], v9 offset:224
    v_mfma_f32_16x16x32_bf16 v[148:151], v[212:215], a[20:23], v[148:151]
    ds_read_b64_tr_b16 v[202:203], v9 offset:4832
    s_add_u32 s66, s61, s6
    s_add_u32 s66, s66, -26624
    buffer_load_dwordx4 a[88:91], v15, s[32:35], s66 offen sc1
    v_mfma_f32_16x16x32_bf16 v[152:155], v[212:215], a[24:27], v[152:155]
    v_mfma_f32_16x16x32_bf16 v[156:159], v[212:215], a[28:31], v[156:159]
    s_waitcnt lgkmcnt(4)
    v_mfma_f32_16x16x32_bf16 v[96:99], v[192:195], a[16:19], v[96:99]
    ds_read_b64_tr_b16 v[204:205], v9 offset:256
    v_mfma_f32_16x16x32_bf16 v[100:103], v[192:195], a[20:23], v[100:103]
    ds_read_b64_tr_b16 v[206:207], v9 offset:4864
    v_mfma_f32_16x16x32_bf16 v[104:107], v[192:195], a[24:27], v[104:107]
    v_mfma_f32_16x16x32_bf16 v[108:111], v[192:195], a[28:31], v[108:111]
    s_add_u32 s66, s61, s6
    s_add_u32 s66, s66, -25600
    buffer_load_dwordx4 a[92:95], v15, s[32:35], s66 offen sc1
    s_waitcnt lgkmcnt(4)
    v_mfma_f32_16x16x32_bf16 v[160:163], v[196:199], a[16:19], v[160:163]
    ds_read_b64_tr_b16 v[208:209], v9 offset:9440
    v_mfma_f32_16x16x32_bf16 v[164:167], v[196:199], a[20:23], v[164:167]
    ds_read_b64_tr_b16 v[210:211], v9 offset:14048
    buffer_load_dwordx4 v29, s[28:31], s51 offen offset:0 lds
    v_mfma_f32_16x16x32_bf16 v[168:171], v[196:199], a[24:27], v[168:171]
    s_add_u32 m0, s59, 104448
    v_mfma_f32_16x16x32_bf16 v[172:175], v[196:199], a[28:31], v[172:175]
    s_waitcnt lgkmcnt(4)
    v_mfma_f32_16x16x32_bf16 v[112:115], v[200:203], a[0:3], 0
    ds_read_b64_tr_b16 v[212:213], v9 offset:9472
    v_mfma_f32_16x16x32_bf16 v[116:119], v[200:203], a[4:7], 0
    ds_read_b64_tr_b16 v[214:215], v9 offset:14080
    s_add_u32 s66, s61, s7
    s_add_u32 s66, s66, -32768
    buffer_load_dwordx4 a[96:99], v15, s[32:35], s66 offen sc1
    v_mfma_f32_16x16x32_bf16 v[120:123], v[200:203], a[8:11], 0
    v_mfma_f32_16x16x32_bf16 v[124:127], v[200:203], a[12:15], 0
    s_waitcnt lgkmcnt(4)
    v_mfma_f32_16x16x32_bf16 v[176:179], v[204:207], a[0:3], 0
    v_add_u32 v9, 18432, v14
    ds_read_b64_tr_b16 v[192:193], v9 offset:0
    v_mfma_f32_16x16x32_bf16 v[180:183], v[204:207], a[4:7], 0
    ds_read_b64_tr_b16 v[194:195], v9 offset:4608
    v_mfma_f32_16x16x32_bf16 v[184:187], v[204:207], a[8:11], 0
    v_mfma_f32_16x16x32_bf16 v[188:191], v[204:207], a[12:15], 0
    s_add_u32 s66, s61, s7
    s_add_u32 s66, s66, -31744
    buffer_load_dwordx4 a[100:103], v15, s[32:35], s66 offen sc1
    s_waitcnt lgkmcnt(4)
    v_mfma_f32_16x16x32_bf16 v[112:115], v[208:211], a[16:19], v[112:115]
    ds_read_b64_tr_b16 v[196:197], v9 offset:32
    v_mfma_f32_16x16x32_bf16 v[116:119], v[208:211], a[20:23], v[116:119]
    ds_read_b64_tr_b16 v[198:199], v9 offset:4640
    buffer_load_dwordx4 v30, s[28:31], s51 offen offset:0 lds
    v_mfma_f32_16x16x32_bf16 v[120:123], v[208:211], a[24:27], v[120:123]
    s_add_u32 m0, s60, 92160
    v_mfma_f32_16x16x32_bf16 v[124:127], v[208:211], a[28:31], v[124:127]
    s_waitcnt lgkmcnt(4)
    v_mfma_f32_16x16x32_bf16 v[176:179], v[212:215], a[16:19], v[176:179]
    ds_read_b64_tr_b16 v[200:201], v9 offset:64
    v_mfma_f32_16x16x32_bf16 v[180:183], v[212:215], a[20:23], v[180:183]
    ds_read_b64_tr_b16 v[202:203], v9 offset:4672
    s_add_u32 s66, s61, s7
    s_add_u32 s66, s66, -30720
    buffer_load_dwordx4 a[104:107], v15, s[32:35], s66 offen sc1
    v_mfma_f32_16x16x32_bf16 v[184:187], v[212:215], a[24:27], v[184:187]
    v_mfma_f32_16x16x32_bf16 v[188:191], v[212:215], a[28:31], v[188:191]
    s_waitcnt vmcnt(40) lgkmcnt(4)
    v_mfma_f32_16x16x32_bf16 v[32:35], v[192:195], a[32:35], v[32:35]
    ds_read_b64_tr_b16 v[204:205], v9 offset:96
    s_waitcnt vmcnt(39)
    v_mfma_f32_16x16x32_bf16 v[36:39], v[192:195], a[36:39], v[36:39]
    ds_read_b64_tr_b16 v[206:207], v9 offset:4704
    s_waitcnt vmcnt(38)
    v_mfma_f32_16x16x32_bf16 v[40:43], v[192:195], a[40:43], v[40:43]
    s_waitcnt vmcnt(36)
    v_mfma_f32_16x16x32_bf16 v[44:47], v[192:195], a[44:47], v[44:47]
    s_add_u32 s66, s61, s7
    s_add_u32 s66, s66, -29696
    buffer_load_dwordx4 a[108:111], v15, s[32:35], s66 offen sc1
    s_waitcnt lgkmcnt(4)
    v_mfma_f32_16x16x32_bf16 v[64:67], v[196:199], a[32:35], v[64:67]
    ds_read_b64_tr_b16 v[208:209], v9 offset:128
    v_mfma_f32_16x16x32_bf16 v[68:71], v[196:199], a[36:39], v[68:71]
    ds_read_b64_tr_b16 v[210:211], v9 offset:4736
    buffer_load_dwordx4 v31, s[28:31], s51 offen offset:0 lds
    v_mfma_f32_16x16x32_bf16 v[72:75], v[196:199], a[40:43], v[72:75]
    v_mfma_f32_16x16x32_bf16 v[76:79], v[196:199], a[44:47], v[76:79]
    s_waitcnt lgkmcnt(4)
    v_mfma_f32_16x16x32_bf16 v[128:131], v[200:203], a[32:35], v[128:131]
    ds_read_b64_tr_b16 v[212:213], v9 offset:160
    v_mfma_f32_16x16x32_bf16 v[132:135], v[200:203], a[36:39], v[132:135]
    ds_read_b64_tr_b16 v[214:215], v9 offset:4768
    s_add_u32 s66, s61, s7
    s_add_u32 s66, s66, -28672
    buffer_load_dwordx4 a[112:115], v15, s[32:35], s66 offen sc1
    v_mfma_f32_16x16x32_bf16 v[136:139], v[200:203], a[40:43], v[136:139]
    v_mfma_f32_16x16x32_bf16 v[140:143], v[200:203], a[44:47], v[140:143]
    s_waitcnt lgkmcnt(4)
    v_mfma_f32_16x16x32_bf16 v[80:83], v[204:207], a[32:35], v[80:83]
    ds_read_b64_tr_b16 v[192:193], v9 offset:192
    v_mfma_f32_16x16x32_bf16 v[84:87], v[204:207], a[36:39], v[84:87]
    ds_read_b64_tr_b16 v[194:195], v9 offset:4800
    v_mfma_f32_16x16x32_bf16 v[88:91], v[204:207], a[40:43], v[88:91]
    v_mfma_f32_16x16x32_bf16 v[92:95], v[204:207], a[44:47], v[92:95]
    s_add_u32 s66, s61, s7
    s_add_u32 s66, s66, -27648
    buffer_load_dwordx4 a[116:119], v15, s[32:35], s66 offen sc1
    s_waitcnt lgkmcnt(4)
    v_mfma_f32_16x16x32_bf16 v[144:147], v[208:211], a[32:35], v[144:147]
    ds_read_b64_tr_b16 v[196:197], v9 offset:224
    v_mfma_f32_16x16x32_bf16 v[148:151], v[208:211], a[36:39], v[148:151]
    ds_read_b64_tr_b16 v[198:199], v9 offset:4832
    v_mfma_f32_16x16x32_bf16 v[152:155], v[208:211], a[40:43], v[152:155]
    v_mfma_f32_16x16x32_bf16 v[156:159], v[208:211], a[44:47], v[156:159]
    s_waitcnt lgkmcnt(4)
    v_mfma_f32_16x16x32_bf16 v[96:99], v[212:215], a[32:35], v[96:99]
    ds_read_b64_tr_b16 v[200:201], v9 offset:256
    v_mfma_f32_16x16x32_bf16 v[100:103], v[212:215], a[36:39], v[100:103]
    ds_read_b64_tr_b16 v[202:203], v9 offset:4864
    s_add_u32 s66, s61, s7
    s_add_u32 s66, s66, -26624
    buffer_load_dwordx4 a[120:123], v15, s[32:35], s66 offen sc1
    v_mfma_f32_16x16x32_bf16 v[104:107], v[212:215], a[40:43], v[104:107]
    v_mfma_f32_16x16x32_bf16 v[108:111], v[212:215], a[44:47], v[108:111]
    s_waitcnt lgkmcnt(4)
    v_mfma_f32_16x16x32_bf16 v[160:163], v[192:195], a[32:35], v[160:163]
    ds_read_b64_tr_b16 v[204:205], v9 offset:9216
    v_mfma_f32_16x16x32_bf16 v[164:167], v[192:195], a[36:39], v[164:167]
    ds_read_b64_tr_b16 v[206:207], v9 offset:13824
    v_mfma_f32_16x16x32_bf16 v[168:171], v[192:195], a[40:43], v[168:171]
    v_mfma_f32_16x16x32_bf16 v[172:175], v[192:195], a[44:47], v[172:175]
    s_add_u32 s66, s61, s7
    s_add_u32 s66, s66, -25600
    buffer_load_dwordx4 a[124:127], v15, s[32:35], s66 offen sc1
    s_waitcnt lgkmcnt(4)
    v_mfma_f32_16x16x32_bf16 v[112:115], v[196:199], a[32:35], v[112:115]
    ds_read_b64_tr_b16 v[208:209], v9 offset:9248
    v_mfma_f32_16x16x32_bf16 v[116:119], v[196:199], a[36:39], v[116:119]
    ds_read_b64_tr_b16 v[210:211], v9 offset:13856
    v_mfma_f32_16x16x32_bf16 v[120:123], v[196:199], a[40:43], v[120:123]
    v_mfma_f32_16x16x32_bf16 v[124:127], v[196:199], a[44:47], v[124:127]
    s_waitcnt lgkmcnt(4)
    v_mfma_f32_16x16x32_bf16 v[176:179], v[200:203], a[32:35], v[176:179]
    ds_read_b64_tr_b16 v[212:213], v9 offset:9280
    v_mfma_f32_16x16x32_bf16 v[180:183], v[200:203], a[36:39], v[180:183]
    ds_read_b64_tr_b16 v[214:215], v9 offset:13888
    s_add_u32 s66, s63, 0
    buffer_load_dwordx2 a[128:129], v16, s[32:35], s66 offen sc1
    v_mfma_f32_16x16x32_bf16 v[184:187], v[200:203], a[40:43], v[184:187]
    v_mfma_f32_16x16x32_bf16 v[188:191], v[200:203], a[44:47], v[188:191]
    s_waitcnt vmcnt(42) lgkmcnt(4)
    v_mfma_f32_16x16x32_bf16 v[32:35], v[204:207], a[48:51], v[32:35]
    ds_read_b64_tr_b16 v[192:193], v9 offset:9312
    s_waitcnt vmcnt(40)
    v_mfma_f32_16x16x32_bf16 v[36:39], v[204:207], a[52:55], v[36:39]
    ds_read_b64_tr_b16 v[194:195], v9 offset:13920
    s_add_u32 s66, s63, 8192
    buffer_load_dwordx2 a[130:131], v16, s[32:35], s66 offen sc1
    s_waitcnt vmcnt(40)
    v_mfma_f32_16x16x32_bf16 v[40:43], v[204:207], a[56:59], v[40:43]
    s_waitcnt vmcnt(38)
    v_mfma_f32_16x16x32_bf16 v[44:47], v[204:207], a[60:63], v[44:47]
    s_waitcnt lgkmcnt(4)
    v_mfma_f32_16x16x32_bf16 v[64:67], v[208:211], a[48:51], v[64:67]
    ds_read_b64_tr_b16 v[196:197], v9 offset:9344
    v_mfma_f32_16x16x32_bf16 v[68:71], v[208:211], a[52:55], v[68:71]
    ds_read_b64_tr_b16 v[198:199], v9 offset:13952
    s_add_u32 s66, s63, 512
    buffer_load_dwordx2 a[132:133], v16, s[32:35], s66 offen sc1
    v_mfma_f32_16x16x32_bf16 v[72:75], v[208:211], a[56:59], v[72:75]
    v_mfma_f32_16x16x32_bf16 v[76:79], v[208:211], a[60:63], v[76:79]
    s_waitcnt lgkmcnt(4)
    v_mfma_f32_16x16x32_bf16 v[128:131], v[212:215], a[48:51], v[128:131]
    ds_read_b64_tr_b16 v[200:201], v9 offset:9376
    v_mfma_f32_16x16x32_bf16 v[132:135], v[212:215], a[52:55], v[132:135]
    ds_read_b64_tr_b16 v[202:203], v9 offset:13984
    s_add_u32 s66, s63, 8704
    buffer_load_dwordx2 a[134:135], v16, s[32:35], s66 offen sc1
    v_mfma_f32_16x16x32_bf16 v[136:139], v[212:215], a[56:59], v[136:139]
    v_mfma_f32_16x16x32_bf16 v[140:143], v[212:215], a[60:63], v[140:143]
    s_waitcnt lgkmcnt(4)
    v_mfma_f32_16x16x32_bf16 v[80:83], v[192:195], a[48:51], v[80:83]
    ds_read_b64_tr_b16 v[204:205], v9 offset:9408
    v_mfma_f32_16x16x32_bf16 v[84:87], v[192:195], a[52:55], v[84:87]
    ds_read_b64_tr_b16 v[206:207], v9 offset:14016
    s_add_u32 s66, s63, 1024
    buffer_load_dwordx2 a[136:137], v16, s[32:35], s66 offen sc1
    v_mfma_f32_16x16x32_bf16 v[88:91], v[192:195], a[56:59], v[88:91]
    v_mfma_f32_16x16x32_bf16 v[92:95], v[192:195], a[60:63], v[92:95]
    s_waitcnt lgkmcnt(4)
    v_mfma_f32_16x16x32_bf16 v[144:147], v[196:199], a[48:51], v[144:147]
    ds_read_b64_tr_b16 v[208:209], v9 offset:9440
    v_mfma_f32_16x16x32_bf16 v[148:151], v[196:199], a[52:55], v[148:151]
    ds_read_b64_tr_b16 v[210:211], v9 offset:14048
    s_add_u32 s66, s63, 9216
    buffer_load_dwordx2 a[138:139], v16, s[32:35], s66 offen sc1
    v_mfma_f32_16x16x32_bf16 v[152:155], v[196:199], a[56:59], v[152:155]
    v_mfma_f32_16x16x32_bf16 v[156:159], v[196:199], a[60:63], v[156:159]
    s_waitcnt lgkmcnt(4)
    v_mfma_f32_16x16x32_bf16 v[96:99], v[200:203], a[48:51], v[96:99]
    ds_read_b64_tr_b16 v[212:213], v9 offset:9472
    v_mfma_f32_16x16x32_bf16 v[100:103], v[200:203], a[52:55], v[100:103]
    ds_read_b64_tr_b16 v[214:215], v9 offset:14080
    s_add_u32 s66, s63, 1536
    buffer_load_dwordx2 a[140:141], v16, s[32:35], s66 offen sc1
    v_mfma_f32_16x16x32_bf16 v[104:107], v[200:203], a[56:59], v[104:107]
    v_mfma_f32_16x16x32_bf16 v[108:111], v[200:203], a[60:63], v[108:111]
    s_waitcnt lgkmcnt(4)
    v_mfma_f32_16x16x32_bf16 v[160:163], v[204:207], a[48:51], v[160:163]
    s_waitcnt vmcnt(22)
    s_barrier
    s_lshl_b32 s66, s47, 2
    s_add_u32 s66, s66, s68
    s_add_u32 s66, s66, 65536
    buffer_store_dword v0, off, s[32:35], s66 sc1
    v_add_u32 v9, 36864, v14
    ds_read_b64_tr_b16 v[192:193], v9 offset:0
    v_mfma_f32_16x16x32_bf16 v[164:167], v[204:207], a[52:55], v[164:167]
    ds_read_b64_tr_b16 v[194:195], v9 offset:4608
    s_add_u32 s51, s58, s10
    v_mfma_f32_16x16x32_bf16 v[168:171], v[204:207], a[56:59], v[168:171]
    s_add_u32 m0, s59, 110592
    v_mfma_f32_16x16x32_bf16 v[172:175], v[204:207], a[60:63], v[172:175]
    buffer_load_dwordx4 v27, s[28:31], s51 offen offset:0 lds
    s_waitcnt lgkmcnt(4)
    v_mfma_f32_16x16x32_bf16 v[112:115], v[208:211], a[48:51], v[112:115]
    ds_read_b64_tr_b16 v[196:197], v9 offset:32
    s_add_u32 m0, s59, 114688
    v_mfma_f32_16x16x32_bf16 v[116:119], v[208:211], a[52:55], v[116:119]
    ds_read_b64_tr_b16 v[198:199], v9 offset:4640
    s_add_u32 s66, s63, 9728
    buffer_load_dwordx2 a[142:143], v16, s[32:35], s66 offen sc1
    v_mfma_f32_16x16x32_bf16 v[120:123], v[208:211], a[56:59], v[120:123]
    v_mfma_f32_16x16x32_bf16 v[124:127], v[208:211], a[60:63], v[124:127]
    s_waitcnt lgkmcnt(4)
    v_mfma_f32_16x16x32_bf16 v[176:179], v[212:215], a[48:51], v[176:179]
    ds_read_b64_tr_b16 v[200:201], v9 offset:64
    s_add_u32 s66, s63, 16384
    buffer_load_dwordx2 a[144:145], v16, s[32:35], s66 offen sc1
    v_mfma_f32_16x16x32_bf16 v[180:183], v[212:215], a[52:55], v[180:183]
    ds_read_b64_tr_b16 v[202:203], v9 offset:4672
    v_mfma_f32_16x16x32_bf16 v[184:187], v[212:215], a[56:59], v[184:187]
    v_mfma_f32_16x16x32_bf16 v[188:191], v[212:215], a[60:63], v[188:191]
    s_waitcnt lgkmcnt(4)
    v_mfma_f32_16x16x32_bf16 v[32:35], v[192:195], a[64:67], v[32:35]
    ds_read_b64_tr_b16 v[204:205], v9 offset:96
    s_add_u32 s66, s63, 24576
    buffer_load_dwordx2 a[146:147], v16, s[32:35], s66 offen sc1
    v_mfma_f32_16x16x32_bf16 v[36:39], v[192:195], a[68:71], v[36:39]
    ds_read_b64_tr_b16 v[206:207], v9 offset:4704
    v_mfma_f32_16x16x32_bf16 v[40:43], v[192:195], a[72:75], v[40:43]
    v_mfma_f32_16x16x32_bf16 v[44:47], v[192:195], a[76:79], v[44:47]
    buffer_load_dwordx4 v28, s[28:31], s51 offen offset:0 lds
    s_waitcnt lgkmcnt(4)
    v_mfma_f32_16x16x32_bf16 v[64:67], v[196:199], a[64:67], v[64:67]
    ds_read_b64_tr_b16 v[208:209], v9 offset:128
    s_add_u32 m0, s59, 118784
    v_mfma_f32_16x16x32_bf16 v[68:71], v[196:199], a[68:71], v[68:71]
    ds_read_b64_tr_b16 v[210:211], v9 offset:4736
    s_add_u32 s66, s63, 16896
    buffer_load_dwordx2 a[148:149], v16, s[32:35], s66 offen sc1
    v_mfma_f32_16x16x32_bf16 v[72:75], v[196:199], a[72:75], v[72:75]
    v_mfma_f32_16x16x32_bf16 v[76:79], v[196:199], a[76:79], v[76:79]
    s_waitcnt lgkmcnt(4)
    v_mfma_f32_16x16x32_bf16 v[128:131], v[200:203], a[64:67], v[128:131]
    ds_read_b64_tr_b16 v[212:213], v9 offset:160
    v_mfma_f32_16x16x32_bf16 v[132:135], v[200:203], a[68:71], v[132:135]
    ds_read_b64_tr_b16 v[214:215], v9 offset:4768
    s_add_u32 s66, s63, 25088
    buffer_load_dwordx2 a[150:151], v16, s[32:35], s66 offen sc1
    v_mfma_f32_16x16x32_bf16 v[136:139], v[200:203], a[72:75], v[136:139]
    v_mfma_f32_16x16x32_bf16 v[140:143], v[200:203], a[76:79], v[140:143]
    s_waitcnt lgkmcnt(4)
    v_mfma_f32_16x16x32_bf16 v[80:83], v[204:207], a[64:67], v[80:83]
    ds_read_b64_tr_b16 v[192:193], v9 offset:192
    v_mfma_f32_16x16x32_bf16 v[84:87], v[204:207], a[68:71], v[84:87]
    ds_read_b64_tr_b16 v[194:195], v9 offset:4800
    s_add_u32 s66, s63, 17408
    buffer_load_dwordx2 a[152:153], v16, s[32:35], s66 offen sc1
    v_mfma_f32_16x16x32_bf16 v[88:91], v[204:207], a[72:75], v[88:91]
    v_mfma_f32_16x16x32_bf16 v[92:95], v[204:207], a[76:79], v[92:95]
    buffer_load_dwordx4 v29, s[28:31], s51 offen offset:0 lds
    s_waitcnt lgkmcnt(4)
    v_mfma_f32_16x16x32_bf16 v[144:147], v[208:211], a[64:67], v[144:147]
    ds_read_b64_tr_b16 v[196:197], v9 offset:224
    s_add_u32 m0, s59, 122880
    v_mfma_f32_16x16x32_bf16 v[148:151], v[208:211], a[68:71], v[148:151]
    ds_read_b64_tr_b16 v[198:199], v9 offset:4832
    s_add_u32 s66, s63, 25600
    buffer_load_dwordx2 a[154:155], v16, s[32:35], s66 offen sc1
    v_mfma_f32_16x16x32_bf16 v[152:155], v[208:211], a[72:75], v[152:155]
    v_mfma_f32_16x16x32_bf16 v[156:159], v[208:211], a[76:79], v[156:159]
    s_waitcnt lgkmcnt(4)
    v_mfma_f32_16x16x32_bf16 v[96:99], v[212:215], a[64:67], v[96:99]
    ds_read_b64_tr_b16 v[200:201], v9 offset:256
    v_mfma_f32_16x16x32_bf16 v[100:103], v[212:215], a[68:71], v[100:103]
    ds_read_b64_tr_b16 v[202:203], v9 offset:4864
    s_add_u32 s66, s63, 17920
    buffer_load_dwordx2 a[156:157], v16, s[32:35], s66 offen sc1
    v_mfma_f32_16x16x32_bf16 v[104:107], v[212:215], a[72:75], v[104:107]
    v_mfma_f32_16x16x32_bf16 v[108:111], v[212:215], a[76:79], v[108:111]
    s_waitcnt lgkmcnt(4)
    v_mfma_f32_16x16x32_bf16 v[160:163], v[192:195], a[64:67], v[160:163]
    ds_read_b64_tr_b16 v[204:205], v9 offset:9216
    v_mfma_f32_16x16x32_bf16 v[164:167], v[192:195], a[68:71], v[164:167]
    ds_read_b64_tr_b16 v[206:207], v9 offset:13824
    s_add_u32 s66, s63, 26112
    buffer_load_dwordx2 a[158:159], v16, s[32:35], s66 offen sc1
    v_mfma_f32_16x16x32_bf16 v[168:171], v[192:195], a[72:75], v[168:171]
    v_mfma_f32_16x16x32_bf16 v[172:175], v[192:195], a[76:79], v[172:175]
    buffer_load_dwordx4 v30, s[28:31], s51 offen offset:0 lds
    s_waitcnt lgkmcnt(4)
    v_mfma_f32_16x16x32_bf16 v[112:115], v[196:199], a[64:67], v[112:115]
    ds_read_b64_tr_b16 v[208:209], v9 offset:9248
    s_add_u32 m0, s60, 110592
    v_mfma_f32_16x16x32_bf16 v[116:119], v[196:199], a[68:71], v[116:119]
    ds_read_b64_tr_b16 v[210:211], v9 offset:13856
    v_mfma_f32_16x16x32_bf16 v[120:123], v[196:199], a[72:75], v[120:123]
    v_mfma_f32_16x16x32_bf16 v[124:127], v[196:199], a[76:79], v[124:127]
    s_waitcnt lgkmcnt(4)
    v_mfma_f32_16x16x32_bf16 v[176:179], v[200:203], a[64:67], v[176:179]
    ds_read_b64_tr_b16 v[212:213], v9 offset:9280
    v_mfma_f32_16x16x32_bf16 v[180:183], v[200:203], a[68:71], v[180:183]
    ds_read_b64_tr_b16 v[214:215], v9 offset:13888
    v_mfma_f32_16x16x32_bf16 v[184:187], v[200:203], a[72:75], v[184:187]
    v_mfma_f32_16x16x32_bf16 v[188:191], v[200:203], a[76:79], v[188:191]
    s_waitcnt lgkmcnt(4)
    v_mfma_f32_16x16x32_bf16 v[32:35], v[204:207], a[80:83], v[32:35]
    ds_read_b64_tr_b16 v[192:193], v9 offset:9312
    s_waitcnt vmcnt(35)
    v_mfma_f32_16x16x32_bf16 v[36:39], v[204:207], a[84:87], v[36:39]
    ds_read_b64_tr_b16 v[194:195], v9 offset:13920
    s_waitcnt vmcnt(33)
    v_mfma_f32_16x16x32_bf16 v[40:43], v[204:207], a[88:91], v[40:43]
    s_waitcnt vmcnt(32)
    v_mfma_f32_16x16x32_bf16 v[44:47], v[204:207], a[92:95], v[44:47]
    buffer_load_dwordx4 v31, s[28:31], s51 offen offset:0 lds
    s_waitcnt lgkmcnt(4)
    v_mfma_f32_16x16x32_bf16 v[64:67], v[208:211], a[80:83], v[64:67]
    ds_read_b64_tr_b16 v[196:197], v9 offset:9344
    s_add_u32 s51, s58, s11
    v_mfma_f32_16x16x32_bf16 v[68:71], v[208:211], a[84:87], v[68:71]
    ds_read_b64_tr_b16 v[198:199], v9 offset:13952
    s_add_u32 m0, s59, 129024
    v_mfma_f32_16x16x32_bf16 v[72:75], v[208:211], a[88:91], v[72:75]
    buffer_load_dwordx4 v27, s[28:31], s51 offen offset:0 lds
    v_mfma_f32_16x16x32_bf16 v[76:79], v[208:211], a[92:95], v[76:79]
    s_add_u32 m0, s59, 133120
    s_waitcnt lgkmcnt(4)
    v_mfma_f32_16x16x32_bf16 v[128:131], v[212:215], a[80:83], v[128:131]
    ds_read_b64_tr_b16 v[200:201], v9 offset:9376
    v_mfma_f32_16x16x32_bf16 v[132:135], v[212:215], a[84:87], v[132:135]
    ds_read_b64_tr_b16 v[202:203], v9 offset:13984
    v_mfma_f32_16x16x32_bf16 v[136:139], v[212:215], a[88:91], v[136:139]
    v_mfma_f32_16x16x32_bf16 v[140:143], v[212:215], a[92:95], v[140:143]
    s_waitcnt lgkmcnt(4)
    v_mfma_f32_16x16x32_bf16 v[80:83], v[192:195], a[80:83], v[80:83]
    ds_read_b64_tr_b16 v[204:205], v9 offset:9408
    v_mfma_f32_16x16x32_bf16 v[84:87], v[192:195], a[84:87], v[84:87]
    ds_read_b64_tr_b16 v[206:207], v9 offset:14016
    v_mfma_f32_16x16x32_bf16 v[88:91], v[192:195], a[88:91], v[88:91]
    v_mfma_f32_16x16x32_bf16 v[92:95], v[192:195], a[92:95], v[92:95]
    s_waitcnt lgkmcnt(4)
    v_mfma_f32_16x16x32_bf16 v[144:147], v[196:199], a[80:83], v[144:147]
    ds_read_b64_tr_b16 v[208:209], v9 offset:9440
    v_mfma_f32_16x16x32_bf16 v[148:151], v[196:199], a[84:87], v[148:151]
    ds_read_b64_tr_b16 v[210:211], v9 offset:14048
    v_mfma_f32_16x16x32_bf16 v[152:155], v[196:199], a[88:91], v[152:155]
    buffer_load_dwordx4 v28, s[28:31], s51 offen offset:0 lds
    v_mfma_f32_16x16x32_bf16 v[156:159], v[196:199], a[92:95], v[156:159]
    s_add_u32 m0, s59, 137216
    s_waitcnt lgkmcnt(4)
    v_mfma_f32_16x16x32_bf16 v[96:99], v[200:203], a[80:83], v[96:99]
    ds_read_b64_tr_b16 v[212:213], v9 offset:9472
    v_mfma_f32_16x16x32_bf16 v[100:103], v[200:203], a[84:87], v[100:103]
    ds_read_b64_tr_b16 v[214:215], v9 offset:14080
    v_mfma_f32_16x16x32_bf16 v[104:107], v[200:203], a[88:91], v[104:107]
    v_mfma_f32_16x16x32_bf16 v[108:111], v[200:203], a[92:95], v[108:111]
    s_waitcnt lgkmcnt(4)
    v_mfma_f32_16x16x32_bf16 v[160:163], v[204:207], a[80:83], v[160:163]
    v_add_u32 v9, 55296, v14
    ds_read_b64_tr_b16 v[192:193], v9 offset:0
    v_mfma_f32_16x16x32_bf16 v[164:167], v[204:207], a[84:87], v[164:167]
    ds_read_b64_tr_b16 v[194:195], v9 offset:4608
    v_mfma_f32_16x16x32_bf16 v[168:171], v[204:207], a[88:91], v[168:171]
    v_mfma_f32_16x16x32_bf16 v[172:175], v[204:207], a[92:95], v[172:175]
    s_waitcnt lgkmcnt(4)
    v_mfma_f32_16x16x32_bf16 v[112:115], v[208:211], a[80:83], v[112:115]
    ds_read_b64_tr_b16 v[196:197], v9 offset:32
    v_mfma_f32_16x16x32_bf16 v[116:119], v[208:211], a[84:87], v[116:119]
    ds_read_b64_tr_b16 v[198:199], v9 offset:4640
    v_mfma_f32_16x16x32_bf16 v[120:123], v[208:211], a[88:91], v[120:123]
    buffer_load_dwordx4 v29, s[28:31], s51 offen offset:0 lds
    v_mfma_f32_16x16x32_bf16 v[124:127], v[208:211], a[92:95], v[124:127]
    s_add_u32 m0, s59, 141312
    s_waitcnt lgkmcnt(4)
    v_mfma_f32_16x16x32_bf16 v[176:179], v[212:215], a[80:83], v[176:179]
    ds_read_b64_tr_b16 v[200:201], v9 offset:64
    v_mfma_f32_16x16x32_bf16 v[180:183], v[212:215], a[84:87], v[180:183]
    ds_read_b64_tr_b16 v[202:203], v9 offset:4672
    v_mfma_f32_16x16x32_bf16 v[184:187], v[212:215], a[88:91], v[184:187]
    v_mfma_f32_16x16x32_bf16 v[188:191], v[212:215], a[92:95], v[188:191]
    s_waitcnt vmcnt(34) lgkmcnt(4)
    v_mfma_f32_16x16x32_bf16 v[32:35], v[192:195], a[96:99], v[32:35]
    ds_read_b64_tr_b16 v[204:205], v9 offset:96
    s_waitcnt vmcnt(33)
    v_mfma_f32_16x16x32_bf16 v[36:39], v[192:195], a[100:103], v[36:39]
    ds_read_b64_tr_b16 v[206:207], v9 offset:4704
    s_waitcnt vmcnt(31)
    v_mfma_f32_16x16x32_bf16 v[40:43], v[192:195], a[104:107], v[40:43]
    s_waitcnt vmcnt(30)
    v_mfma_f32_16x16x32_bf16 v[44:47], v[192:195], a[108:111], v[44:47]
    s_waitcnt lgkmcnt(4)
    v_mfma_f32_16x16x32_bf16 v[64:67], v[196:199], a[96:99], v[64:67]
    ds_read_b64_tr_b16 v[208:209], v9 offset:128
    v_mfma_f32_16x16x32_bf16 v[68:71], v[196:199], a[100:103], v[68:71]
    ds_read_b64_tr_b16 v[210:211], v9 offset:4736
    v_mfma_f32_16x16x32_bf16 v[72:75], v[196:199], a[104:107], v[72:75]
    buffer_load_dwordx4 v30, s[28:31], s51 offen offset:0 lds
    v_mfma_f32_16x16x32_bf16 v[76:79], v[196:199], a[108:111], v[76:79]
    s_add_u32 m0, s60, 129024
    s_waitcnt lgkmcnt(4)
    v_mfma_f32_16x16x32_bf16 v[128:131], v[200:203], a[96:99], v[128:131]
    ds_read_b64_tr_b16 v[212:213], v9 offset:160
    v_mfma_f32_16x16x32_bf16 v[132:135], v[200:203], a[100:103], v[132:135]
    ds_read_b64_tr_b16 v[214:215], v9 offset:4768
    v_mfma_f32_16x16x32_bf16 v[136:139], v[200:203], a[104:107], v[136:139]
    v_mfma_f32_16x16x32_bf16 v[140:143], v[200:203], a[108:111], v[140:143]
    s_waitcnt lgkmcnt(4)
    v_mfma_f32_16x16x32_bf16 v[80:83], v[204:207], a[96:99], v[80:83]
    ds_read_b64_tr_b16 v[192:193], v9 offset:192
    v_mfma_f32_16x16x32_bf16 v[84:87], v[204:207], a[100:103], v[84:87]
    ds_read_b64_tr_b16 v[194:195], v9 offset:4800
    v_mfma_f32_16x16x32_bf16 v[88:91], v[204:207], a[104:107], v[88:91]
    v_mfma_f32_16x16x32_bf16 v[92:95], v[204:207], a[108:111], v[92:95]
    s_waitcnt lgkmcnt(4)
    v_mfma_f32_16x16x32_bf16 v[144:147], v[208:211], a[96:99], v[144:147]
    ds_read_b64_tr_b16 v[196:197], v9 offset:224
    v_mfma_f32_16x16x32_bf16 v[148:151], v[208:211], a[100:103], v[148:151]
    ds_read_b64_tr_b16 v[198:199], v9 offset:4832
    v_mfma_f32_16x16x32_bf16 v[152:155], v[208:211], a[104:107], v[152:155]
    buffer_load_dwordx4 v31, s[28:31], s51 offen offset:0 lds
    v_mfma_f32_16x16x32_bf16 v[156:159], v[208:211], a[108:111], v[156:159]
    s_waitcnt lgkmcnt(4)
    v_mfma_f32_16x16x32_bf16 v[96:99], v[212:215], a[96:99], v[96:99]
    ds_read_b64_tr_b16 v[200:201], v9 offset:256
    v_mfma_f32_16x16x32_bf16 v[100:103], v[212:215], a[100:103], v[100:103]
    ds_read_b64_tr_b16 v[202:203], v9 offset:4864
    v_mfma_f32_16x16x32_bf16 v[104:107], v[212:215], a[104:107], v[104:107]
    v_mfma_f32_16x16x32_bf16 v[108:111], v[212:215], a[108:111], v[108:111]
    s_waitcnt lgkmcnt(4)
    v_mfma_f32_16x16x32_bf16 v[160:163], v[192:195], a[96:99], v[160:163]
    ds_read_b64_tr_b16 v[204:205], v9 offset:9216
    v_mfma_f32_16x16x32_bf16 v[164:167], v[192:195], a[100:103], v[164:167]
    ds_read_b64_tr_b16 v[206:207], v9 offset:13824
    v_mfma_f32_16x16x32_bf16 v[168:171], v[192:195], a[104:107], v[168:171]
    v_mfma_f32_16x16x32_bf16 v[172:175], v[192:195], a[108:111], v[172:175]
    s_waitcnt lgkmcnt(4)
    v_mfma_f32_16x16x32_bf16 v[112:115], v[196:199], a[96:99], v[112:115]
    ds_read_b64_tr_b16 v[208:209], v9 offset:9248
    v_mfma_f32_16x16x32_bf16 v[116:119], v[196:199], a[100:103], v[116:119]
    ds_read_b64_tr_b16 v[210:211], v9 offset:13856
    v_mfma_f32_16x16x32_bf16 v[120:123], v[196:199], a[104:107], v[120:123]
    v_mfma_f32_16x16x32_bf16 v[124:127], v[196:199], a[108:111], v[124:127]
    s_waitcnt lgkmcnt(4)
    v_mfma_f32_16x16x32_bf16 v[176:179], v[200:203], a[96:99], v[176:179]
    ds_read_b64_tr_b16 v[212:213], v9 offset:9280
    v_mfma_f32_16x16x32_bf16 v[180:183], v[200:203], a[100:103], v[180:183]
    ds_read_b64_tr_b16 v[214:215], v9 offset:13888
    v_mfma_f32_16x16x32_bf16 v[184:187], v[200:203], a[104:107], v[184:187]
    v_mfma_f32_16x16x32_bf16 v[188:191], v[200:203], a[108:111], v[188:191]
    s_waitcnt vmcnt(30) lgkmcnt(4)
    v_mfma_f32_16x16x32_bf16 v[32:35], v[204:207], a[112:115], v[32:35]
    ds_read_b64_tr_b16 v[192:193], v9 offset:9312
    s_waitcnt vmcnt(29)
    v_mfma_f32_16x16x32_bf16 v[36:39], v[204:207], a[116:119], v[36:39]
    ds_read_b64_tr_b16 v[194:195], v9 offset:13920
    s_waitcnt vmcnt(28)
    v_mfma_f32_16x16x32_bf16 v[40:43], v[204:207], a[120:123], v[40:43]
    s_waitcnt vmcnt(27)
    v_mfma_f32_16x16x32_bf16 v[44:47], v[204:207], a[124:127], v[44:47]
    s_waitcnt lgkmcnt(4)
    v_mfma_f32_16x16x32_bf16 v[64:67], v[208:211], a[112:115], v[64:67]
    ds_read_b64_tr_b16 v[196:197], v9 offset:9344
    v_mfma_f32_16x16x32_bf16 v[68:71], v[208:211], a[116:119], v[68:71]
    ds_read_b64_tr_b16 v[198:199], v9 offset:13952
    v_mfma_f32_16x16x32_bf16 v[72:75], v[208:211], a[120:123], v[72:75]
    v_mfma_f32_16x16x32_bf16 v[76:79], v[208:211], a[124:127], v[76:79]
    s_waitcnt lgkmcnt(4)
    v_mfma_f32_16x16x32_bf16 v[128:131], v[212:215], a[112:115], v[128:131]
    ds_read_b64_tr_b16 v[200:201], v9 offset:9376
    v_mfma_f32_16x16x32_bf16 v[132:135], v[212:215], a[116:119], v[132:135]
    ds_read_b64_tr_b16 v[202:203], v9 offset:13984
    v_mfma_f32_16x16x32_bf16 v[136:139], v[212:215], a[120:123], v[136:139]
    v_mfma_f32_16x16x32_bf16 v[140:143], v[212:215], a[124:127], v[140:143]
    s_waitcnt lgkmcnt(4)
    v_mfma_f32_16x16x32_bf16 v[80:83], v[192:195], a[112:115], v[80:83]
    ds_read_b64_tr_b16 v[204:205], v9 offset:9408
    v_mfma_f32_16x16x32_bf16 v[84:87], v[192:195], a[116:119], v[84:87]
    ds_read_b64_tr_b16 v[206:207], v9 offset:14016
    v_mfma_f32_16x16x32_bf16 v[88:91], v[192:195], a[120:123], v[88:91]
    v_mfma_f32_16x16x32_bf16 v[92:95], v[192:195], a[124:127], v[92:95]
    s_waitcnt lgkmcnt(4)
    v_mfma_f32_16x16x32_bf16 v[144:147], v[196:199], a[112:115], v[144:147]
    ds_read_b64_tr_b16 v[208:209], v9 offset:9440
    v_mfma_f32_16x16x32_bf16 v[148:151], v[196:199], a[116:119], v[148:151]
    ds_read_b64_tr_b16 v[210:211], v9 offset:14048
    v_mfma_f32_16x16x32_bf16 v[152:155], v[196:199], a[120:123], v[152:155]
    v_mfma_f32_16x16x32_bf16 v[156:159], v[196:199], a[124:127], v[156:159]
    s_waitcnt lgkmcnt(4)
    v_mfma_f32_16x16x32_bf16 v[96:99], v[200:203], a[112:115], v[96:99]
    ds_read_b64_tr_b16 v[212:213], v9 offset:9472
    s_add_u32 s66, s68, 65536
    buffer_load_dword v19, v17, s[32:35], s66 offen sc1
    v_mfma_f32_16x16x32_bf16 v[100:103], v[200:203], a[116:119], v[100:103]
    ds_read_b64_tr_b16 v[214:215], v9 offset:14080
    v_mfma_f32_16x16x32_bf16 v[104:107], v[200:203], a[120:123], v[104:107]
    v_mfma_f32_16x16x32_bf16 v[108:111], v[200:203], a[124:127], v[108:111]
    s_waitcnt lgkmcnt(4)
    v_mfma_f32_16x16x32_bf16 v[160:163], v[204:207], a[112:115], v[160:163]
    s_barrier
    v_add_u32 v9, 0, v14
    ds_read_b64_tr_b16 v[192:193], v9 offset:0
    v_mfma_f32_16x16x32_bf16 v[164:167], v[204:207], a[116:119], v[164:167]
    ds_read_b64_tr_b16 v[194:195], v9 offset:4608
    v_mfma_f32_16x16x32_bf16 v[168:171], v[204:207], a[120:123], v[168:171]
    v_mfma_f32_16x16x32_bf16 v[172:175], v[204:207], a[124:127], v[172:175]
    s_waitcnt lgkmcnt(4)
    v_mfma_f32_16x16x32_bf16 v[112:115], v[208:211], a[112:115], v[112:115]
    ds_read_b64_tr_b16 v[196:197], v9 offset:32
    v_mfma_f32_16x16x32_bf16 v[116:119], v[208:211], a[116:119], v[116:119]
    ds_read_b64_tr_b16 v[198:199], v9 offset:4640
    v_mfma_f32_16x16x32_bf16 v[120:123], v[208:211], a[120:123], v[120:123]
    v_mfma_f32_16x16x32_bf16 v[124:127], v[208:211], a[124:127], v[124:127]
    s_waitcnt lgkmcnt(4)
    v_mfma_f32_16x16x32_bf16 v[176:179], v[212:215], a[112:115], v[176:179]
    ds_read_b64_tr_b16 v[200:201], v9 offset:64
    v_mfma_f32_16x16x32_bf16 v[180:183], v[212:215], a[116:119], v[180:183]
    ds_read_b64_tr_b16 v[202:203], v9 offset:4672
    v_mfma_f32_16x16x32_bf16 v[184:187], v[212:215], a[120:123], v[184:187]
    v_mfma_f32_16x16x32_bf16 v[188:191], v[212:215], a[124:127], v[188:191]
    s_waitcnt vmcnt(26) lgkmcnt(4)
    v_mfma_f32_16x16x32_bf16 v[32:35], v[192:195], a[128:131], v[32:35]
    ds_read_b64_tr_b16 v[204:205], v9 offset:96
    s_waitcnt vmcnt(24)
    v_mfma_f32_16x16x32_bf16 v[36:39], v[192:195], a[132:135], v[36:39]
    ds_read_b64_tr_b16 v[206:207], v9 offset:4704
    s_waitcnt vmcnt(22)
    v_mfma_f32_16x16x32_bf16 v[40:43], v[192:195], a[136:139], v[40:43]
    s_waitcnt vmcnt(18)
    v_mfma_f32_16x16x32_bf16 v[44:47], v[192:195], a[140:143], v[44:47]
    s_waitcnt lgkmcnt(4)
    v_mfma_f32_16x16x32_bf16 v[64:67], v[196:199], a[128:131], v[64:67]
    ds_read_b64_tr_b16 v[208:209], v9 offset:128
    v_mfma_f32_16x16x32_bf16 v[68:71], v[196:199], a[132:135], v[68:71]
    ds_read_b64_tr_b16 v[210:211], v9 offset:4736
    v_mfma_f32_16x16x32_bf16 v[72:75], v[196:199], a[136:139], v[72:75]
    v_mfma_f32_16x16x32_bf16 v[76:79], v[196:199], a[140:143], v[76:79]
    s_waitcnt lgkmcnt(4)
    v_mfma_f32_16x16x32_bf16 v[128:131], v[200:203], a[128:131], v[128:131]
    ds_read_b64_tr_b16 v[212:213], v9 offset:160
    v_mfma_f32_16x16x32_bf16 v[132:135], v[200:203], a[132:135], v[132:135]
    ds_read_b64_tr_b16 v[214:215], v9 offset:4768
    v_mfma_f32_16x16x32_bf16 v[136:139], v[200:203], a[136:139], v[136:139]
    v_mfma_f32_16x16x32_bf16 v[140:143], v[200:203], a[140:143], v[140:143]
    s_waitcnt lgkmcnt(4)
    v_mfma_f32_16x16x32_bf16 v[80:83], v[204:207], a[128:131], v[80:83]
    ds_read_b64_tr_b16 v[192:193], v9 offset:192
    v_mfma_f32_16x16x32_bf16 v[84:87], v[204:207], a[132:135], v[84:87]
    ds_read_b64_tr_b16 v[194:195], v9 offset:4800
    v_mfma_f32_16x16x32_bf16 v[88:91], v[204:207], a[136:139], v[88:91]
    v_mfma_f32_16x16x32_bf16 v[92:95], v[204:207], a[140:143], v[92:95]
    s_waitcnt lgkmcnt(4)
    v_mfma_f32_16x16x32_bf16 v[144:147], v[208:211], a[128:131], v[144:147]
    ds_read_b64_tr_b16 v[196:197], v9 offset:224
    v_mfma_f32_16x16x32_bf16 v[148:151], v[208:211], a[132:135], v[148:151]
    ds_read_b64_tr_b16 v[198:199], v9 offset:4832
    v_mfma_f32_16x16x32_bf16 v[152:155], v[208:211], a[136:139], v[152:155]
    v_mfma_f32_16x16x32_bf16 v[156:159], v[208:211], a[140:143], v[156:159]
    s_waitcnt lgkmcnt(4)
    v_mfma_f32_16x16x32_bf16 v[96:99], v[212:215], a[128:131], v[96:99]
    ds_read_b64_tr_b16 v[200:201], v9 offset:256
    v_mfma_f32_16x16x32_bf16 v[100:103], v[212:215], a[132:135], v[100:103]
    ds_read_b64_tr_b16 v[202:203], v9 offset:4864
    v_mfma_f32_16x16x32_bf16 v[104:107], v[212:215], a[136:139], v[104:107]
    v_mfma_f32_16x16x32_bf16 v[108:111], v[212:215], a[140:143], v[108:111]
    s_waitcnt lgkmcnt(4)
    v_mfma_f32_16x16x32_bf16 v[160:163], v[192:195], a[128:131], v[160:163]
    ds_read_b64_tr_b16 v[204:205], v9 offset:9216
    v_mfma_f32_16x16x32_bf16 v[164:167], v[192:195], a[132:135], v[164:167]
    ds_read_b64_tr_b16 v[206:207], v9 offset:13824
    v_mfma_f32_16x16x32_bf16 v[168:171], v[192:195], a[136:139], v[168:171]
    v_mfma_f32_16x16x32_bf16 v[172:175], v[192:195], a[140:143], v[172:175]
    s_waitcnt lgkmcnt(4)
    v_mfma_f32_16x16x32_bf16 v[112:115], v[196:199], a[128:131], v[112:115]
    ds_read_b64_tr_b16 v[208:209], v9 offset:9248
    v_mfma_f32_16x16x32_bf16 v[116:119], v[196:199], a[132:135], v[116:119]
    ds_read_b64_tr_b16 v[210:211], v9 offset:13856
    v_mfma_f32_16x16x32_bf16 v[120:123], v[196:199], a[136:139], v[120:123]
    v_mfma_f32_16x16x32_bf16 v[124:127], v[196:199], a[140:143], v[124:127]
    s_waitcnt lgkmcnt(4)
    v_mfma_f32_16x16x32_bf16 v[176:179], v[200:203], a[128:131], v[176:179]
    ds_read_b64_tr_b16 v[212:213], v9 offset:9280
    v_mfma_f32_16x16x32_bf16 v[180:183], v[200:203], a[132:135], v[180:183]
    ds_read_b64_tr_b16 v[214:215], v9 offset:13888
    v_mfma_f32_16x16x32_bf16 v[184:187], v[200:203], a[136:139], v[184:187]
    s_waitcnt vmcnt(0)
    v_cmp_ne_u32 vcc, v19, v0
    s_nop 4
    s_cbranch_vccz L_ok2
    s_mov_b32 s67, 1000000
L_sp2:
    s_add_u32 s66, s68, 65536
    buffer_load_dword v19, v17, s[32:35], s66 offen sc1
    s_waitcnt vmcnt(0)
    v_cmp_ne_u32 vcc, v19, v0
    s_sub_u32 s67, s67, 1
    s_nop 4
    s_cbranch_vccz L_ok2
    s_cmp_lg_u32 s67, 0
    s_cbranch_scc1 L_sp2
L_ok2:
    v_mfma_f32_16x16x32_bf16 v[188:191], v[200:203], a[140:143], v[188:191]
    s_add_u32 s66, s61, s5
    s_add_u32 s66, s66, 0
    buffer_load_dwordx4 a[192:195], v15, s[32:35], s66 offen sc1
    s_waitcnt lgkmcnt(4)
    v_mfma_f32_16x16x32_bf16 v[32:35], v[204:207], a[144:147], v[32:35]
    ds_read_b64_tr_b16 v[192:193], v9 offset:9312
    v_mfma_f32_16x16x32_bf16 v[36:39], v[204:207], a[148:151], v[36:39]
    ds_read_b64_tr_b16 v[194:195], v9 offset:13920
    v_mfma_f32_16x16x32_bf16 v[40:43], v[204:207], a[152:155], v[40:43]
    s_add_u32 s66, s61, s5
    s_add_u32 s66, s66, 1024
    buffer_load_dwordx4 a[196:199], v15, s[32:35], s66 offen sc1
    v_mfma_f32_16x16x32_bf16 v[44:47], v[204:207], a[156:159], v[44:47]
    s_waitcnt lgkmcnt(4)
    v_mfma_f32_16x16x32_bf16 v[64:67], v[208:211], a[144:147], v[64:67]
    ds_read_b64_tr_b16 v[196:197], v9 offset:9344
    v_mfma_f32_16x16x32_bf16 v[68:71], v[208:211], a[148:151], v[68:71]
    ds_read_b64_tr_b16 v[198:199], v9 offset:13952
    s_add_u32 s66, s61, s5
    s_add_u32 s66, s66, 2048
    buffer_load_dwordx4 a[200:203], v15, s[32:35], s66 offen sc1
    v_mfma_f32_16x16x32_bf16 v[72:75], v[208:211], a[152:155], v[72:75]
    v_mfma_f32_16x16x32_bf16 v[76:79], v[208:211], a[156:159], v[76:79]
    s_waitcnt lgkmcnt(4)
    v_mfma_f32_16x16x32_bf16 v[128:131], v[212:215], a[144:147], v[128:131]
    ds_read_b64_tr_b16 v[200:201], v9 offset:9376
    s_add_u32 s66, s61, s5
    s_add_u32 s66, s66, 3072
    buffer_load_dwordx4 a[204:207], v15, s[32:35], s66 offen sc1
    v_mfma_f32_16x16x32_bf16 v[132:135], v[212:215], a[148:151], v[132:135]
    ds_read_b64_tr_b16 v[202:203], v9 offset:13984
    v_mfma_f32_16x16x32_bf16 v[136:139], v[212:215], a[152:155], v[136:139]
    v_mfma_f32_16x16x32_bf16 v[140:143], v[212:215], a[156:159], v[140:143]
    s_add_u32 s66, s61, s5
    s_add_u32 s66, s66, 4096
    buffer_load_dwordx4 a[208:211], v15, s[32:35], s66 offen sc1
    s_waitcnt lgkmcnt(4)
    v_mfma_f32_16x16x32_bf16 v[80:83], v[192:195], a[144:147], v[80:83]
    ds_read_b64_tr_b16 v[204:205], v9 offset:9408
    v_mfma_f32_16x16x32_bf16 v[84:87], v[192:195], a[148:151], v[84:87]
    ds_read_b64_tr_b16 v[206:207], v9 offset:14016
    v_mfma_f32_16x16x32_bf16 v[88:91], v[192:195], a[152:155], v[88:91]
    s_add_u32 s66, s61, s5
    s_add_u32 s66, s66, 5120
    buffer_load_dwordx4 a[212:215], v15, s[32:35], s66 offen sc1
    v_mfma_f32_16x16x32_bf16 v[92:95], v[192:195], a[156:159], v[92:95]
    s_waitcnt lgkmcnt(4)
    v_mfma_f32_16x16x32_bf16 v[144:147], v[196:199], a[144:147], v[144:147]
    ds_read_b64_tr_b16 v[208:209], v9 offset:9440
    v_mfma_f32_16x16x32_bf16 v[148:151], v[196:199], a[148:151], v[148:151]
    ds_read_b64_tr_b16 v[210:211], v9 offset:14048
    s_add_u32 s66, s61, s5
    s_add_u32 s66, s66, 6144
    buffer_load_dwordx4 a[216:219], v15, s[32:35], s66 offen sc1
    v_mfma_f32_16x16x32_bf16 v[152:155], v[196:199], a[152:155], v[152:155]
    v_mfma_f32_16x16x32_bf16 v[156:159], v[196:199], a[156:159], v[156:159]
    s_waitcnt lgkmcnt(4)
    v_mfma_f32_16x16x32_bf16 v[96:99], v[200:203], a[144:147], v[96:99]
    ds_read_b64_tr_b16 v[212:213], v9 offset:9472
    s_add_u32 s66, s61, s5
    s_add_u32 s66, s66, 7168
    buffer_load_dwordx4 a[220:223], v15, s[32:35], s66 offen sc1
    v_mfma_f32_16x16x32_bf16 v[100:103], v[200:203], a[148:151], v[100:103]
    ds_read_b64_tr_b16 v[214:215], v9 offset:14080
    v_mfma_f32_16x16x32_bf16 v[104:107], v[200:203], a[152:155], v[104:107]
    v_mfma_f32_16x16x32_bf16 v[108:111], v[200:203], a[156:159], v[108:111]
    s_add_u32 s66, s61, s6
    s_add_u32 s66, s66, 0
    buffer_load_dwordx4 a[224:227], v15, s[32:35], s66 offen sc1
    s_waitcnt lgkmcnt(4)
    v_mfma_f32_16x16x32_bf16 v[160:163], v[204:207], a[144:147], v[160:163]
    v_add_u32 v9, 73728, v14
    ds_read_b64_tr_b16 v[192:193], v9 offset:0
    v_mfma_f32_16x16x32_bf16 v[164:167], v[204:207], a[148:151], v[164:167]
    ds_read_b64_tr_b16 v[194:195], v9 offset:4608
    v_mfma_f32_16x16x32_bf16 v[168:171], v[204:207], a[152:155], v[168:171]
    s_add_u32 s66, s61, s6
    s_add_u32 s66, s66, 1024
    buffer_load_dwordx4 a[228:231], v15, s[32:35], s66 offen sc1
    v_mfma_f32_16x16x32_bf16 v[172:175], v[204:207], a[156:159], v[172:175]
    s_waitcnt lgkmcnt(4)
    v_mfma_f32_16x16x32_bf16 v[112:115], v[208:211], a[144:147], v[112:115]
    ds_read_b64_tr_b16 v[196:197], v9 offset:32
    v_mfma_f32_16x16x32_bf16 v[116:119], v[208:211], a[148:151], v[116:119]
    ds_read_b64_tr_b16 v[198:199], v9 offset:4640
    s_add_u32 s66, s61, s6
    s_add_u32 s66, s66, 2048
    buffer_load_dwordx4 a[232:235], v15, s[32:35], s66 offen sc1
    v_mfma_f32_16x16x32_bf16 v[120:123], v[208:211], a[152:155], v[120:123]
    v_mfma_f32_16x16x32_bf16 v[124:127], v[208:211], a[156:159], v[124:127]
    s_waitcnt lgkmcnt(4)
    v_mfma_f32_16x16x32_bf16 v[176:179], v[212:215], a[144:147], v[176:179]
    ds_read_b64_tr_b16 v[200:201], v9 offset:64
    s_add_u32 s66, s61, s6
    s_add_u32 s66, s66, 3072
    buffer_load_dwordx4 a[236:239], v15, s[32:35], s66 offen sc1
    v_mfma_f32_16x16x32_bf16 v[180:183], v[212:215], a[148:151], v[180:183]
    ds_read_b64_tr_b16 v[202:203], v9 offset:4672
    v_mfma_f32_16x16x32_bf16 v[184:187], v[212:215], a[152:155], v[184:187]
    v_mfma_f32_16x16x32_bf16 v[188:191], v[212:215], a[156:159], v[188:191]
    s_add_u32 s66, s61, s6
    s_add_u32 s66, s66, 4096
    buffer_load_dwordx4 a[240:243], v15, s[32:35], s66 offen sc1
    s_waitcnt lgkmcnt(4)
    v_mfma_f32_16x16x32_bf16 v[32:35], v[192:195], v[224:227], v[32:35]
    ds_read_b64_tr_b16 v[204:205], v9 offset:96
    v_mfma_f32_16x16x32_bf16 v[36:39], v[192:195], v[228:231], v[36:39]
    ds_read_b64_tr_b16 v[206:207], v9 offset:4704
    v_mfma_f32_16x16x32_bf16 v[40:43], v[192:195], v[232:235], v[40:43]
    s_add_u32 s66, s61, s6
    s_add_u32 s66, s66, 5120
    buffer_load_dwordx4 a[244:247], v15, s[32:35], s66 offen sc1
    v_mfma_f32_16x16x32_bf16 v[44:47], v[192:195], v[236:239], v[44:47]
    s_waitcnt lgkmcnt(4)
    v_mfma_f32_16x16x32_bf16 v[64:67], v[196:199], v[224:227], v[64:67]
    ds_read_b64_tr_b16 v[208:209], v9 offset:128
    v_mfma_f32_16x16x32_bf16 v[68:71], v[196:199], v[228:231], v[68:71]
    ds_read_b64_tr_b16 v[210:211], v9 offset:4736
    s_add_u32 s66, s61, s6
    s_add_u32 s66, s66, 6144
    buffer_load_dwordx4 a[248:251], v15, s[32:35], s66 offen sc1
    v_mfma_f32_16x16x32_bf16 v[72:75], v[196:199], v[232:235], v[72:75]
    v_mfma_f32_16x16x32_bf16 v[76:79], v[196:199], v[236:239], v[76:79]
    s_waitcnt lgkmcnt(4)
    v_mfma_f32_16x16x32_bf16 v[128:131], v[200:203], v[224:227], v[128:131]
    ds_read_b64_tr_b16 v[212:213], v9 offset:160
    s_add_u32 s66, s61, s6
    s_add_u32 s66, s66, 7168
    buffer_load_dwordx4 a[252:255], v15, s[32:35], s66 offen sc1
    v_mfma_f32_16x16x32_bf16 v[132:135], v[200:203], v[228:231], v[132:135]
    ds_read_b64_tr_b16 v[214:215], v9 offset:4768
    v_mfma_f32_16x16x32_bf16 v[136:139], v[200:203], v[232:235], v[136:139]
    v_mfma_f32_16x16x32_bf16 v[140:143], v[200:203], v[236:239], v[140:143]
    s_add_u32 s66, s61, s7
    s_add_u32 s66, s66, 0
    buffer_load_dwordx4 v[48:51], v15, s[32:35], s66 offen sc1
    s_waitcnt lgkmcnt(4)
    v_mfma_f32_16x16x32_bf16 v[80:83], v[204:207], v[224:227], v[80:83]
    ds_read_b64_tr_b16 v[192:193], v9 offset:192
    s_lshl_b32 s83, s45, 2
    v_mfma_f32_16x16x32_bf16 v[84:87], v[204:207], v[228:231], v[84:87]
    ds_read_b64_tr_b16 v[194:195], v9 offset:4800
    s_add_u32 s83, s83, s47
    v_mfma_f32_16x16x32_bf16 v[88:91], v[204:207], v[232:235], v[88:91]
    s_add_u32 s66, s61, s7
    s_add_u32 s66, s66, 1024
    buffer_load_dwordx4 v[52:55], v15, s[32:35], s66 offen sc1
    s_lshl_b32 s81, s83, 12
    v_mfma_f32_16x16x32_bf16 v[92:95], v[204:207], v[236:239], v[92:95]
    s_add_u32 s81, s81, 38010880
    s_waitcnt lgkmcnt(4)
    v_mfma_f32_16x16x32_bf16 v[144:147], v[208:211], v[224:227], v[144:147]
    ds_read_b64_tr_b16 v[196:197], v9 offset:224
    s_lshr_b32 s70, s46, 1
    v_mfma_f32_16x16x32_bf16 v[148:151], v[208:211], v[228:231], v[148:151]
    ds_read_b64_tr_b16 v[198:199], v9 offset:4832
    s_add_u32 s66, s61, s7
    s_add_u32 s66, s66, 2048
    buffer_load_dwordx4 v[56:59], v15, s[32:35], s66 offen sc1
    v_mfma_f32_16x16x32_bf16 v[152:155], v[208:211], v[232:235], v[152:155]
    s_lshl_b32 s70, s70, 7
    s_add_u32 s69, s81, s70
    v_mfma_f32_16x16x32_bf16 v[156:159], v[208:211], v[236:239], v[156:159]
    s_lshl_b32 s82, s83, 3
    s_waitcnt lgkmcnt(4)
    v_mfma_f32_16x16x32_bf16 v[96:99], v[212:215], v[224:227], v[96:99]
    ds_read_b64_tr_b16 v[200:201], v9 offset:256
    s_add_u32 s66, s61, s7
    s_add_u32 s66, s66, 3072
    buffer_load_dwordx4 v[60:63], v15, s[32:35], s66 offen sc1
    v_mfma_f32_16x16x32_bf16 v[100:103], v[212:215], v[228:231], v[100:103]
    ds_read_b64_tr_b16 v[202:203], v9 offset:4864
    s_add_u32 s82, s82, s46
    v_mfma_f32_16x16x32_bf16 v[104:107], v[212:215], v[232:235], v[104:107]
    s_mul_i32 s82, s82, 73728
    s_add_u32 s82, s82, 18874368
    v_mfma_f32_16x16x32_bf16 v[108:111], v[212:215], v[236:239], v[108:111]
    s_add_u32 s66, s61, s7
    s_add_u32 s66, s66, 4096
    buffer_load_dwordx4 a[0:3], v15, s[32:35], s66 offen sc1
    s_waitcnt lgkmcnt(4)
    v_mfma_f32_16x16x32_bf16 v[160:163], v[192:195], v[224:227], v[160:163]
    ds_read_b64_tr_b16 v[204:205], v9 offset:9216
    s_lshl_b32 s70, s44, 10
    v_mfma_f32_16x16x32_bf16 v[164:167], v[192:195], v[228:231], v[164:167]
    ds_read_b64_tr_b16 v[206:207], v9 offset:13824
    s_add_u32 s82, s82, s70
    v_mfma_f32_16x16x32_bf16 v[168:171], v[192:195], v[232:235], v[168:171]
    s_add_u32 s66, s61, s7
    s_add_u32 s66, s66, 5120
    buffer_load_dwordx4 a[4:7], v15, s[32:35], s66 offen sc1
    v_bfe_u32 v17, v15, 4, 3
    v_mfma_f32_16x16x32_bf16 v[172:175], v[192:195], v[236:239], v[172:175]
    v_lshlrev_b32 v17, 9, v17
    s_waitcnt lgkmcnt(4)
    v_mfma_f32_16x16x32_bf16 v[112:115], v[196:199], v[224:227], v[112:115]
    ds_read_b64_tr_b16 v[208:209], v9 offset:9248
    s_add_u32 s72, s46, 1
    v_mfma_f32_16x16x32_bf16 v[116:119], v[196:199], v[228:231], v[116:119]
    ds_read_b64_tr_b16 v[210:211], v9 offset:13856
    s_add_u32 s66, s61, s7
    s_add_u32 s66, s66, 6144
    buffer_load_dwordx4 a[8:11], v15, s[32:35], s66 offen sc1
    v_mfma_f32_16x16x32_bf16 v[120:123], v[196:199], v[232:235], v[120:123]
    s_and_b32 s72, s72, 7
    s_mul_i32 s72, s72, 9216
    v_mfma_f32_16x16x32_bf16 v[124:127], v[196:199], v[236:239], v[124:127]
    s_add_u32 s72, s72, s82
    s_waitcnt lgkmcnt(4)
    v_mfma_f32_16x16x32_bf16 v[176:179], v[200:203], v[224:227], v[176:179]
    ds_read_b64_tr_b16 v[212:213], v9 offset:9280
    s_add_u32 s66, s61, s7
    s_add_u32 s66, s66, 7168
    buffer_load_dwordx4 a[12:15], v15, s[32:35], s66 offen sc1
    v_mfma_f32_16x16x32_bf16 v[180:183], v[200:203], v[228:231], v[180:183]
    ds_read_b64_tr_b16 v[214:215], v9 offset:13888
    s_add_u32 s73, s46, 2
    v_mfma_f32_16x16x32_bf16 v[184:187], v[200:203], v[232:235], v[184:187]
    s_and_b32 s73, s73, 7
    s_mul_i32 s73, s73, 9216
    v_mfma_f32_16x16x32_bf16 v[188:191], v[200:203], v[236:239], v[188:191]
    s_add_u32 s73, s73, s82
    s_waitcnt lgkmcnt(4)
    v_mfma_f32_16x16x32_bf16 v[32:35], v[204:207], v[240:243], v[32:35]
    ds_read_b64_tr_b16 v[192:193], v9 offset:9312
    s_add_u32 s74, s46, 3
    v_mfma_f32_16x16x32_bf16 v[36:39], v[204:207], v[244:247], v[36:39]
    ds_read_b64_tr_b16 v[194:195], v9 offset:13920
    s_and_b32 s74, s74, 7
    v_mfma_f32_16x16x32_bf16 v[40:43], v[204:207], v[248:251], v[40:43]
    s_mul_i32 s74, s74, 9216
    s_add_u32 s74, s74, s82
    v_mfma_f32_16x16x32_bf16 v[44:47], v[204:207], v[252:255], v[44:47]
    s_add_u32 s75, s46, 4
    s_waitcnt lgkmcnt(4)
    v_mfma_f32_16x16x32_bf16 v[64:67], v[208:211], v[240:243], v[64:67]
    ds_read_b64_tr_b16 v[196:197], v9 offset:9344
    s_and_b32 s75, s75, 7
    v_mfma_f32_16x16x32_bf16 v[68:71], v[208:211], v[244:247], v[68:71]
    ds_read_b64_tr_b16 v[198:199], v9 offset:13952
    s_mul_i32 s75, s75, 9216
    v_mfma_f32_16x16x32_bf16 v[72:75], v[208:211], v[248:251], v[72:75]
    s_add_u32 s75, s75, s82
    s_add_u32 s76, s46, 5
    v_mfma_f32_16x16x32_bf16 v[76:79], v[208:211], v[252:255], v[76:79]
    s_and_b32 s76, s76, 7
    s_waitcnt lgkmcnt(4)
    v_mfma_f32_16x16x32_bf16 v[128:131], v[212:215], v[240:243], v[128:131]
    ds_read_b64_tr_b16 v[200:201], v9 offset:9376
    s_mul_i32 s76, s76, 9216
    v_mfma_f32_16x16x32_bf16 v[132:135], v[212:215], v[244:247], v[132:135]
    ds_read_b64_tr_b16 v[202:203], v9 offset:13984
    s_add_u32 s76, s76, s82
    v_mfma_f32_16x16x32_bf16 v[136:139], v[212:215], v[248:251], v[136:139]
    s_add_u32 s77, s46, 6
    s_and_b32 s77, s77, 7
    v_mfma_f32_16x16x32_bf16 v[140:143], v[212:215], v[252:255], v[140:143]
    s_mul_i32 s77, s77, 9216
    s_waitcnt lgkmcnt(4)
    v_mfma_f32_16x16x32_bf16 v[80:83], v[192:195], v[240:243], v[80:83]
    ds_read_b64_tr_b16 v[204:205], v9 offset:9408
    s_add_u32 s77, s77, s82
    v_mfma_f32_16x16x32_bf16 v[84:87], v[192:195], v[244:247], v[84:87]
    ds_read_b64_tr_b16 v[206:207], v9 offset:14016
    s_add_u32 s78, s46, 7
    v_mfma_f32_16x16x32_bf16 v[88:91], v[192:195], v[248:251], v[88:91]
    s_and_b32 s78, s78, 7
    s_mul_i32 s78, s78, 9216
    v_mfma_f32_16x16x32_bf16 v[92:95], v[192:195], v[252:255], v[92:95]
    s_add_u32 s78, s78, s82
    s_waitcnt lgkmcnt(4)
    v_mfma_f32_16x16x32_bf16 v[144:147], v[196:199], v[240:243], v[144:147]
    ds_read_b64_tr_b16 v[208:209], v9 offset:9440
    s_add_u32 s79, s46, 8
    v_mfma_f32_16x16x32_bf16 v[148:151], v[196:199], v[244:247], v[148:151]
    ds_read_b64_tr_b16 v[210:211], v9 offset:14048
    s_and_b32 s79, s79, 7
    v_mfma_f32_16x16x32_bf16 v[152:155], v[196:199], v[248:251], v[152:155]
    s_mul_i32 s79, s79, 9216
    s_add_u32 s79, s79, s82
    v_mfma_f32_16x16x32_bf16 v[156:159], v[196:199], v[252:255], v[156:159]
    v_bfe_u32 v21, v15, 4, 3
    s_waitcnt lgkmcnt(4)
    v_mfma_f32_16x16x32_bf16 v[96:99], v[200:203], v[240:243], v[96:99]
    ds_read_b64_tr_b16 v[212:213], v9 offset:9472
    v_cmp_eq_u32 s[96:97], s46, v21
    v_mfma_f32_16x16x32_bf16 v[100:103], v[200:203], v[244:247], v[100:103]
    ds_read_b64_tr_b16 v[214:215], v9 offset:14080
    s_mov_b32 s80, 0
    v_mfma_f32_16x16x32_bf16 v[104:107], v[200:203], v[248:251], v[104:107]
    s_lshl_b32 s70, s44, 1
    s_add_u32 s70, s70, 0
    v_mfma_f32_16x16x32_bf16 v[108:111], v[200:203], v[252:255], v[108:111]
    s_add_u32 s86, s64, 0
    s_waitcnt lgkmcnt(4)
    v_mfma_f32_16x16x32_bf16 v[160:163], v[204:207], v[240:243], v[160:163]
    s_barrier
    v_add_u32 v9, 92160, v14
    v_add_u32 v10, 110592, v14
    v_add_u32 v11, 129024, v14
    ds_read_b64_tr_b16 v[192:193], v9 offset:256
    s_cmp_eq_u32 s70, s46
    s_cselect_b32 s86, 0xf0000000, s86
    s_cselect_b32 s71, 147456, 0
    v_mfma_f32_16x16x32_bf16 v[164:167], v[204:207], v[244:247], v[164:167]
    ds_read_b64_tr_b16 v[194:195], v9 offset:4864
    v_add_u32 v24, s71, v15
    v_mfma_f32_16x16x32_bf16 v[168:171], v[204:207], v[248:251], v[168:171]
    s_lshl_b32 s70, s44, 1
    s_add_u32 s70, s70, 1
    v_mfma_f32_16x16x32_bf16 v[172:175], v[204:207], v[252:255], v[172:175]
    s_add_u32 s87, s64, 73728
    s_waitcnt lgkmcnt(4)
    v_mfma_f32_16x16x32_bf16 v[112:115], v[208:211], v[240:243], v[112:115]
    ds_read_b64_tr_b16 v[196:197], v9 offset:9472
    s_cmp_eq_u32 s70, s46
    s_cselect_b32 s87, 0xf0000000, s87
    s_cselect_b32 s71, 147456, 0
    v_mfma_f32_16x16x32_bf16 v[116:119], v[208:211], v[244:247], v[116:119]
    ds_read_b64_tr_b16 v[198:199], v9 offset:14080
    v_add_u32 v25, s71, v15
    v_mfma_f32_16x16x32_bf16 v[120:123], v[208:211], v[248:251], v[120:123]
    v_mfma_f32_16x16x32_bf16 v[124:127], v[208:211], v[252:255], v[124:127]
    s_waitcnt lgkmcnt(4)
    v_mfma_f32_16x16x32_bf16 v[176:179], v[212:215], v[240:243], v[176:179]
    ds_read_b64_tr_b16 v[200:201], v10 offset:256
    v_mfma_f32_16x16x32_bf16 v[180:183], v[212:215], v[244:247], v[180:183]
    ds_read_b64_tr_b16 v[202:203], v10 offset:4864
    v_mfma_f32_16x16x32_bf16 v[184:187], v[212:215], v[248:251], v[184:187]
    v_mfma_f32_16x16x32_bf16 v[188:191], v[212:215], v[252:255], v[188:191]
    s_waitcnt vmcnt(23) lgkmcnt(4)
    v_mfma_f32_16x16x32_bf16 v[176:179], v[192:195], a[192:195], v[176:179]
    ds_read_b64_tr_b16 v[204:205], v10 offset:9472
    s_waitcnt vmcnt(22)
    v_mfma_f32_16x16x32_bf16 v[180:183], v[192:195], a[196:199], v[180:183]
    ds_read_b64_tr_b16 v[206:207], v10 offset:14080
    s_waitcnt vmcnt(21)
    v_mfma_f32_16x16x32_bf16 v[184:187], v[192:195], a[200:203], v[184:187]
    s_waitcnt vmcnt(20)
    v_mfma_f32_16x16x32_bf16 v[188:191], v[192:195], a[204:207], v[188:191]
    s_waitcnt vmcnt(19) lgkmcnt(4)
    v_mfma_f32_16x16x32_bf16 v[176:179], v[196:199], a[208:211], v[176:179]
    ds_read_b64_tr_b16 v[208:209], v11 offset:256
    s_waitcnt vmcnt(18)
    v_mfma_f32_16x16x32_bf16 v[180:183], v[196:199], a[212:215], v[180:183]
    ds_read_b64_tr_b16 v[210:211], v11 offset:4864
    s_waitcnt vmcnt(17)
    v_mfma_f32_16x16x32_bf16 v[184:187], v[196:199], a[216:219], v[184:187]
    s_waitcnt vmcnt(16)
    v_mfma_f32_16x16x32_bf16 v[188:191], v[196:199], a[220:223], v[188:191]
    s_waitcnt vmcnt(15) lgkmcnt(4)
    v_mfma_f32_16x16x32_bf16 v[176:179], v[200:203], a[224:227], v[176:179]
    ds_read_b64_tr_b16 v[212:213], v11 offset:9472
    s_waitcnt vmcnt(14)
    v_mfma_f32_16x16x32_bf16 v[180:183], v[200:203], a[228:231], v[180:183]
    ds_read_b64_tr_b16 v[214:215], v11 offset:14080
    s_waitcnt vmcnt(13)
    v_mfma_f32_16x16x32_bf16 v[184:187], v[200:203], a[232:235], v[184:187]
    s_waitcnt vmcnt(12)
    v_mfma_f32_16x16x32_bf16 v[188:191], v[200:203], a[236:239], v[188:191]
    s_waitcnt vmcnt(11) lgkmcnt(4)
    v_mfma_f32_16x16x32_bf16 v[176:179], v[204:207], a[240:243], v[176:179]
    ds_read_b64_tr_b16 v[192:193], v9 offset:0
    s_waitcnt vmcnt(10)
    v_mfma_f32_16x16x32_bf16 v[180:183], v[204:207], a[244:247], v[180:183]
    ds_read_b64_tr_b16 v[194:195], v9 offset:4608
    s_waitcnt vmcnt(9)
    v_mfma_f32_16x16x32_bf16 v[184:187], v[204:207], a[248:251], v[184:187]
    s_waitcnt vmcnt(8)
    v_mfma_f32_16x16x32_bf16 v[188:191], v[204:207], a[252:255], v[188:191]
    s_waitcnt vmcnt(7) lgkmcnt(4)
    v_mfma_f32_16x16x32_bf16 v[176:179], v[208:211], v[48:51], v[176:179]
    ds_read_b64_tr_b16 v[196:197], v9 offset:9216
    s_waitcnt vmcnt(6)
    v_mfma_f32_16x16x32_bf16 v[180:183], v[208:211], v[52:55], v[180:183]
    ds_read_b64_tr_b16 v[198:199], v9 offset:13824
    s_waitcnt vmcnt(5)
    v_mfma_f32_16x16x32_bf16 v[184:187], v[208:211], v[56:59], v[184:187]
    s_waitcnt vmcnt(4)
    v_mfma_f32_16x16x32_bf16 v[188:191], v[208:211], v[60:63], v[188:191]
    s_waitcnt vmcnt(3) lgkmcnt(4)
    v_mfma_f32_16x16x32_bf16 v[176:179], v[212:215], a[0:3], v[176:179]
    ds_read_b64_tr_b16 v[200:201], v10 offset:0
    s_waitcnt vmcnt(2)
    v_mfma_f32_16x16x32_bf16 v[180:183], v[212:215], a[4:7], v[180:183]
    ds_read_b64_tr_b16 v[202:203], v10 offset:4608
    s_waitcnt vmcnt(1)
    v_mfma_f32_16x16x32_bf16 v[184:187], v[212:215], a[8:11], v[184:187]
    s_waitcnt vmcnt(0)
    v_mfma_f32_16x16x32_bf16 v[188:191], v[212:215], a[12:15], v[188:191]
    s_waitcnt lgkmcnt(4)
    v_mfma_f32_16x16x32_bf16 v[32:35], v[192:195], a[192:195], v[32:35]
    ds_read_b64_tr_b16 v[204:205], v10 offset:9216
    v_mfma_f32_16x16x32_bf16 v[36:39], v[192:195], a[196:199], v[36:39]
    ds_read_b64_tr_b16 v[206:207], v10 offset:13824
    v_mfma_f32_16x16x32_bf16 v[40:43], v[192:195], a[200:203], v[40:43]
    v_cvt_pk_bf16_f32 v224, v176, v177
    v_cvt_pk_bf16_f32 v225, v178, v179
    v_mfma_f32_16x16x32_bf16 v[44:47], v[192:195], a[204:207], v[44:47]
    v_cvt_pk_bf16_f32 v226, v180, v181
    v_cvt_pk_bf16_f32 v227, v182, v183
    s_waitcnt lgkmcnt(4)
    v_mfma_f32_16x16x32_bf16 v[32:35], v[196:199], a[208:211], v[32:35]
    ds_read_b64_tr_b16 v[208:209], v11 offset:0
    s_add_u32 s66, s86, 8192
    buffer_store_dwordx4 v[224:227], v15, s[32:35], s66 offen sc1
    ds_write_b128 v24, v[224:227] offset:8192
    v_mfma_f32_16x16x32_bf16 v[36:39], v[196:199], a[212:215], v[36:39]
    ds_read_b64_tr_b16 v[210:211], v11 offset:4608
    v_cvt_pk_bf16_f32 v228, v184, v185
    v_cvt_pk_bf16_f32 v229, v186, v187
    v_mfma_f32_16x16x32_bf16 v[40:43], v[196:199], a[216:219], v[40:43]
    v_cvt_pk_bf16_f32 v230, v188, v189
    v_cvt_pk_bf16_f32 v231, v190, v191
    v_mfma_f32_16x16x32_bf16 v[44:47], v[196:199], a[220:223], v[44:47]
    s_add_u32 s66, s87, 8192
    buffer_store_dwordx4 v[228:231], v15, s[32:35], s66 offen sc1
    ds_write_b128 v25, v[228:231] offset:8192
    s_waitcnt lgkmcnt(6)
    v_mfma_f32_16x16x32_bf16 v[32:35], v[200:203], a[224:227], v[32:35]
    ds_read_b64_tr_b16 v[212:213], v11 offset:9216
    v_mfma_f32_16x16x32_bf16 v[36:39], v[200:203], a[228:231], v[36:39]
    ds_read_b64_tr_b16 v[214:215], v11 offset:13824
    v_mfma_f32_16x16x32_bf16 v[40:43], v[200:203], a[232:235], v[40:43]
    v_mfma_f32_16x16x32_bf16 v[44:47], v[200:203], a[236:239], v[44:47]
    s_waitcnt lgkmcnt(6)
    v_mfma_f32_16x16x32_bf16 v[32:35], v[204:207], a[240:243], v[32:35]
    ds_read_b64_tr_b16 v[192:193], v9 offset:32
    v_mfma_f32_16x16x32_bf16 v[36:39], v[204:207], a[244:247], v[36:39]
    ds_read_b64_tr_b16 v[194:195], v9 offset:4640
    v_mfma_f32_16x16x32_bf16 v[40:43], v[204:207], a[248:251], v[40:43]
    v_mfma_f32_16x16x32_bf16 v[44:47], v[204:207], a[252:255], v[44:47]
    s_waitcnt lgkmcnt(5)
    v_mfma_f32_16x16x32_bf16 v[32:35], v[208:211], v[48:51], v[32:35]
    ds_read_b64_tr_b16 v[196:197], v9 offset:9248
    v_mfma_f32_16x16x32_bf16 v[36:39], v[208:211], v[52:55], v[36:39]
    ds_read_b64_tr_b16 v[198:199], v9 offset:13856
    v_mfma_f32_16x16x32_bf16 v[40:43], v[208:211], v[56:59], v[40:43]
    v_mfma_f32_16x16x32_bf16 v[44:47], v[208:211], v[60:63], v[44:47]
    s_waitcnt lgkmcnt(4)
    v_mfma_f32_16x16x32_bf16 v[32:35], v[212:215], a[0:3], v[32:35]
    ds_read_b64_tr_b16 v[200:201], v10 offset:32
    v_mfma_f32_16x16x32_bf16 v[36:39], v[212:215], a[4:7], v[36:39]
    ds_read_b64_tr_b16 v[202:203], v10 offset:4640
    v_mfma_f32_16x16x32_bf16 v[40:43], v[212:215], a[8:11], v[40:43]
    v_mfma_f32_16x16x32_bf16 v[44:47], v[212:215], a[12:15], v[44:47]
    s_waitcnt lgkmcnt(4)
    v_mfma_f32_16x16x32_bf16 v[64:67], v[192:195], a[192:195], v[64:67]
    ds_read_b64_tr_b16 v[204:205], v10 offset:9248
    v_mfma_f32_16x16x32_bf16 v[68:71], v[192:195], a[196:199], v[68:71]
    ds_read_b64_tr_b16 v[206:207], v10 offset:13856
    v_mfma_f32_16x16x32_bf16 v[72:75], v[192:195], a[200:203], v[72:75]
    v_cvt_pk_bf16_f32 v224, v32, v33
    v_cvt_pk_bf16_f32 v225, v34, v35
    v_mfma_f32_16x16x32_bf16 v[76:79], v[192:195], a[204:207], v[76:79]
    v_cvt_pk_bf16_f32 v226, v36, v37
    v_cvt_pk_bf16_f32 v227, v38, v39
    s_waitcnt lgkmcnt(4)
    v_mfma_f32_16x16x32_bf16 v[64:67], v[196:199], a[208:211], v[64:67]
    ds_read_b64_tr_b16 v[208:209], v11 offset:32
    s_add_u32 s66, s86, 0
    buffer_store_dwordx4 v[224:227], v15, s[32:35], s66 offen sc1
    ds_write_b128 v24, v[224:227] offset:0
    v_mfma_f32_16x16x32_bf16 v[68:71], v[196:199], a[212:215], v[68:71]
    ds_read_b64_tr_b16 v[210:211], v11 offset:4640
    v_cvt_pk_bf16_f32 v228, v40, v41
    v_cvt_pk_bf16_f32 v229, v42, v43
    v_mfma_f32_16x16x32_bf16 v[72:75], v[196:199], a[216:219], v[72:75]
    v_cvt_pk_bf16_f32 v230, v44, v45
    v_cvt_pk_bf16_f32 v231, v46, v47
    v_mfma_f32_16x16x32_bf16 v[76:79], v[196:199], a[220:223], v[76:79]
    s_add_u32 s66, s87, 0
    buffer_store_dwordx4 v[228:231], v15, s[32:35], s66 offen sc1
    ds_write_b128 v25, v[228:231] offset:0
    s_waitcnt lgkmcnt(6)
    v_mfma_f32_16x16x32_bf16 v[64:67], v[200:203], a[224:227], v[64:67]
    ds_read_b64_tr_b16 v[212:213], v11 offset:9248
    v_mfma_f32_16x16x32_bf16 v[68:71], v[200:203], a[228:231], v[68:71]
    ds_read_b64_tr_b16 v[214:215], v11 offset:13856
    v_mfma_f32_16x16x32_bf16 v[72:75], v[200:203], a[232:235], v[72:75]
    v_mfma_f32_16x16x32_bf16 v[76:79], v[200:203], a[236:239], v[76:79]
    s_waitcnt lgkmcnt(6)
    v_mfma_f32_16x16x32_bf16 v[64:67], v[204:207], a[240:243], v[64:67]
    ds_read_b64_tr_b16 v[192:193], v9 offset:64
    v_mfma_f32_16x16x32_bf16 v[68:71], v[204:207], a[244:247], v[68:71]
    ds_read_b64_tr_b16 v[194:195], v9 offset:4672
    v_mfma_f32_16x16x32_bf16 v[72:75], v[204:207], a[248:251], v[72:75]
    v_mfma_f32_16x16x32_bf16 v[76:79], v[204:207], a[252:255], v[76:79]
    s_waitcnt lgkmcnt(5)
    v_mfma_f32_16x16x32_bf16 v[64:67], v[208:211], v[48:51], v[64:67]
    ds_read_b64_tr_b16 v[196:197], v9 offset:9280
    v_mfma_f32_16x16x32_bf16 v[68:71], v[208:211], v[52:55], v[68:71]
    ds_read_b64_tr_b16 v[198:199], v9 offset:13888
    v_mfma_f32_16x16x32_bf16 v[72:75], v[208:211], v[56:59], v[72:75]
    v_mfma_f32_16x16x32_bf16 v[76:79], v[208:211], v[60:63], v[76:79]
    s_waitcnt lgkmcnt(4)
    v_mfma_f32_16x16x32_bf16 v[64:67], v[212:215], a[0:3], v[64:67]
    ds_read_b64_tr_b16 v[200:201], v10 offset:64
    v_mfma_f32_16x16x32_bf16 v[68:71], v[212:215], a[4:7], v[68:71]
    ds_read_b64_tr_b16 v[202:203], v10 offset:4672
    v_mfma_f32_16x16x32_bf16 v[72:75], v[212:215], a[8:11], v[72:75]
    v_mfma_f32_16x16x32_bf16 v[76:79], v[212:215], a[12:15], v[76:79]
    s_waitcnt lgkmcnt(4)
    v_mfma_f32_16x16x32_bf16 v[128:131], v[192:195], a[192:195], v[128:131]
    ds_read_b64_tr_b16 v[204:205], v10 offset:9280
    v_mfma_f32_16x16x32_bf16 v[132:135], v[192:195], a[196:199], v[132:135]
    ds_read_b64_tr_b16 v[206:207], v10 offset:13888
    v_mfma_f32_16x16x32_bf16 v[136:139], v[192:195], a[200:203], v[136:139]
    v_cvt_pk_bf16_f32 v232, v64, v65
    v_cvt_pk_bf16_f32 v233, v66, v67
    v_mfma_f32_16x16x32_bf16 v[140:143], v[192:195], a[204:207], v[140:143]
    v_cvt_pk_bf16_f32 v234, v68, v69
    v_cvt_pk_bf16_f32 v235, v70, v71
    s_waitcnt lgkmcnt(4)
    v_mfma_f32_16x16x32_bf16 v[128:131], v[196:199], a[208:211], v[128:131]
    ds_read_b64_tr_b16 v[208:209], v11 offset:64
    s_add_u32 s66, s86, 1024
    buffer_store_dwordx4 v[232:235], v15, s[32:35], s66 offen sc1
    ds_write_b128 v24, v[232:235] offset:1024
    v_mfma_f32_16x16x32_bf16 v[132:135], v[196:199], a[212:215], v[132:135]
    ds_read_b64_tr_b16 v[210:211], v11 offset:4672
    v_cvt_pk_bf16_f32 v236, v72, v73
    v_cvt_pk_bf16_f32 v237, v74, v75
    v_mfma_f32_16x16x32_bf16 v[136:139], v[196:199], a[216:219], v[136:139]
    v_cvt_pk_bf16_f32 v238, v76, v77
    v_cvt_pk_bf16_f32 v239, v78, v79
    v_mfma_f32_16x16x32_bf16 v[140:143], v[196:199], a[220:223], v[140:143]
    s_add_u32 s66, s87, 1024
    buffer_store_dwordx4 v[236:239], v15, s[32:35], s66 offen sc1
    ds_write_b128 v25, v[236:239] offset:1024
    s_waitcnt lgkmcnt(6)
    v_mfma_f32_16x16x32_bf16 v[128:131], v[200:203], a[224:227], v[128:131]
    ds_read_b64_tr_b16 v[212:213], v11 offset:9280
    v_mfma_f32_16x16x32_bf16 v[132:135], v[200:203], a[228:231], v[132:135]
    ds_read_b64_tr_b16 v[214:215], v11 offset:13888
    v_mfma_f32_16x16x32_bf16 v[136:139], v[200:203], a[232:235], v[136:139]
    v_mfma_f32_16x16x32_bf16 v[140:143], v[200:203], a[236:239], v[140:143]
    s_waitcnt lgkmcnt(6)
    v_mfma_f32_16x16x32_bf16 v[128:131], v[204:207], a[240:243], v[128:131]
    ds_read_b64_tr_b16 v[192:193], v9 offset:96
    v_mfma_f32_16x16x32_bf16 v[132:135], v[204:207], a[244:247], v[132:135]
    ds_read_b64_tr_b16 v[194:195], v9 offset:4704
    v_mfma_f32_16x16x32_bf16 v[136:139], v[204:207], a[248:251], v[136:139]
    v_mfma_f32_16x16x32_bf16 v[140:143], v[204:207], a[252:255], v[140:143]
    s_waitcnt lgkmcnt(5)
    v_mfma_f32_16x16x32_bf16 v[128:131], v[208:211], v[48:51], v[128:131]
    ds_read_b64_tr_b16 v[196:197], v9 offset:9312
    v_mfma_f32_16x16x32_bf16 v[132:135], v[208:211], v[52:55], v[132:135]
    ds_read_b64_tr_b16 v[198:199], v9 offset:13920
    v_mfma_f32_16x16x32_bf16 v[136:139], v[208:211], v[56:59], v[136:139]
    v_mfma_f32_16x16x32_bf16 v[140:143], v[208:211], v[60:63], v[140:143]
    s_waitcnt lgkmcnt(4)
    v_mfma_f32_16x16x32_bf16 v[128:131], v[212:215], a[0:3], v[128:131]
    ds_read_b64_tr_b16 v[200:201], v10 offset:96
    v_mfma_f32_16x16x32_bf16 v[132:135], v[212:215], a[4:7], v[132:135]
    ds_read_b64_tr_b16 v[202:203], v10 offset:4704
    v_mfma_f32_16x16x32_bf16 v[136:139], v[212:215], a[8:11], v[136:139]
    v_mfma_f32_16x16x32_bf16 v[140:143], v[212:215], a[12:15], v[140:143]
    s_waitcnt lgkmcnt(4)
    v_mfma_f32_16x16x32_bf16 v[80:83], v[192:195], a[192:195], v[80:83]
    ds_read_b64_tr_b16 v[204:205], v10 offset:9312
    v_mfma_f32_16x16x32_bf16 v[84:87], v[192:195], a[196:199], v[84:87]
    ds_read_b64_tr_b16 v[206:207], v10 offset:13920
    v_mfma_f32_16x16x32_bf16 v[88:91], v[192:195], a[200:203], v[88:91]
    v_cvt_pk_bf16_f32 v224, v128, v129
    v_cvt_pk_bf16_f32 v225, v130, v131
    v_mfma_f32_16x16x32_bf16 v[92:95], v[192:195], a[204:207], v[92:95]
    v_cvt_pk_bf16_f32 v226, v132, v133
    v_cvt_pk_bf16_f32 v227, v134, v135
    s_waitcnt lgkmcnt(4)
    v_mfma_f32_16x16x32_bf16 v[80:83], v[196:199], a[208:211], v[80:83]
    ds_read_b64_tr_b16 v[208:209], v11 offset:96
    s_add_u32 s66, s86, 2048
    buffer_store_dwordx4 v[224:227], v15, s[32:35], s66 offen sc1
    ds_write_b128 v24, v[224:227] offset:2048
    v_mfma_f32_16x16x32_bf16 v[84:87], v[196:199], a[212:215], v[84:87]
    ds_read_b64_tr_b16 v[210:211], v11 offset:4704
    v_cvt_pk_bf16_f32 v228, v136, v137
    v_cvt_pk_bf16_f32 v229, v138, v139
    v_mfma_f32_16x16x32_bf16 v[88:91], v[196:199], a[216:219], v[88:91]
    v_cvt_pk_bf16_f32 v230, v140, v141
    v_cvt_pk_bf16_f32 v231, v142, v143
    v_mfma_f32_16x16x32_bf16 v[92:95], v[196:199], a[220:223], v[92:95]
    s_add_u32 s66, s87, 2048
    buffer_store_dwordx4 v[228:231], v15, s[32:35], s66 offen sc1
    ds_write_b128 v25, v[228:231] offset:2048
    s_waitcnt lgkmcnt(6)
    v_mfma_f32_16x16x32_bf16 v[80:83], v[200:203], a[224:227], v[80:83]
    ds_read_b64_tr_b16 v[212:213], v11 offset:9312
    v_mfma_f32_16x16x32_bf16 v[84:87], v[200:203], a[228:231], v[84:87]
    ds_read_b64_tr_b16 v[214:215], v11 offset:13920
    v_mfma_f32_16x16x32_bf16 v[88:91], v[200:203], a[232:235], v[88:91]
    v_mfma_f32_16x16x32_bf16 v[92:95], v[200:203], a[236:239], v[92:95]
    s_waitcnt lgkmcnt(6)
    v_mfma_f32_16x16x32_bf16 v[80:83], v[204:207], a[240:243], v[80:83]
    ds_read_b64_tr_b16 v[192:193], v9 offset:128
    v_mfma_f32_16x16x32_bf16 v[84:87], v[204:207], a[244:247], v[84:87]
    ds_read_b64_tr_b16 v[194:195], v9 offset:4736
    v_mfma_f32_16x16x32_bf16 v[88:91], v[204:207], a[248:251], v[88:91]
    v_mfma_f32_16x16x32_bf16 v[92:95], v[204:207], a[252:255], v[92:95]
    s_waitcnt lgkmcnt(5)
    v_mfma_f32_16x16x32_bf16 v[80:83], v[208:211], v[48:51], v[80:83]
    ds_read_b64_tr_b16 v[196:197], v9 offset:9344
    v_mfma_f32_16x16x32_bf16 v[84:87], v[208:211], v[52:55], v[84:87]
    ds_read_b64_tr_b16 v[198:199], v9 offset:13952
    v_mfma_f32_16x16x32_bf16 v[88:91], v[208:211], v[56:59], v[88:91]
    v_mfma_f32_16x16x32_bf16 v[92:95], v[208:211], v[60:63], v[92:95]
    s_waitcnt lgkmcnt(4)
    v_mfma_f32_16x16x32_bf16 v[80:83], v[212:215], a[0:3], v[80:83]
    ds_read_b64_tr_b16 v[200:201], v10 offset:128
    v_mfma_f32_16x16x32_bf16 v[84:87], v[212:215], a[4:7], v[84:87]
    ds_read_b64_tr_b16 v[202:203], v10 offset:4736
    v_mfma_f32_16x16x32_bf16 v[88:91], v[212:215], a[8:11], v[88:91]
    v_mfma_f32_16x16x32_bf16 v[92:95], v[212:215], a[12:15], v[92:95]
    s_waitcnt lgkmcnt(4)
    v_mfma_f32_16x16x32_bf16 v[144:147], v[192:195], a[192:195], v[144:147]
    ds_read_b64_tr_b16 v[204:205], v10 offset:9344
    v_mfma_f32_16x16x32_bf16 v[148:151], v[192:195], a[196:199], v[148:151]
    ds_read_b64_tr_b16 v[206:207], v10 offset:13952
    v_mfma_f32_16x16x32_bf16 v[152:155], v[192:195], a[200:203], v[152:155]
    v_cvt_pk_bf16_f32 v232, v80, v81
    v_cvt_pk_bf16_f32 v233, v82, v83
    v_mfma_f32_16x16x32_bf16 v[156:159], v[192:195], a[204:207], v[156:159]
    v_cvt_pk_bf16_f32 v234, v84, v85
    v_cvt_pk_bf16_f32 v235, v86, v87
    s_waitcnt lgkmcnt(4)
    v_mfma_f32_16x16x32_bf16 v[144:147], v[196:199], a[208:211], v[144:147]
    ds_read_b64_tr_b16 v[208:209], v11 offset:128
    s_add_u32 s66, s86, 3072
    buffer_store_dwordx4 v[232:235], v15, s[32:35], s66 offen sc1
    ds_write_b128 v24, v[232:235] offset:3072
    v_mfma_f32_16x16x32_bf16 v[148:151], v[196:199], a[212:215], v[148:151]
    ds_read_b64_tr_b16 v[210:211], v11 offset:4736
    v_cvt_pk_bf16_f32 v236, v88, v89
    v_cvt_pk_bf16_f32 v237, v90, v91
    v_mfma_f32_16x16x32_bf16 v[152:155], v[196:199], a[216:219], v[152:155]
    v_cvt_pk_bf16_f32 v238, v92, v93
    v_cvt_pk_bf16_f32 v239, v94, v95
    v_mfma_f32_16x16x32_bf16 v[156:159], v[196:199], a[220:223], v[156:159]
    s_add_u32 s66, s87, 3072
    buffer_store_dwordx4 v[236:239], v15, s[32:35], s66 offen sc1
    ds_write_b128 v25, v[236:239] offset:3072
    s_waitcnt lgkmcnt(6)
    v_mfma_f32_16x16x32_bf16 v[144:147], v[200:203], a[224:227], v[144:147]
    ds_read_b64_tr_b16 v[212:213], v11 offset:9344
    v_mfma_f32_16x16x32_bf16 v[148:151], v[200:203], a[228:231], v[148:151]
    ds_read_b64_tr_b16 v[214:215], v11 offset:13952
    v_mfma_f32_16x16x32_bf16 v[152:155], v[200:203], a[232:235], v[152:155]
    v_mfma_f32_16x16x32_bf16 v[156:159], v[200:203], a[236:239], v[156:159]
    s_waitcnt lgkmcnt(6)
    v_mfma_f32_16x16x32_bf16 v[144:147], v[204:207], a[240:243], v[144:147]
    ds_read_b64_tr_b16 v[192:193], v9 offset:160
    v_mfma_f32_16x16x32_bf16 v[148:151], v[204:207], a[244:247], v[148:151]
    ds_read_b64_tr_b16 v[194:195], v9 offset:4768
    v_mfma_f32_16x16x32_bf16 v[152:155], v[204:207], a[248:251], v[152:155]
    v_mfma_f32_16x16x32_bf16 v[156:159], v[204:207], a[252:255], v[156:159]
    s_waitcnt lgkmcnt(5)
    v_mfma_f32_16x16x32_bf16 v[144:147], v[208:211], v[48:51], v[144:147]
    ds_read_b64_tr_b16 v[196:197], v9 offset:9376
    v_mfma_f32_16x16x32_bf16 v[148:151], v[208:211], v[52:55], v[148:151]
    ds_read_b64_tr_b16 v[198:199], v9 offset:13984
    v_mfma_f32_16x16x32_bf16 v[152:155], v[208:211], v[56:59], v[152:155]
    v_mfma_f32_16x16x32_bf16 v[156:159], v[208:211], v[60:63], v[156:159]
    s_waitcnt lgkmcnt(4)
    v_mfma_f32_16x16x32_bf16 v[144:147], v[212:215], a[0:3], v[144:147]
    ds_read_b64_tr_b16 v[200:201], v10 offset:160
    v_mfma_f32_16x16x32_bf16 v[148:151], v[212:215], a[4:7], v[148:151]
    ds_read_b64_tr_b16 v[202:203], v10 offset:4768
    v_mfma_f32_16x16x32_bf16 v[152:155], v[212:215], a[8:11], v[152:155]
    v_mfma_f32_16x16x32_bf16 v[156:159], v[212:215], a[12:15], v[156:159]
    s_waitcnt lgkmcnt(4)
    v_mfma_f32_16x16x32_bf16 v[96:99], v[192:195], a[192:195], v[96:99]
    ds_read_b64_tr_b16 v[204:205], v10 offset:9376
    v_mfma_f32_16x16x32_bf16 v[100:103], v[192:195], a[196:199], v[100:103]
    ds_read_b64_tr_b16 v[206:207], v10 offset:13984
    v_mfma_f32_16x16x32_bf16 v[104:107], v[192:195], a[200:203], v[104:107]
    v_cvt_pk_bf16_f32 v224, v144, v145
    v_cvt_pk_bf16_f32 v225, v146, v147
    v_mfma_f32_16x16x32_bf16 v[108:111], v[192:195], a[204:207], v[108:111]
    v_cvt_pk_bf16_f32 v226, v148, v149
    v_cvt_pk_bf16_f32 v227, v150, v151
    s_waitcnt lgkmcnt(4)
    v_mfma_f32_16x16x32_bf16 v[96:99], v[196:199], a[208:211], v[96:99]
    ds_read_b64_tr_b16 v[208:209], v11 offset:160
    s_add_u32 s66, s86, 4096
    buffer_store_dwordx4 v[224:227], v15, s[32:35], s66 offen sc1
    ds_write_b128 v24, v[224:227] offset:4096
    v_mfma_f32_16x16x32_bf16 v[100:103], v[196:199], a[212:215], v[100:103]
    ds_read_b64_tr_b16 v[210:211], v11 offset:4768
    v_cvt_pk_bf16_f32 v228, v152, v153
    v_cvt_pk_bf16_f32 v229, v154, v155
    v_mfma_f32_16x16x32_bf16 v[104:107], v[196:199], a[216:219], v[104:107]
    v_cvt_pk_bf16_f32 v230, v156, v157
    v_cvt_pk_bf16_f32 v231, v158, v159
    v_mfma_f32_16x16x32_bf16 v[108:111], v[196:199], a[220:223], v[108:111]
    s_add_u32 s66, s87, 4096
    buffer_store_dwordx4 v[228:231], v15, s[32:35], s66 offen sc1
    ds_write_b128 v25, v[228:231] offset:4096
    s_waitcnt lgkmcnt(6)
    v_mfma_f32_16x16x32_bf16 v[96:99], v[200:203], a[224:227], v[96:99]
    ds_read_b64_tr_b16 v[212:213], v11 offset:9376
    v_mfma_f32_16x16x32_bf16 v[100:103], v[200:203], a[228:231], v[100:103]
    ds_read_b64_tr_b16 v[214:215], v11 offset:13984
    v_mfma_f32_16x16x32_bf16 v[104:107], v[200:203], a[232:235], v[104:107]
    v_mfma_f32_16x16x32_bf16 v[108:111], v[200:203], a[236:239], v[108:111]
    s_waitcnt lgkmcnt(6)
    v_mfma_f32_16x16x32_bf16 v[96:99], v[204:207], a[240:243], v[96:99]
    ds_read_b64_tr_b16 v[192:193], v9 offset:192
    v_mfma_f32_16x16x32_bf16 v[100:103], v[204:207], a[244:247], v[100:103]
    ds_read_b64_tr_b16 v[194:195], v9 offset:4800
    v_mfma_f32_16x16x32_bf16 v[104:107], v[204:207], a[248:251], v[104:107]
    v_mfma_f32_16x16x32_bf16 v[108:111], v[204:207], a[252:255], v[108:111]
    s_waitcnt lgkmcnt(5)
    v_mfma_f32_16x16x32_bf16 v[96:99], v[208:211], v[48:51], v[96:99]
    ds_read_b64_tr_b16 v[196:197], v9 offset:9408
    v_mfma_f32_16x16x32_bf16 v[100:103], v[208:211], v[52:55], v[100:103]
    ds_read_b64_tr_b16 v[198:199], v9 offset:14016
    v_mfma_f32_16x16x32_bf16 v[104:107], v[208:211], v[56:59], v[104:107]
    v_mfma_f32_16x16x32_bf16 v[108:111], v[208:211], v[60:63], v[108:111]
    s_waitcnt lgkmcnt(4)
    v_mfma_f32_16x16x32_bf16 v[96:99], v[212:215], a[0:3], v[96:99]
    ds_read_b64_tr_b16 v[200:201], v10 offset:192
    v_mfma_f32_16x16x32_bf16 v[100:103], v[212:215], a[4:7], v[100:103]
    ds_read_b64_tr_b16 v[202:203], v10 offset:4800
    v_mfma_f32_16x16x32_bf16 v[104:107], v[212:215], a[8:11], v[104:107]
    v_mfma_f32_16x16x32_bf16 v[108:111], v[212:215], a[12:15], v[108:111]
    s_waitcnt lgkmcnt(4)
    v_mfma_f32_16x16x32_bf16 v[160:163], v[192:195], a[192:195], v[160:163]
    ds_read_b64_tr_b16 v[204:205], v10 offset:9408
    v_mfma_f32_16x16x32_bf16 v[164:167], v[192:195], a[196:199], v[164:167]
    ds_read_b64_tr_b16 v[206:207], v10 offset:14016
    v_mfma_f32_16x16x32_bf16 v[168:171], v[192:195], a[200:203], v[168:171]
    v_cvt_pk_bf16_f32 v232, v96, v97
    v_cvt_pk_bf16_f32 v233, v98, v99
    v_mfma_f32_16x16x32_bf16 v[172:175], v[192:195], a[204:207], v[172:175]
    v_cvt_pk_bf16_f32 v234, v100, v101
    v_cvt_pk_bf16_f32 v235, v102, v103
    s_waitcnt lgkmcnt(4)
    v_mfma_f32_16x16x32_bf16 v[160:163], v[196:199], a[208:211], v[160:163]
    ds_read_b64_tr_b16 v[208:209], v11 offset:192
    s_add_u32 s66, s86, 5120
    buffer_store_dwordx4 v[232:235], v15, s[32:35], s66 offen sc1
    ds_write_b128 v24, v[232:235] offset:5120
    v_mfma_f32_16x16x32_bf16 v[164:167], v[196:199], a[212:215], v[164:167]
    ds_read_b64_tr_b16 v[210:211], v11 offset:4800
    v_cvt_pk_bf16_f32 v236, v104, v105
    v_cvt_pk_bf16_f32 v237, v106, v107
    v_mfma_f32_16x16x32_bf16 v[168:171], v[196:199], a[216:219], v[168:171]
    v_cvt_pk_bf16_f32 v238, v108, v109
    v_cvt_pk_bf16_f32 v239, v110, v111
    v_mfma_f32_16x16x32_bf16 v[172:175], v[196:199], a[220:223], v[172:175]
    s_add_u32 s66, s87, 5120
    buffer_store_dwordx4 v[236:239], v15, s[32:35], s66 offen sc1
    ds_write_b128 v25, v[236:239] offset:5120
    s_waitcnt lgkmcnt(6)
    v_mfma_f32_16x16x32_bf16 v[160:163], v[200:203], a[224:227], v[160:163]
    ds_read_b64_tr_b16 v[212:213], v11 offset:9408
    v_mfma_f32_16x16x32_bf16 v[164:167], v[200:203], a[228:231], v[164:167]
    ds_read_b64_tr_b16 v[214:215], v11 offset:14016
    v_mfma_f32_16x16x32_bf16 v[168:171], v[200:203], a[232:235], v[168:171]
    v_mfma_f32_16x16x32_bf16 v[172:175], v[200:203], a[236:239], v[172:175]
    s_waitcnt lgkmcnt(6)
    v_mfma_f32_16x16x32_bf16 v[160:163], v[204:207], a[240:243], v[160:163]
    ds_read_b64_tr_b16 v[192:193], v9 offset:224
    v_mfma_f32_16x16x32_bf16 v[164:167], v[204:207], a[244:247], v[164:167]
    ds_read_b64_tr_b16 v[194:195], v9 offset:4832
    v_mfma_f32_16x16x32_bf16 v[168:171], v[204:207], a[248:251], v[168:171]
    v_mfma_f32_16x16x32_bf16 v[172:175], v[204:207], a[252:255], v[172:175]
    s_waitcnt lgkmcnt(5)
    v_mfma_f32_16x16x32_bf16 v[160:163], v[208:211], v[48:51], v[160:163]
    ds_read_b64_tr_b16 v[196:197], v9 offset:9440
    v_mfma_f32_16x16x32_bf16 v[164:167], v[208:211], v[52:55], v[164:167]
    ds_read_b64_tr_b16 v[198:199], v9 offset:14048
    v_mfma_f32_16x16x32_bf16 v[168:171], v[208:211], v[56:59], v[168:171]
    v_mfma_f32_16x16x32_bf16 v[172:175], v[208:211], v[60:63], v[172:175]
    s_waitcnt lgkmcnt(4)
    v_mfma_f32_16x16x32_bf16 v[160:163], v[212:215], a[0:3], v[160:163]
    ds_read_b64_tr_b16 v[200:201], v10 offset:224
    v_mfma_f32_16x16x32_bf16 v[164:167], v[212:215], a[4:7], v[164:167]
    ds_read_b64_tr_b16 v[202:203], v10 offset:4832
    v_mfma_f32_16x16x32_bf16 v[168:171], v[212:215], a[8:11], v[168:171]
    v_mfma_f32_16x16x32_bf16 v[172:175], v[212:215], a[12:15], v[172:175]
    s_waitcnt lgkmcnt(4)
    v_mfma_f32_16x16x32_bf16 v[112:115], v[192:195], a[192:195], v[112:115]
    ds_read_b64_tr_b16 v[204:205], v10 offset:9440
    v_mfma_f32_16x16x32_bf16 v[116:119], v[192:195], a[196:199], v[116:119]
    ds_read_b64_tr_b16 v[206:207], v10 offset:14048
    v_mfma_f32_16x16x32_bf16 v[120:123], v[192:195], a[200:203], v[120:123]
    v_cvt_pk_bf16_f32 v224, v160, v161
    v_cvt_pk_bf16_f32 v225, v162, v163
    v_mfma_f32_16x16x32_bf16 v[124:127], v[192:195], a[204:207], v[124:127]
    v_cvt_pk_bf16_f32 v226, v164, v165
    v_cvt_pk_bf16_f32 v227, v166, v167
    s_waitcnt lgkmcnt(4)
    v_mfma_f32_16x16x32_bf16 v[112:115], v[196:199], a[208:211], v[112:115]
    ds_read_b64_tr_b16 v[208:209], v11 offset:224
    s_add_u32 s66, s86, 6144
    buffer_store_dwordx4 v[224:227], v15, s[32:35], s66 offen sc1
    ds_write_b128 v24, v[224:227] offset:6144
    v_mfma_f32_16x16x32_bf16 v[116:119], v[196:199], a[212:215], v[116:119]
    ds_read_b64_tr_b16 v[210:211], v11 offset:4832
    v_cvt_pk_bf16_f32 v228, v168, v169
    v_cvt_pk_bf16_f32 v229, v170, v171
    v_mfma_f32_16x16x32_bf16 v[120:123], v[196:199], a[216:219], v[120:123]
    v_cvt_pk_bf16_f32 v230, v172, v173
    v_cvt_pk_bf16_f32 v231, v174, v175
    v_mfma_f32_16x16x32_bf16 v[124:127], v[196:199], a[220:223], v[124:127]
    s_add_u32 s66, s87, 6144
    buffer_store_dwordx4 v[228:231], v15, s[32:35], s66 offen sc1
    ds_write_b128 v25, v[228:231] offset:6144
    s_waitcnt lgkmcnt(6)
    v_mfma_f32_16x16x32_bf16 v[112:115], v[200:203], a[224:227], v[112:115]
    ds_read_b64_tr_b16 v[212:213], v11 offset:9440
    v_mfma_f32_16x16x32_bf16 v[116:119], v[200:203], a[228:231], v[116:119]
    ds_read_b64_tr_b16 v[214:215], v11 offset:14048
    v_mfma_f32_16x16x32_bf16 v[120:123], v[200:203], a[232:235], v[120:123]
    v_mfma_f32_16x16x32_bf16 v[124:127], v[200:203], a[236:239], v[124:127]
    s_waitcnt lgkmcnt(6)
    v_mfma_f32_16x16x32_bf16 v[112:115], v[204:207], a[240:243], v[112:115]
    v_mfma_f32_16x16x32_bf16 v[116:119], v[204:207], a[244:247], v[116:119]
    s_waitcnt vmcnt(6)
    s_lshl_b32 s66, s46, 2
    s_add_u32 s66, s66, s44
    s_lshl_b32 s66, s66, 7
    s_add_u32 s66, s66, s81
    s_add_u32 s66, s66, 0
    buffer_store_dword v0, off, s[32:35], s66 sc1
    v_mfma_f32_16x16x32_bf16 v[120:123], v[204:207], a[248:251], v[120:123]
    v_mfma_f32_16x16x32_bf16 v[124:127], v[204:207], a[252:255], v[124:127]
    s_waitcnt lgkmcnt(3)
    v_mfma_f32_16x16x32_bf16 v[112:115], v[208:211], v[48:51], v[112:115]
    v_mfma_f32_16x16x32_bf16 v[116:119], v[208:211], v[52:55], v[116:119]
    v_mfma_f32_16x16x32_bf16 v[120:123], v[208:211], v[56:59], v[120:123]
    v_mfma_f32_16x16x32_bf16 v[124:127], v[208:211], v[60:63], v[124:127]
    s_waitcnt lgkmcnt(0)
    v_mfma_f32_16x16x32_bf16 v[112:115], v[212:215], a[0:3], v[112:115]
    v_mfma_f32_16x16x32_bf16 v[116:119], v[212:215], a[4:7], v[116:119]
    v_mfma_f32_16x16x32_bf16 v[120:123], v[212:215], a[8:11], v[120:123]
    v_mfma_f32_16x16x32_bf16 v[124:127], v[212:215], a[12:15], v[124:127]
    s_nop 4
    v_cvt_pk_bf16_f32 v232, v112, v113
    v_cvt_pk_bf16_f32 v233, v114, v115
    v_cvt_pk_bf16_f32 v234, v116, v117
    v_cvt_pk_bf16_f32 v235, v118, v119
    s_add_u32 s66, s86, 7168
    buffer_store_dwordx4 v[232:235], v15, s[32:35], s66 offen sc1
    ds_write_b128 v24, v[232:235] offset:7168
    v_cvt_pk_bf16_f32 v236, v120, v121
    v_cvt_pk_bf16_f32 v237, v122, v123
    v_cvt_pk_bf16_f32 v238, v124, v125
    v_cvt_pk_bf16_f32 v239, v126, v127
    s_add_u32 s66, s87, 7168
    buffer_store_dwordx4 v[236:239], v15, s[32:35], s66 offen sc1
    ds_write_b128 v25, v[236:239] offset:7168
    s_add_u32 s66, s69, 0
    buffer_load_dword v19, v17, s[32:35], s66 offen sc1
    s_lshl_b32 s19, s45, 3
    s_add_u32 s19, s19, s46
    s_mul_i32 s19, s19, 36864
    s_mul_i32 s67, s47, 288
    s_add_u32 s19, s19, s67
    s_lshl_b32 s67, s44, 5
    s_add_u32 s19, s19, s67
    v_bfe_u32 v20, v15, 4, 4
    v_mul_u32_u24 v20, 1152, v20
    v_lshrrev_b32 v21, 8, v15
    v_lshl_add_u32 v20, v21, 3, v20
    s_waitcnt vmcnt(0)
    s_lshl_b32 s66, s46, 2
    s_add_u32 s66, s66, s44
    s_lshl_b32 s66, s66, 7
    s_add_u32 s66, s66, s81
    s_add_u32 s66, s66, 131072
    buffer_store_dword v0, off, s[32:35], s66 sc1
    s_waitcnt lgkmcnt(0)
    s_barrier
    s_cmp_eq_u32 s80, 1
    s_cbranch_scc1 L_g1done
    v_cmp_ne_u32 s[70:71], v19, v0
    s_nop 3
    s_andn2_b64 s[70:71], s[70:71], s[96:97]
    s_cbranch_scc0 L_f1ok
    s_mov_b32 s4, 1000000
L_f1sp:
    s_add_u32 s66, s69, 0
    buffer_load_dword v19, v17, s[32:35], s66 offen sc1
    s_waitcnt vmcnt(0)
    v_cmp_ne_u32 s[70:71], v19, v0
    s_nop 3
    s_andn2_b64 s[70:71], s[70:71], s[96:97]
    s_cbranch_scc0 L_f1ok
    s_sub_u32 s4, s4, 1
    s_cmp_lg_u32 s4, 0
    s_cbranch_scc1 L_f1sp
L_f1ok:
    buffer_load_dwordx4 v[176:179], v15, s[32:35], s72 offen sc1
    buffer_load_dwordx4 v[180:183], v15, s[32:35], s73 offen sc1
    buffer_load_dwordx4 v[184:187], v15, s[32:35], s74 offen sc1
    buffer_load_dwordx4 v[188:191], v15, s[32:35], s75 offen sc1
    buffer_load_dwordx4 v[32:35], v15, s[32:35], s76 offen sc1
    buffer_load_dwordx4 v[36:39], v15, s[32:35], s77 offen sc1
    buffer_load_dwordx4 v[40:43], v15, s[32:35], s78 offen sc1
    s_cmp_eq_u32 s44, 0
    s_cbranch_scc0 L_no3
    s_add_u32 s66, s72, 8192
    buffer_load_dwordx4 v[64:67], v15, s[32:35], s66 offen sc1
    s_add_u32 s66, s73, 8192
    buffer_load_dwordx4 v[68:71], v15, s[32:35], s66 offen sc1
    s_add_u32 s66, s74, 8192
    buffer_load_dwordx4 v[72:75], v15, s[32:35], s66 offen sc1
    s_add_u32 s66, s75, 8192
    buffer_load_dwordx4 v[76:79], v15, s[32:35], s66 offen sc1
    s_add_u32 s66, s76, 8192
    buffer_load_dwordx4 v[128:131], v15, s[32:35], s66 offen sc1
    s_add_u32 s66, s77, 8192
    buffer_load_dwordx4 v[132:135], v15, s[32:35], s66 offen sc1
    s_add_u32 s66, s78, 8192
    buffer_load_dwordx4 v[136:139], v15, s[32:35], s66 offen sc1
L_no3:
L_g1done:
    s_lshl_b32 s66, s44, 10
    s_add_u32 s66, s66, 147456
    v_add_u32 v21, s66, v15
    ds_read_b128 v[44:47], v21
    ds_read_b128 v[156:159], v21 offset:4096
    ds_read_b128 v[140:143], v21 offset:8192
    s_waitcnt lgkmcnt(0)
    s_add_u32 s66, s69, 131072
    buffer_load_dword v19, v17, s[32:35], s66 offen sc1
    s_waitcnt vmcnt(0)
    v_cmp_ne_u32 s[70:71], v19, v0
    s_nop 3
    s_andn2_b64 s[70:71], s[70:71], s[96:97]
    s_cbranch_scc0 L_f2ok
    s_mov_b32 s4, 1000000
L_f2sp:
    s_add_u32 s66, s69, 131072
    buffer_load_dword v19, v17, s[32:35], s66 offen sc1
    s_waitcnt vmcnt(0)
    v_cmp_ne_u32 s[70:71], v19, v0
    s_nop 3
    s_andn2_b64 s[70:71], s[70:71], s[96:97]
    s_cbranch_scc0 L_f2ok
    s_sub_u32 s4, s4, 1
    s_cmp_lg_u32 s4, 0
    s_cbranch_scc1 L_f2sp
L_f2ok:
    s_add_u32 s66, s72, 4096
    buffer_load_dwordx4 v[80:83], v15, s[32:35], s66 offen sc1
    s_add_u32 s66, s73, 4096
    buffer_load_dwordx4 v[84:87], v15, s[32:35], s66 offen sc1
    s_add_u32 s66, s74, 4096
    buffer_load_dwordx4 v[88:91], v15, s[32:35], s66 offen sc1
    s_add_u32 s66, s75, 4096
    buffer_load_dwordx4 v[92:95], v15, s[32:35], s66 offen sc1
    s_add_u32 s66, s76, 4096
    buffer_load_dwordx4 v[144:147], v15, s[32:35], s66 offen sc1
    s_add_u32 s66, s77, 4096
    buffer_load_dwordx4 v[148:151], v15, s[32:35], s66 offen sc1
    s_add_u32 s66, s78, 4096
    buffer_load_dwordx4 v[152:155], v15, s[32:35], s66 offen sc1
    v_lshlrev_b32 v160, 16, v176
    v_and_b32 v161, 0xffff0000, v176
    v_lshlrev_b32 v162, 16, v177
    v_and_b32 v163, 0xffff0000, v177
    v_lshlrev_b32 v164, 16, v178
    v_and_b32 v165, 0xffff0000, v178
    v_lshlrev_b32 v166, 16, v179
    v_and_b32 v167, 0xffff0000, v179
    v_lshlrev_b32 v22, 16, v180
    v_and_b32 v23, 0xffff0000, v180
    v_pk_add_f32 v[160:161], v[160:161], v[22:23]
    v_lshlrev_b32 v24, 16, v181
    v_and_b32 v25, 0xffff0000, v181
    v_pk_add_f32 v[162:163], v[162:163], v[24:25]
    v_lshlrev_b32 v22, 16, v182
    v_and_b32 v23, 0xffff0000, v182
    v_pk_add_f32 v[164:165], v[164:165], v[22:23]
    v_lshlrev_b32 v24, 16, v183
    v_and_b32 v25, 0xffff0000, v183
    v_pk_add_f32 v[166:167], v[166:167], v[24:25]
    v_lshlrev_b32 v22, 16, v184
    v_and_b32 v23, 0xffff0000, v184
    v_pk_add_f32 v[160:161], v[160:161], v[22:23]
    v_lshlrev_b32 v24, 16, v185
    v_and_b32 v25, 0xffff0000, v185
    v_pk_add_f32 v[162:163], v[162:163], v[24:25]
    v_lshlrev_b32 v22, 16, v186
    v_and_b32 v23, 0xffff0000, v186
    v_pk_add_f32 v[164:165], v[164:165], v[22:23]
    v_lshlrev_b32 v24, 16, v187
    v_and_b32 v25, 0xffff0000, v187
    v_pk_add_f32 v[166:167], v[166:167], v[24:25]
    v_lshlrev_b32 v22, 16, v188
    v_and_b32 v23, 0xffff0000, v188
    v_pk_add_f32 v[160:161], v[160:161], v[22:23]
    v_lshlrev_b32 v24, 16, v189
    v_and_b32 v25, 0xffff0000, v189
    v_pk_add_f32 v[162:163], v[162:163], v[24:25]
    v_lshlrev_b32 v22, 16, v190
    v_and_b32 v23, 0xffff0000, v190
    v_pk_add_f32 v[164:165], v[164:165], v[22:23]
    v_lshlrev_b32 v24, 16, v191
    v_and_b32 v25, 0xffff0000, v191
    v_pk_add_f32 v[166:167], v[166:167], v[24:25]
    v_lshlrev_b32 v22, 16, v32
    v_and_b32 v23, 0xffff0000, v32
    v_pk_add_f32 v[160:161], v[160:161], v[22:23]
    v_lshlrev_b32 v24, 16, v33
    v_and_b32 v25, 0xffff0000, v33
    v_pk_add_f32 v[162:163], v[162:163], v[24:25]
    v_lshlrev_b32 v22, 16, v34
    v_and_b32 v23, 0xffff0000, v34
    v_pk_add_f32 v[164:165], v[164:165], v[22:23]
    v_lshlrev_b32 v24, 16, v35
    v_and_b32 v25, 0xffff0000, v35
    v_pk_add_f32 v[166:167], v[166:167], v[24:25]
    v_lshlrev_b32 v22, 16, v36
    v_and_b32 v23, 0xffff0000, v36
    v_pk_add_f32 v[160:161], v[160:161], v[22:23]
    v_lshlrev_b32 v24, 16, v37
    v_and_b32 v25, 0xffff0000, v37
    v_pk_add_f32 v[162:163], v[162:163], v[24:25]
    v_lshlrev_b32 v22, 16, v38
    v_and_b32 v23, 0xffff0000, v38
    v_pk_add_f32 v[164:165], v[164:165], v[22:23]
    v_lshlrev_b32 v24, 16, v39
    v_and_b32 v25, 0xffff0000, v39
    v_pk_add_f32 v[166:167], v[166:167], v[24:25]
    v_lshlrev_b32 v22, 16, v40
    v_and_b32 v23, 0xffff0000, v40
    v_pk_add_f32 v[160:161], v[160:161], v[22:23]
    v_lshlrev_b32 v24, 16, v41
    v_and_b32 v25, 0xffff0000, v41
    v_pk_add_f32 v[162:163], v[162:163], v[24:25]
    v_lshlrev_b32 v22, 16, v42
    v_and_b32 v23, 0xffff0000, v42
    v_pk_add_f32 v[164:165], v[164:165], v[22:23]
    v_lshlrev_b32 v24, 16, v43
    v_and_b32 v25, 0xffff0000, v43
    v_pk_add_f32 v[166:167], v[166:167], v[24:25]
    v_lshlrev_b32 v22, 16, v44
    v_and_b32 v23, 0xffff0000, v44
    v_pk_add_f32 v[160:161], v[160:161], v[22:23]
    v_lshlrev_b32 v24, 16, v45
    v_and_b32 v25, 0xffff0000, v45
    v_pk_add_f32 v[162:163], v[162:163], v[24:25]
    v_lshlrev_b32 v22, 16, v46
    v_and_b32 v23, 0xffff0000, v46
    v_pk_add_f32 v[164:165], v[164:165], v[22:23]
    v_lshlrev_b32 v24, 16, v47
    v_and_b32 v25, 0xffff0000, v47
    v_pk_add_f32 v[166:167], v[166:167], v[24:25]
    v_cvt_pk_bf16_f32 v168, v160, v161
    v_cvt_pk_bf16_f32 v169, v162, v163
    v_cvt_pk_bf16_f32 v170, v164, v165
    v_cvt_pk_bf16_f32 v171, v166, v167
    s_cmp_eq_u32 s44, 0
    s_cbranch_scc0 L_no3b
    v_lshlrev_b32 v192, 16, v64
    v_and_b32 v193, 0xffff0000, v64
    v_lshlrev_b32 v194, 16, v65
    v_and_b32 v195, 0xffff0000, v65
    v_lshlrev_b32 v196, 16, v66
    v_and_b32 v197, 0xffff0000, v66
    v_lshlrev_b32 v198, 16, v67
    v_and_b32 v199, 0xffff0000, v67
    v_lshlrev_b32 v22, 16, v68
    v_and_b32 v23, 0xffff0000, v68
    v_pk_add_f32 v[192:193], v[192:193], v[22:23]
    v_lshlrev_b32 v24, 16, v69
    v_and_b32 v25, 0xffff0000, v69
    v_pk_add_f32 v[194:195], v[194:195], v[24:25]
    v_lshlrev_b32 v22, 16, v70
    v_and_b32 v23, 0xffff0000, v70
    v_pk_add_f32 v[196:197], v[196:197], v[22:23]
    v_lshlrev_b32 v24, 16, v71
    v_and_b32 v25, 0xffff0000, v71
    v_pk_add_f32 v[198:199], v[198:199], v[24:25]
    v_lshlrev_b32 v22, 16, v72
    v_and_b32 v23, 0xffff0000, v72
    v_pk_add_f32 v[192:193], v[192:193], v[22:23]
    v_lshlrev_b32 v24, 16, v73
    v_and_b32 v25, 0xffff0000, v73
    v_pk_add_f32 v[194:195], v[194:195], v[24:25]
    v_lshlrev_b32 v22, 16, v74
    v_and_b32 v23, 0xffff0000, v74
    v_pk_add_f32 v[196:197], v[196:197], v[22:23]
    v_lshlrev_b32 v24, 16, v75
    v_and_b32 v25, 0xffff0000, v75
    v_pk_add_f32 v[198:199], v[198:199], v[24:25]
    v_lshlrev_b32 v22, 16, v76
    v_and_b32 v23, 0xffff0000, v76
    v_pk_add_f32 v[192:193], v[192:193], v[22:23]
    v_lshlrev_b32 v24, 16, v77
    v_and_b32 v25, 0xffff0000, v77
    v_pk_add_f32 v[194:195], v[194:195], v[24:25]
    v_lshlrev_b32 v22, 16, v78
    v_and_b32 v23, 0xffff0000, v78
    v_pk_add_f32 v[196:197], v[196:197], v[22:23]
    v_lshlrev_b32 v24, 16, v79
    v_and_b32 v25, 0xffff0000, v79
    v_pk_add_f32 v[198:199], v[198:199], v[24:25]
    v_lshlrev_b32 v22, 16, v128
    v_and_b32 v23, 0xffff0000, v128
    v_pk_add_f32 v[192:193], v[192:193], v[22:23]
    v_lshlrev_b32 v24, 16, v129
    v_and_b32 v25, 0xffff0000, v129
    v_pk_add_f32 v[194:195], v[194:195], v[24:25]
    v_lshlrev_b32 v22, 16, v130
    v_and_b32 v23, 0xffff0000, v130
    v_pk_add_f32 v[196:197], v[196:197], v[22:23]
    v_lshlrev_b32 v24, 16, v131
    v_and_b32 v25, 0xffff0000, v131
    v_pk_add_f32 v[198:199], v[198:199], v[24:25]
    v_lshlrev_b32 v22, 16, v132
    v_and_b32 v23, 0xffff0000, v132
    v_pk_add_f32 v[192:193], v[192:193], v[22:23]
    v_lshlrev_b32 v24, 16, v133
    v_and_b32 v25, 0xffff0000, v133
    v_pk_add_f32 v[194:195], v[194:195], v[24:25]
    v_lshlrev_b32 v22, 16, v134
    v_and_b32 v23, 0xffff0000, v134
    v_pk_add_f32 v[196:197], v[196:197], v[22:23]
    v_lshlrev_b32 v24, 16, v135
    v_and_b32 v25, 0xffff0000, v135
    v_pk_add_f32 v[198:199], v[198:199], v[24:25]
    v_lshlrev_b32 v22, 16, v136
    v_and_b32 v23, 0xffff0000, v136
    v_pk_add_f32 v[192:193], v[192:193], v[22:23]
    v_lshlrev_b32 v24, 16, v137
    v_and_b32 v25, 0xffff0000, v137
    v_pk_add_f32 v[194:195], v[194:195], v[24:25]
    v_lshlrev_b32 v22, 16, v138
    v_and_b32 v23, 0xffff0000, v138
    v_pk_add_f32 v[196:197], v[196:197], v[22:23]
    v_lshlrev_b32 v24, 16, v139
    v_and_b32 v25, 0xffff0000, v139
    v_pk_add_f32 v[198:199], v[198:199], v[24:25]
    v_lshlrev_b32 v22, 16, v140
    v_and_b32 v23, 0xffff0000, v140
    v_pk_add_f32 v[192:193], v[192:193], v[22:23]
    v_lshlrev_b32 v24, 16, v141
    v_and_b32 v25, 0xffff0000, v141
    v_pk_add_f32 v[194:195], v[194:195], v[24:25]
    v_lshlrev_b32 v22, 16, v142
    v_and_b32 v23, 0xffff0000, v142
    v_pk_add_f32 v[196:197], v[196:197], v[22:23]
    v_lshlrev_b32 v24, 16, v143
    v_and_b32 v25, 0xffff0000, v143
    v_pk_add_f32 v[198:199], v[198:199], v[24:25]
    v_cvt_pk_bf16_f32 v200, v192, v193
    v_cvt_pk_bf16_f32 v201, v194, v195
    v_cvt_pk_bf16_f32 v202, v196, v197
    v_cvt_pk_bf16_f32 v203, v198, v199
L_no3b:
    s_waitcnt vmcnt(6)
    v_lshlrev_b32 v176, 16, v80
    v_and_b32 v177, 0xffff0000, v80
    v_lshlrev_b32 v178, 16, v81
    v_and_b32 v179, 0xffff0000, v81
    v_lshlrev_b32 v180, 16, v82
    v_and_b32 v181, 0xffff0000, v82
    v_lshlrev_b32 v182, 16, v83
    v_and_b32 v183, 0xffff0000, v83
    s_waitcnt vmcnt(5)
    v_lshlrev_b32 v22, 16, v84
    v_and_b32 v23, 0xffff0000, v84
    v_pk_add_f32 v[176:177], v[176:177], v[22:23]
    v_lshlrev_b32 v24, 16, v85
    v_and_b32 v25, 0xffff0000, v85
    v_pk_add_f32 v[178:179], v[178:179], v[24:25]
    v_lshlrev_b32 v22, 16, v86
    v_and_b32 v23, 0xffff0000, v86
    v_pk_add_f32 v[180:181], v[180:181], v[22:23]
    v_lshlrev_b32 v24, 16, v87
    v_and_b32 v25, 0xffff0000, v87
    v_pk_add_f32 v[182:183], v[182:183], v[24:25]
    s_waitcnt vmcnt(4)
    v_lshlrev_b32 v22, 16, v88
    v_and_b32 v23, 0xffff0000, v88
    v_pk_add_f32 v[176:177], v[176:177], v[22:23]
    v_lshlrev_b32 v24, 16, v89
    v_and_b32 v25, 0xffff0000, v89
    v_pk_add_f32 v[178:179], v[178:179], v[24:25]
    v_lshlrev_b32 v22, 16, v90
    v_and_b32 v23, 0xffff0000, v90
    v_pk_add_f32 v[180:181], v[180:181], v[22:23]
    v_lshlrev_b32 v24, 16, v91
    v_and_b32 v25, 0xffff0000, v91
    v_pk_add_f32 v[182:183], v[182:183], v[24:25]
    s_waitcnt vmcnt(3)
    v_lshlrev_b32 v22, 16, v92
    v_and_b32 v23, 0xffff0000, v92
    v_pk_add_f32 v[176:177], v[176:177], v[22:23]
    v_lshlrev_b32 v24, 16, v93
    v_and_b32 v25, 0xffff0000, v93
    v_pk_add_f32 v[178:179], v[178:179], v[24:25]
    v_lshlrev_b32 v22, 16, v94
    v_and_b32 v23, 0xffff0000, v94
    v_pk_add_f32 v[180:181], v[180:181], v[22:23]
    v_lshlrev_b32 v24, 16, v95
    v_and_b32 v25, 0xffff0000, v95
    v_pk_add_f32 v[182:183], v[182:183], v[24:25]
    s_waitcnt vmcnt(2)
    v_lshlrev_b32 v22, 16, v144
    v_and_b32 v23, 0xffff0000, v144
    v_pk_add_f32 v[176:177], v[176:177], v[22:23]
    v_lshlrev_b32 v24, 16, v145
    v_and_b32 v25, 0xffff0000, v145
    v_pk_add_f32 v[178:179], v[178:179], v[24:25]
    v_lshlrev_b32 v22, 16, v146
    v_and_b32 v23, 0xffff0000, v146
    v_pk_add_f32 v[180:181], v[180:181], v[22:23]
    v_lshlrev_b32 v24, 16, v147
    v_and_b32 v25, 0xffff0000, v147
    v_pk_add_f32 v[182:183], v[182:183], v[24:25]
    s_waitcnt vmcnt(1)
    v_lshlrev_b32 v22, 16, v148
    v_and_b32 v23, 0xffff0000, v148
    v_pk_add_f32 v[176:177], v[176:177], v[22:23]
    v_lshlrev_b32 v24, 16, v149
    v_and_b32 v25, 0xffff0000, v149
    v_pk_add_f32 v[178:179], v[178:179], v[24:25]
    v_lshlrev_b32 v22, 16, v150
    v_and_b32 v23, 0xffff0000, v150
    v_pk_add_f32 v[180:181], v[180:181], v[22:23]
    v_lshlrev_b32 v24, 16, v151
    v_and_b32 v25, 0xffff0000, v151
    v_pk_add_f32 v[182:183], v[182:183], v[24:25]
    s_waitcnt vmcnt(0)
    v_lshlrev_b32 v22, 16, v152
    v_and_b32 v23, 0xffff0000, v152
    v_pk_add_f32 v[176:177], v[176:177], v[22:23]
    v_lshlrev_b32 v24, 16, v153
    v_and_b32 v25, 0xffff0000, v153
    v_pk_add_f32 v[178:179], v[178:179], v[24:25]
    v_lshlrev_b32 v22, 16, v154
    v_and_b32 v23, 0xffff0000, v154
    v_pk_add_f32 v[180:181], v[180:181], v[22:23]
    v_lshlrev_b32 v24, 16, v155
    v_and_b32 v25, 0xffff0000, v155
    v_pk_add_f32 v[182:183], v[182:183], v[24:25]
    v_lshlrev_b32 v22, 16, v156
    v_and_b32 v23, 0xffff0000, v156
    v_pk_add_f32 v[176:177], v[176:177], v[22:23]
    v_lshlrev_b32 v24, 16, v157
    v_and_b32 v25, 0xffff0000, v157
    v_pk_add_f32 v[178:179], v[178:179], v[24:25]
    v_lshlrev_b32 v22, 16, v158
    v_and_b32 v23, 0xffff0000, v158
    v_pk_add_f32 v[180:181], v[180:181], v[22:23]
    v_lshlrev_b32 v24, 16, v159
    v_and_b32 v25, 0xffff0000, v159
    v_pk_add_f32 v[182:183], v[182:183], v[24:25]
    v_cvt_pk_bf16_f32 v184, v176, v177
    v_cvt_pk_bf16_f32 v185, v178, v179
    v_cvt_pk_bf16_f32 v186, v180, v181
    v_cvt_pk_bf16_f32 v187, v182, v183
    s_add_u32 s66, s19, 0
    buffer_store_dwordx2 v[168:169], v20, s[36:39], s66 offen
    s_add_u32 s66, s19, 18432
    buffer_store_dwordx2 v[170:171], v20, s[36:39], s66 offen
    s_add_u32 s66, s19, 128
    buffer_store_dwordx2 v[184:185], v20, s[36:39], s66 offen
    s_add_u32 s66, s19, 18560
    buffer_store_dwordx2 v[186:187], v20, s[36:39], s66 offen
    s_cmp_eq_u32 s44, 0
    s_cbranch_scc0 L_no3c
    s_add_u32 s66, s19, 256
    buffer_store_dwordx2 v[200:201], v20, s[36:39], s66 offen
    s_add_u32 s66, s19, 18688
    buffer_store_dwordx2 v[202:203], v20, s[36:39], s66 offen
L_no3c:
    s_add_u32 s66, s47, s46
    s_add_u32 s66, s66, s44
    s_cmp_eq_u32 s66, 0
    s_cbranch_scc0 L_nonon
    s_lshl_b32 s66, s45, 7
    s_add_u32 s66, s66, 37879808
    buffer_store_dword v0, off, s[32:35], s66 sc1
L_nonon:
    s_waitcnt vmcnt(0) lgkmcnt(0)
L_done:
    s_endpgm
.section .rodata,"a"
.p2align 6
.amdhsa_kernel standalone__glu_gated_reglu__prompt_kernel
  .amdhsa_next_free_vgpr 512
  .amdhsa_next_free_sgpr 102
  .amdhsa_accum_offset 256
  .amdhsa_group_segment_fixed_size 0
  .amdhsa_kernarg_size 56
  .amdhsa_user_sgpr_count 2
  .amdhsa_user_sgpr_kernarg_segment_ptr 1
  .amdhsa_system_sgpr_workgroup_id_x 1
.end_amdhsa_kernel
```
